```python
import torch

def _softmax(x, axis=-1):
    return torch.softmax(x, dim=axis)
def _gelu(x):
    return torch.nn.functional.gelu(x, approximate="tanh")
def _silu(x):
    return torch.nn.functional.silu(x)
def _sigmoid(x):
    return torch.sigmoid(x)
def _layernorm(x, axis=-1, eps=1e-5):
    m = x.mean(dim=axis, keepdim=True)
    v = x.var(dim=axis, keepdim=True, unbiased=False)
    return (x - m) / torch.sqrt(v + eps)
def _scatter_add(tgt, idx, src, axis=0):
    return tgt.clone().index_add_(axis, idx, src)
def _segment_sum(src, seg, n):
    out = torch.zeros((n,) + src.shape[1:], dtype=src.dtype)
    return out.index_add_(0, seg, src)
def _pad(x, pw):
    flat = tuple(v for pair in reversed(pw) for v in pair)
    return torch.nn.functional.pad(x, flat)

kernel_name = 'standalone__mha_softmax__near_ridge'

def setup_inputs():

    _w = (lambda a: (lambda t: t.to(torch.bfloat16) if t.is_floating_point() else t)(torch.as_tensor(a)))
    B, H, Sq, Sk, D = 8, 32, 624, 1024, 128
    return {
        "q": _w((lambda *s: torch.randn(*s, dtype=torch.bfloat16) * 0.8)(B, H, Sq, D)),
        "k": _w((lambda *s: torch.randn(*s, dtype=torch.bfloat16) * 0.8)(B, H, Sk, D)),
        "v": _w((lambda *s: torch.randn(*s, dtype=torch.bfloat16) * 0.05)(B, H, Sk, D)),
    }

def reference(q, k, v):
    scale = q.shape[-1] ** -0.5
    scores = torch.einsum("bhqd,bhkd->bhqk", q, k) * scale
    p = _softmax(scores, axis=-1)
    return torch.einsum("bhqk,bhkd->bhqd", p, v)
```

```asm
; @launch grid=(256,1,1) block=(256,1,1) lds=159488
.amdgcn_target "amdgcn-amd-amdhsa--gfx950"
.text
.globl standalone__mha_softmax__near_ridge_kernel
.p2align 12
.fill 512, 4, 0xbf810000
.p2align 8
.type standalone__mha_softmax__near_ridge_kernel,@function
standalone__mha_softmax__near_ridge_kernel:
    s_cmp_ge_u32 s2, 256
    s_cbranch_scc1 L_exit
    s_load_dwordx4 s[48:51], s[0:1], 0
    s_load_dwordx4 s[52:55], s[0:1], 16
    s_getpc_b64 s[58:59]
L_pc:
    s_bfe_u32 s3, s2, 0x30003
    s_mul_i32 s3, s3, 6272
    v_mul_u32_u24 v12, 49, v0
    v_lshrrev_b32 v12, 8, v12
    v_lshl_add_u32 v12, v12, 7, s3
    v_min_u32 v12, L_end-L_pc, v12
    v_mov_b32 v13, s59
    v_add_co_u32 v12, vcc, s58, v12
    s_nop 1
    v_addc_co_u32 v13, vcc, 0, v13, vcc
    global_load_dword v19, v[12:13], off
    v_lshrrev_b32 v11, 6, v0
    v_and_b32 v0, 63, v0
    v_readfirstlane_b32 s33, v11
    v_lshlrev_b32 v3, 4, v0
    s_and_b32 s34, s2, 7
    s_lshr_b32 s35, s2, 4
    s_lshl_b32 s35, s35, 3
    s_or_b32 s3, s34, s35
    s_bfe_u32 s34, s2, 0x10003
    s_mul_i32 s37, s34, 81920
    s_sub_u32 s38, 81920, s37
    s_mul_i32 s34, s33, 20480
    s_add_u32 s37, s37, s34
    s_add_u32 s38, s38, s34
    s_mul_i32 s24, s33, 2112
    s_add_u32 s24, s24, 92416
    s_mul_i32 s25, s33, 2080
    s_add_u32 s25, s25, 126208
    s_mul_i32 s36, s33, 23104
    s_lshl_b32 s26, s33, 11
    s_sub_u32 s20, 524288, s26
    s_mov_b32 s6, s20
    s_lshl_b32 s34, s3, 19
    s_mul_i32 s35, s3, 319488
    s_mov_b32 s7, 0x20000
    s_mov_b32 s11, 0x20000
    s_mov_b32 s15, 0x20000
    s_mov_b32 s19, 0x20000
    s_mov_b32 s14, 159744
    v_bfe_u32 v11, v0, 3, 1
    v_lshrrev_b32 v12, 4, v0
    v_lshl_add_u32 v11, v11, 4, v12
    v_and_b32 v12, 7, v0
    v_lshlrev_b32 v12, 4, v12
    v_lshl_add_u32 v4, v11, 8, v12
    s_mov_b32 s22, s37
    s_waitcnt lgkmcnt(0)
    s_add_u32 s50, s50, s34
    s_addc_u32 s51, s51, 0
    s_add_u32 s4, s50, s26
    s_addc_u32 s5, s51, 0
    s_add_u32 s12, s48, s35
    s_addc_u32 s13, s49, 0
    s_getreg_b32 s27, hwreg(HW_REG_XCC_ID, 0, 1)
    s_cmp_eq_u32 s27, 0
    s_cbranch_scc1 L_shallow0
    s_add_u32 m0, s24, 0
    s_nop 0
    buffer_load_dwordx4 v3, s[4:7], 0 offen nt lds
    s_add_u32 m0, s24, 32
    s_nop 0
    buffer_load_dwordx4 v3, s[4:7], 0 offen offset:1024 nt lds
    s_add_u32 s4, s4, 8192
    s_addc_u32 s5, s5, 0
    s_sub_u32 s20, s20, 8192
    s_max_i32 s6, s20, 0
    s_add_u32 m0, s36, 0
    s_nop 0
    buffer_load_dwordx4 v3, s[12:15], s22 offen offset:0 nt lds
    s_add_u32 m0, s36, 64
    s_nop 0
    buffer_load_dwordx4 v3, s[12:15], s22 offen offset:1024 nt lds
    s_add_u32 m0, s36, 128
    s_nop 0
    buffer_load_dwordx4 v3, s[12:15], s22 offen offset:2048 nt lds
    s_add_u32 m0, s36, 192
    s_nop 0
    buffer_load_dwordx4 v3, s[12:15], s22 offen offset:3072 nt lds
    s_add_u32 s22, s22, 4096
L_shallow0:
    s_add_u32 s52, s52, s34
    s_addc_u32 s53, s53, 0
    s_add_u32 s16, s54, s35
    s_addc_u32 s17, s55, 0
    s_and_b32 s34, s33, 1
    s_lshl_b32 s34, s34, 11
    s_add_u32 s34, s34, 128
    s_sub_u32 s21, 524288, s34
    s_add_u32 s8, s52, s34
    s_addc_u32 s9, s53, 0
    s_cmp_lt_u32 s33, 2
    s_cselect_b32 s10, 0, s21
    s_cmp_eq_u32 s27, 0
    s_cbranch_scc1 L_shallow
    s_add_u32 m0, s24, 8448
    s_nop 0
    buffer_load_dwordx4 v3, s[4:7], 0 offen nt lds
    s_add_u32 m0, s24, 8480
    s_nop 0
    buffer_load_dwordx4 v3, s[4:7], 0 offen offset:1024 nt lds
    s_add_u32 s4, s4, 8192
    s_addc_u32 s5, s5, 0
    s_sub_u32 s20, s20, 8192
    s_max_i32 s6, s20, 0
    s_add_u32 m0, s25, 0
    s_nop 0
    buffer_load_dwordx4 v4, s[8:11], 0 offen nt lds
    s_add_u32 m0, s25, 16
    s_nop 0
    buffer_load_dwordx4 v4, s[8:11], 0 offen offset:1024 nt lds
    s_lshr_b32 s34, s33, 1
    s_lshl_b32 s34, s34, 13
    s_sub_u32 s34, s34, 128
    s_ashr_i32 s35, s34, 31
    s_add_u32 s8, s8, s34
    s_addc_u32 s9, s9, s35
    s_sub_u32 s21, s21, s34
    s_mov_b32 s10, s21
    s_add_u32 m0, s24, 16896
    s_nop 0
    buffer_load_dwordx4 v3, s[4:7], 0 offen nt lds
    s_add_u32 m0, s24, 16928
    s_nop 0
    buffer_load_dwordx4 v3, s[4:7], 0 offen offset:1024 nt lds
    s_add_u32 s4, s4, 8192
    s_addc_u32 s5, s5, 0
    s_sub_u32 s20, s20, 8192
    s_max_i32 s6, s20, 0
L_shallow:
    s_add_u32 s48, s36, 21760
    s_mov_b32 s54, 0xff800000
    s_cmp_ge_u32 s37, 143360
    s_cmov_b32 s54, 0x71800000
    s_mov_b32 s55, 0xff800000
    s_cmp_ge_u32 s38, 143360
    s_cmov_b32 s55, 0x71800000
    s_mov_b32 s40, s12
    s_mov_b32 s41, s13
    s_mov_b32 s42, s16
    s_mov_b32 s43, s17
    s_sub_u32 s23, s36, 1088
    s_sub_u32 s32, s37, 3072
    s_add_u32 s34, s37, 20480
    s_min_u32 s18, s34, 159744
    s_mov_b32 s28, 0
    s_mov_b32 s30, 0x3e0293ee
    s_mov_b32 s31, 0x3e0293ee
    s_mov_b32 s29, 0xffff0000
    s_mov_b32 s39, 0x44800000
    s_mov_b32 s3, 0xc20c0000
    v_and_b32 v11, 15, v0
    v_lshrrev_b32 v12, 4, v0
    v_lshlrev_b32 v9, 4, v12
    v_and_b32 v13, 7, v0
    v_mul_u32_u24 v13, 1056, v13
    v_lshrrev_b32 v16, 3, v11
    v_lshl_add_u32 v13, v16, 8, v13
    v_add_u32 v13, 92416, v13
    v_add_u32 v1, v13, v9
    v_lshrrev_b32 v14, 2, v11
    v_and_b32 v15, 3, v0
    v_mul_u32_u24 v13, 1040, v14
    v_lshl_add_u32 v13, v12, 7, v13
    v_bfe_u32 v17, v0, 1, 1
    v_lshl_add_u32 v13, v17, 6, v13
    v_and_b32 v17, 1, v0
    v_lshl_add_u32 v13, v17, 3, v13
    v_add_u32 v2, 126208, v13
    v_mul_u32_u24 v13, 1088, v15
    v_lshl_add_u32 v13, v14, 8, v13
    v_add3_u32 v5, v13, v9, s36
    v_mul_u32_u24 v13, 272, v12
    v_and_b32 v17, 16, v0
    v_add3_u32 v13, v13, v17, s36
    v_lshl_add_u32 v6, v11, 3, v13
    v_lshl_add_u32 v13, v15, 6, v13
    v_lshl_add_u32 v7, v14, 3, v13
    v_and_b32 v17, 1, v0
    v_lshlrev_b32 v17, 4, v17
    v_cmp_gt_u32 vcc, 2, v15
    v_mov_b32 v13, 0x3e03
    v_lshlrev_b32 v13, v17, v13
    v_cndmask_b32 v16, 0, v13, vcc
    v_accvgpr_write_b32 a232, v16
    v_sub_u32 v16, v13, v16
    v_accvgpr_write_b32 a233, v16
    v_mov_b32 v13, 0xb9d8
    v_lshlrev_b32 v13, v17, v13
    v_cndmask_b32 v16, 0, v13, vcc
    v_accvgpr_write_b32 a234, v16
    v_sub_u32 v16, v13, v16
    v_accvgpr_write_b32 a235, v16
    v_cmp_gt_u32 vcc, 2, v11
    v_mov_b32 v13, 0x3f803f80
    v_mov_b32 v10, 0x44444444
    v_cndmask_b32 v14, 0, v13, vcc
    v_cmp_eq_u32 vcc, 1, v11
    v_mov_b32 v13, 0xeeeeeeee
    v_accvgpr_write_b32 a228, v14
    v_accvgpr_write_b32 a229, v14
    v_accvgpr_write_b32 a230, v14
    v_accvgpr_write_b32 a231, v14
    v_cndmask_b32 v10, v10, v13, vcc
    v_accvgpr_write_b32 a208, 0
    v_accvgpr_write_b32 a209, 0
    v_accvgpr_write_b32 a210, 0
    v_accvgpr_write_b32 a211, 0
    v_accvgpr_write_b32 a212, 0
    v_accvgpr_write_b32 a213, 0
    v_accvgpr_write_b32 a214, 0
    v_accvgpr_write_b32 a215, 0
    v_accvgpr_write_b32 a216, 0
    v_accvgpr_write_b32 a217, 0
    v_accvgpr_write_b32 a218, 0
    v_accvgpr_write_b32 a219, 0
    v_accvgpr_write_b32 a220, 0
    v_accvgpr_write_b32 a221, 0
    v_accvgpr_write_b32 a222, 0
    v_accvgpr_write_b32 a223, 0
    v_accvgpr_write_b32 a224, 0
    v_accvgpr_write_b32 a225, 0
    v_accvgpr_write_b32 a226, 0
    v_accvgpr_write_b32 a227, 0
    s_add_u32 s34, s36, 22848
    v_add_u32 v9, s34, v9
    v_lshl_add_u32 v8, v0, 2, s34
    v_accvgpr_write_b32 a252, v6
    v_accvgpr_write_b32 a253, v7
    v_accvgpr_write_b32 a254, v8
    v_accvgpr_write_b32 a255, v9
    s_mov_b32 s58, 0x7f800000
    s_mov_b32 s59, 0x31400000
    s_cmp_eq_u32 s27, 0
    s_cbranch_scc1 L_start_b
    s_mov_b64 exec, 0
    s_cmp_eq_u32 s33, 1
    s_cbranch_scc1 L_pad2
    s_cmp_eq_u32 s33, 2
    s_cbranch_scc1 L_pad3
    s_cmp_eq_u32 s33, 3
    s_cbranch_scc1 L_pad4
    s_branch L_pad1
L_warmed:
    s_mov_b64 exec, -1
    s_cmp_eq_u32 s27, 0
    s_cbranch_scc1 L_warmed_b
L_start:
    s_waitcnt vmcnt(6)
    ds_read_b128 a[0:3], v5 offset:0
    s_add_u32 m0, s25, 8320
    s_barrier
    buffer_load_dwordx4 v4, s[8:11], 0 offen nt lds
    s_add_u32 m0, s25, 8336
    ds_read_b128 a[4:7], v5 offset:64
    buffer_load_dwordx4 v4, s[8:11], 0 offen offset:1024 nt lds
    s_add_u32 s8, s8, 8320
    s_addc_u32 s9, s9, 0
    s_sub_u32 s21, s21, 8320
    s_max_i32 s10, s21, 0
    ds_read_b128 v[148:151], v1 offset:0
    s_add_u32 m0, s36, 4352
    s_nop 0
    buffer_load_dwordx4 v3, s[12:15], s22 offen offset:0 nt lds
    ds_read_b128 a[8:11], v5 offset:128
    s_add_u32 m0, s36, 4416
    s_nop 0
    buffer_load_dwordx4 v3, s[12:15], s22 offen offset:1024 nt lds
    s_add_u32 m0, s36, 4480
    s_waitcnt lgkmcnt(3)
    v_mfma_f32_4x4x4_16b_bf16 v[184:187], a[232:233], a[2:3], 0
    ds_read_b128 v[164:167], v1 offset:512
    v_mfma_f32_4x4x4_16b_bf16 v[180:183], a[232:233], a[0:1], 0
    v_mfma_f32_4x4x4_16b_bf16 v[184:187], a[234:235], a[2:3], v[184:187]
    ds_read_b128 v[176:179], v1 offset:704
    v_mfma_f32_4x4x4_16b_bf16 v[180:183], a[234:235], a[0:1], v[180:183]
    s_waitcnt lgkmcnt(4)
    v_mfma_f32_4x4x4_16b_bf16 v[236:239], a[232:233], a[4:5], 0
    ds_read_b128 a[12:15], v5 offset:192
    v_cvt_pk_bf16_f32 v184, v184, v185
    v_accvgpr_write_b32 a2, v184
    v_cvt_pk_bf16_f32 v185, v186, v187
    v_mfma_f32_4x4x4_16b_bf16 v[236:239], a[234:235], a[4:5], v[236:239]
    v_cvt_pk_bf16_f32 v180, v180, v181
    v_cvt_pk_bf16_f32 v181, v182, v183
    v_accvgpr_write_b32 a3, v185
    v_accvgpr_write_b32 a0, v180
    v_accvgpr_write_b32 a1, v181
    v_mfma_f32_4x4x4_16b_bf16 v[180:183], a[232:233], a[6:7], 0
    s_waitcnt lgkmcnt(3)
    v_mfma_f32_4x4x4_16b_bf16 v[184:187], a[232:233], a[8:9], 0
    buffer_load_dwordx4 v3, s[12:15], s22 offen offset:2048 nt lds
    ds_read_b128 v[160:163], v1 offset:192
    s_add_u32 m0, s36, 4544
    v_mfma_f32_4x4x4_16b_bf16 v[184:187], a[234:235], a[8:9], v[184:187]
    ds_read_b128 v[172:175], v1 offset:640
    v_mfma_f32_4x4x4_16b_bf16 v[180:183], a[234:235], a[6:7], v[180:183]
    buffer_load_dwordx4 v3, s[12:15], s22 offen offset:3072 nt lds
    ds_read_b128 v[152:155], v1 offset:64
    v_cvt_pk_bf16_f32 v236, v236, v237
    v_accvgpr_write_b32 a4, v236
    v_cvt_pk_bf16_f32 v237, v238, v239
    v_accvgpr_write_b32 a5, v237
    v_mfma_f32_4x4x4_16b_bf16 v[236:239], a[232:233], a[10:11], 0
    s_add_u32 s22, s22, 4096
    ds_read_b128 v[168:171], v1 offset:576
    v_mfma_f32_4x4x4_16b_bf16 v[236:239], a[234:235], a[10:11], v[236:239]
    v_cvt_pk_bf16_f32 v180, v180, v181
    v_cvt_pk_bf16_f32 v181, v182, v183
    v_accvgpr_write_b32 a7, v181
    v_accvgpr_write_b32 a6, v180
    s_waitcnt lgkmcnt(4)
    v_mfma_f32_4x4x4_16b_bf16 v[180:183], a[232:233], a[12:13], 0
    ds_read_b128 v[156:159], v1 offset:128
    v_cvt_pk_bf16_f32 v184, v184, v185
    v_cvt_pk_bf16_f32 v185, v186, v187
    v_mfma_f32_4x4x4_16b_bf16 v[180:183], a[234:235], a[12:13], v[180:183]
    v_accvgpr_write_b32 a8, v184
    v_accvgpr_write_b32 a9, v185
    v_mfma_f32_4x4x4_16b_bf16 v[184:187], a[232:233], a[14:15], 0
    v_cvt_pk_bf16_f32 v236, v236, v237
    v_cvt_pk_bf16_f32 v237, v238, v239
    v_mfma_f32_4x4x4_16b_bf16 v[184:187], a[234:235], a[14:15], v[184:187]
    v_cvt_pk_bf16_f32 v180, v180, v181
    v_cvt_pk_bf16_f32 v181, v182, v183
    v_accvgpr_write_b32 a11, v237
    v_accvgpr_write_b32 a13, v181
    v_accvgpr_write_b32 a12, v180
    v_accvgpr_write_b32 a10, v236
    v_cvt_pk_bf16_f32 v184, v184, v185
    v_accvgpr_write_b32 a14, v184
    v_cvt_pk_bf16_f32 v185, v186, v187
    v_accvgpr_write_b32 a15, v185
    s_waitcnt vmcnt(8)
    s_barrier
    ds_read_b128 a[128:131], v1 offset:8960
    v_mfma_f32_16x16x32_bf16 v[12:15], v[148:151], a[0:3], 0
    ds_read_b128 a[120:123], v1 offset:8576
    s_waitcnt lgkmcnt(4)
    v_mfma_f32_16x16x32_bf16 v[12:15], v[152:155], a[4:7], v[12:15]
    ds_read_b128 a[124:127], v1 offset:8640
    s_waitcnt lgkmcnt(3)
    v_mfma_f32_16x16x32_bf16 v[12:15], v[156:159], a[8:11], v[12:15]
    s_add_u32 m0, s36, 8704
    ds_read_b128 a[116:119], v1 offset:8512
    v_mfma_f32_16x16x32_bf16 v[12:15], v[160:163], a[12:15], v[12:15]
    buffer_load_dwordx4 v3, s[12:15], s22 offen offset:0 nt lds
    ds_read_b64_tr_b16 v[214:215], v2 offset:4176
    ds_read_b64_tr_b16 a[206:207], v2 offset:4720
    v_mfma_f32_16x16x32_bf16 v[16:19], v[176:179], a[12:15], 0
    ds_read_b64_tr_b16 a[188:189], v2 offset:4176
    ds_read_b64_tr_b16 a[196:197], v2 offset:4192
    v_mfma_f32_16x16x32_bf16 v[16:19], v[172:175], a[8:11], v[16:19]
    ds_read_b64_tr_b16 a[180:181], v2 offset:4160
    ds_read_b128 a[132:135], v1 offset:9024
    v_mfma_f32_16x16x32_bf16 v[16:19], v[168:171], a[4:7], v[16:19]
    ds_read_b128 a[140:143], v1 offset:9152
    v_max3_f32 v11, v12, v13, v14
    v_mfma_f32_16x16x32_bf16 v[16:19], v[164:167], a[0:3], v[16:19]
    s_add_u32 m0, s36, 8768
    ds_read_b64_tr_b16 a[182:183], v2 offset:4672
    buffer_load_dwordx4 v3, s[12:15], s22 offen offset:1024 nt lds
    s_add_u32 m0, s36, 8832
    ds_read_b64_tr_b16 v[216:217], v2 offset:4192
    ds_read_b64_tr_b16 v[212:213], v2 offset:4160
    buffer_load_dwordx4 v3, s[12:15], s22 offen offset:2048 nt lds
    ds_read_b128 a[136:139], v1 offset:9088
    v_max3_f32 v11, v11, v18, v19
    v_max3_f32 v0, v15, v16, v17
    v_max_f32 v11, v11, v0
    v_mov_b32 v0, v11
    s_add_u32 m0, s36, 8896
    s_nop 0
    buffer_load_dwordx4 v3, s[12:15], s22 offen offset:3072 nt lds
    ds_read_b128 a[112:115], v1 offset:8448
    v_permlane32_swap_b32 v11, v0
    v_max_f32 v11, v11, v0
    v_mov_b32 v0, v11
    s_nop 1
    v_permlane16_swap_b32 v11, v0
    v_max_f32 v11, v11, v0
    v_sub_f32 v238, s3, v11
    v_sub_f32 v237, s3, v11
    v_sub_f32 v236, s3, v11
    v_pk_add_f32 v[16:17], v[16:17], v[236:237]
    v_pk_add_f32 v[18:19], v[18:19], v[236:237]
    v_pk_add_f32 v[14:15], v[14:15], v[236:237]
    v_exp_f32 v15, v15
    v_sub_f32 v239, s3, v11
    v_pk_add_f32 v[12:13], v[12:13], v[236:237]
    v_exp_f32 v16, v16
    v_exp_f32 v13, v13
    s_waitcnt lgkmcnt(0)
    v_mfma_f32_16x16x32_bf16 v[228:231], a[112:115], a[0:3], v[236:239]
    v_exp_f32 v17, v17
    v_mfma_f32_16x16x32_bf16 v[228:231], a[116:119], a[4:7], v[228:231]
    v_exp_f32 v14, v14
    v_mfma_f32_16x16x32_bf16 v[228:231], a[120:123], a[8:11], v[228:231]
    v_exp_f32 v19, v19
    v_mfma_f32_16x16x32_bf16 v[228:231], a[124:127], a[12:15], v[228:231]
    ds_read_b64_tr_b16 v[218:219], v2 offset:4208
    v_cvt_pk_bf16_f32 v182, v16, v17
    v_exp_f32 v12, v12
    v_exp_f32 v18, v18
    v_mfma_f32_16x16x32_bf16 v[232:235], a[140:143], a[12:15], v[236:239]
    ds_read_b64_tr_b16 a[204:205], v2 offset:4208
    ds_read_b64_tr_b16 a[198:199], v2 offset:4704
    v_mfma_f32_16x16x32_bf16 v[232:235], a[136:139], a[8:11], v[232:235]
    v_cvt_pk_bf16_f32 v180, v12, v13
    v_cvt_pk_bf16_f32 v181, v14, v15
    v_mfma_f32_16x16x32_bf16 v[232:235], a[132:135], a[4:7], v[232:235]
    s_add_u32 s22, s22, 4096
    ds_read_b64_tr_b16 a[190:191], v2 offset:4688
    v_cvt_pk_bf16_f32 v183, v18, v19
    v_mfma_f32_16x16x32_bf16 v[232:235], a[128:131], a[0:3], v[232:235]
    s_waitcnt vmcnt(8)
    s_barrier
    ds_read_b64_tr_b16 v[208:209], v2 offset:8352
    s_add_u32 m0, s36, 13056
    ds_read_b64_tr_b16 v[210:211], v2 offset:8368
    buffer_load_dwordx4 v3, s[12:15], s22 offen offset:0 nt lds
    ds_read_b64_tr_b16 v[204:205], v2 offset:8320
    s_add_u32 m0, s36, 13120
    ds_read_b64_tr_b16 v[206:207], v2 offset:8336
    ds_read_b64_tr_b16 a[146:147], v2 offset:8832
    buffer_load_dwordx4 v3, s[12:15], s22 offen offset:1024 nt lds
    ds_read_b64_tr_b16 a[156:157], v2 offset:12496
    ds_read_b128 a[84:87], v1 offset:16960
    v_max_f32 v212, abs(v212), abs(v213)
    v_max_f32 v216, abs(v216), abs(v217)
    v_max_f32 v214, abs(v214), abs(v215)
    s_add_u32 m0, s36, 13184
    ds_read_b64_tr_b16 a[160:161], v2 offset:8352
    ds_read_b64_tr_b16 a[172:173], v2 offset:12528
    ds_read_b128 a[88:91], v1 offset:17024
    s_waitcnt lgkmcnt(9)
    v_max_f32 v208, abs(v208), abs(v209)
    ds_read_b64_tr_b16 a[170:171], v2 offset:8880
    ds_read_b128 a[92:95], v1 offset:17088
    s_waitcnt lgkmcnt(8)
    v_max_f32 v206, abs(v206), abs(v207)
    v_max_f32 v210, abs(v210), abs(v211)
    v_max_f32 v204, abs(v204), abs(v205)
    v_max_f32 v218, abs(v218), abs(v219)
    v_min3_f32 v204, v204, v206, v208
    ds_read_b64_tr_b16 a[168:169], v2 offset:8368
    ds_read_b64_tr_b16 a[162:163], v2 offset:8864
    ds_read_b128 a[96:99], v1 offset:17408
    v_min3_f32 v204, v204, v216, v218
    v_min3_f32 v210, v210, v212, v214
    v_min_f32 v204, v204, v210
    v_and_b32 v204, s58, v204
    v_mov_b32 v205, v204
    ds_read_b128 a[104:107], v1 offset:17536
    buffer_load_dwordx4 v3, s[12:15], s22 offen offset:2048 nt lds
    ds_read_b128 a[80:83], v1 offset:16896
    v_permlane32_swap_b32 v204, v205
    v_max_f32 v204, v204, v205
    v_mov_b32 v205, v204
    s_add_u32 m0, s36, 13248
    s_nop 0
    buffer_load_dwordx4 v3, s[12:15], s22 offen offset:3072 nt lds
    ds_read_b64_tr_b16 a[148:149], v2 offset:12480
    ds_read_b64_tr_b16 a[154:155], v2 offset:8848
    ds_read_b128 a[108:111], v1 offset:17600
    v_permlane16_swap_b32 v204, v205
    v_max_f32 v204, v204, v205
    v_mul_f32 v8, s59, v204
    v_mul_f32 v7, s59, v204
    v_mul_f32 v6, s59, v204
    v_mul_f32 v9, s59, v204
    ds_read_b64_tr_b16 a[164:165], v2 offset:12512
    ds_read_b64_tr_b16 a[166:167], v2 offset:13024
    v_mfma_f32_16x16x32_bf16 v[48:51], v[180:183], a[204:207], v[6:9]
    s_add_u32 s22, s22, 4096
    ds_read_b64_tr_b16 a[152:153], v2 offset:8336
    ds_read_b64_tr_b16 a[144:145], v2 offset:8320
    v_mfma_f32_16x16x32_bf16 v[40:43], v[180:183], a[188:191], v[6:9]
    ds_read_b64_tr_b16 a[174:175], v2 offset:13040
    ds_read_b64_tr_b16 a[158:159], v2 offset:13008
    v_mfma_f32_16x16x32_bf16 v[44:47], v[180:183], a[196:199], v[6:9]
    ds_read_b64_tr_b16 a[150:151], v2 offset:12992
    ds_read_b128 a[100:103], v1 offset:17472
    v_mfma_f32_16x16x32_bf16 v[36:39], v[180:183], a[180:183], v[6:9]
    s_waitcnt vmcnt(8)
    ds_read_b128 a[16:19], v5 offset:4352
    s_waitcnt lgkmcnt(9)
    v_mfma_f32_16x16x32_bf16 v[224:227], a[108:111], a[12:15], v[236:239]
    s_add_u32 m0, s36, 17408
    v_exp_f32 v235, v235
    v_mfma_f32_16x16x32_bf16 v[224:227], a[104:107], a[8:11], v[224:227]
    ds_read_b128 a[20:23], v5 offset:4416
    v_exp_f32 v232, v232
    v_mfma_f32_16x16x32_bf16 v[220:223], a[80:83], a[0:3], v[236:239]
    v_exp_f32 v234, v234
    v_mfma_f32_16x16x32_bf16 v[220:223], a[84:87], a[4:7], v[220:223]
    ds_read_b128 a[28:31], v5 offset:4544
    v_exp_f32 v228, v228
    v_mfma_f32_16x16x32_bf16 v[220:223], a[88:91], a[8:11], v[220:223]
    v_exp_f32 v230, v230
    v_mfma_f32_16x16x32_bf16 v[220:223], a[92:95], a[12:15], v[220:223]
    v_exp_f32 v231, v231
    s_waitcnt lgkmcnt(2)
    v_mfma_f32_4x4x4_16b_bf16 v[192:195], a[232:233], a[18:19], 0
    ds_read_b128 a[24:27], v5 offset:4480
    v_mfma_f32_4x4x4_16b_bf16 v[188:191], a[232:233], a[16:17], 0
    buffer_load_dwordx4 v3, s[12:15], s22 offen offset:0 nt lds
    v_exp_f32 v233, v233
    v_mfma_f32_4x4x4_16b_bf16 v[188:191], a[234:235], a[16:17], v[188:191]
    s_waitcnt lgkmcnt(2)
    v_mfma_f32_4x4x4_16b_bf16 v[240:243], a[232:233], a[20:21], 0
    v_cvt_pk_bf16_f32 v186, v232, v233
    v_mfma_f32_4x4x4_16b_bf16 v[192:195], a[234:235], a[18:19], v[192:195]
    v_cvt_pk_bf16_f32 v187, v234, v235
    v_mfma_f32_4x4x4_16b_bf16 v[240:243], a[234:235], a[20:21], v[240:243]
    v_cvt_pk_bf16_f32 v188, v188, v189
    v_accvgpr_write_b32 a16, v188
    v_cvt_pk_bf16_f32 v189, v190, v191
    v_accvgpr_write_b32 a17, v189
    v_mfma_f32_4x4x4_16b_bf16 v[188:191], a[232:233], a[22:23], 0
    v_cvt_pk_bf16_f32 v192, v192, v193
    v_accvgpr_write_b32 a18, v192
    v_mfma_f32_4x4x4_16b_bf16 v[188:191], a[234:235], a[22:23], v[188:191]
    v_cvt_pk_bf16_f32 v193, v194, v195
    v_cvt_pk_bf16_f32 v240, v240, v241
    v_accvgpr_write_b32 a19, v193
    v_mfma_f32_16x16x32_bf16 v[224:227], a[100:103], a[4:7], v[224:227]
    s_nop 0
    v_cvt_pk_bf16_f32 v188, v188, v189
    v_cvt_pk_bf16_f32 v189, v190, v191
    s_waitcnt lgkmcnt(0)
    v_mfma_f32_4x4x4_16b_bf16 v[192:195], a[232:233], a[24:25], 0
    v_cvt_pk_bf16_f32 v241, v242, v243
    v_accvgpr_write_b32 a22, v188
    v_mfma_f32_4x4x4_16b_bf16 v[192:195], a[234:235], a[24:25], v[192:195]
    v_accvgpr_write_b32 a23, v189
    v_mfma_f32_4x4x4_16b_bf16 v[188:191], a[232:233], a[28:29], 0
    v_accvgpr_write_b32 a21, v241
    v_accvgpr_write_b32 a20, v240
    v_mfma_f32_4x4x4_16b_bf16 v[188:191], a[234:235], a[28:29], v[188:191]
    v_cvt_pk_bf16_f32 v185, v230, v231
    v_mfma_f32_4x4x4_16b_bf16 v[240:243], a[232:233], a[26:27], 0
    v_cvt_pk_bf16_f32 v192, v192, v193
    v_cvt_pk_bf16_f32 v193, v194, v195
    v_accvgpr_write_b32 a24, v192
    v_mfma_f32_4x4x4_16b_bf16 v[240:243], a[234:235], a[26:27], v[240:243]
    v_accvgpr_write_b32 a25, v193
    v_mfma_f32_4x4x4_16b_bf16 v[192:195], a[232:233], a[30:31], 0
    v_cvt_pk_bf16_f32 v188, v188, v189
    v_accvgpr_write_b32 a28, v188
    v_mfma_f32_4x4x4_16b_bf16 v[192:195], a[234:235], a[30:31], v[192:195]
    v_cvt_pk_bf16_f32 v240, v240, v241
    v_cvt_pk_bf16_f32 v241, v242, v243
    v_accvgpr_write_b32 a27, v241
    v_mfma_f32_16x16x32_bf16 v[224:227], a[96:99], a[0:3], v[224:227]
    s_nop 0
    v_cvt_pk_bf16_f32 v192, v192, v193
    v_cvt_pk_bf16_f32 v193, v194, v195
    v_accvgpr_write_b32 a31, v193
    v_mfma_f32_16x16x32_bf16 v[12:15], v[148:151], a[16:19], 0
    v_accvgpr_write_b32 a26, v240
    v_accvgpr_write_b32 a30, v192
    v_mfma_f32_16x16x32_bf16 v[12:15], v[152:155], a[20:23], v[12:15]
    v_cvt_pk_bf16_f32 v189, v190, v191
    v_accvgpr_write_b32 a29, v189
    v_mfma_f32_16x16x32_bf16 v[12:15], v[156:159], a[24:27], v[12:15]
    s_add_u32 m0, s36, 17472
    v_exp_f32 v226, v226
    v_mfma_f32_16x16x32_bf16 v[12:15], v[160:163], a[28:31], v[12:15]
    buffer_load_dwordx4 v3, s[12:15], s22 offen offset:1024 nt lds
    v_exp_f32 v220, v220
    v_mfma_f32_16x16x32_bf16 v[16:19], v[176:179], a[28:31], 0
    v_exp_f32 v227, v227
    v_mfma_f32_16x16x32_bf16 v[16:19], v[172:175], a[24:27], v[16:19]
    v_exp_f32 v229, v229
    v_mfma_f32_16x16x32_bf16 v[16:19], v[168:171], a[20:23], v[16:19]
    s_add_u32 m0, s36, 17536
    v_exp_f32 v223, v223
    v_mfma_f32_16x16x32_bf16 v[16:19], v[164:167], a[16:19], v[16:19]
    buffer_load_dwordx4 v3, s[12:15], s22 offen offset:2048 nt lds
    v_cvt_pk_bf16_f32 v184, v228, v229
    v_max3_f32 v11, v12, v13, v14
    v_mfma_f32_16x16x32_bf16 v[20:23], v[180:183], a[144:147], v[6:9]
    s_add_u32 m0, s36, 17600
    v_exp_f32 v224, v224
    v_mfma_f32_16x16x32_bf16 v[20:23], v[184:187], a[148:151], v[20:23]
    buffer_load_dwordx4 v3, s[12:15], s22 offen offset:3072 nt lds
    v_max3_f32 v0, v15, v16, v17
    v_max3_f32 v11, v11, v18, v19
    v_mfma_f32_16x16x32_bf16 v[24:27], v[184:187], a[156:159], v[6:9]
    v_max_f32 v11, v11, v0
    v_mov_b32 v0, v11
    v_mfma_f32_16x16x32_bf16 v[24:27], v[180:183], a[152:155], v[24:27]
    s_nop 0
    v_permlane32_swap_b32 v11, v0
    v_mfma_f32_16x16x32_bf16 v[32:35], v[184:187], a[172:175], v[6:9]
    v_max_f32 v11, v11, v0
    v_exp_f32 v221, v221
    v_mov_b32 v0, v11
    v_mfma_f32_16x16x32_bf16 v[28:31], v[180:183], a[160:163], v[6:9]
    s_add_u32 s22, s22, 4096
    v_permlane16_swap_b32 v11, v0
    v_mfma_f32_16x16x32_bf16 v[28:31], v[184:187], a[164:167], v[28:31]
    s_add_u32 s12, s12, 159744
    v_max_f32 v11, v11, v0
    v_sub_f32 v242, s3, v11
    v_sub_f32 v240, s3, v11
    v_sub_f32 v243, s3, v11
    v_sub_f32 v241, s3, v11
    v_pk_add_f32 v[18:19], v[18:19], v[240:241]
    v_pk_add_f32 v[12:13], v[12:13], v[240:241]
    v_pk_add_f32 v[16:17], v[16:17], v[240:241]
    v_pk_add_f32 v[14:15], v[14:15], v[240:241]
    v_mfma_f32_16x16x32_bf16 v[232:235], a[140:143], a[28:31], v[240:243]
    v_exp_f32 v17, v17
    v_mfma_f32_16x16x32_bf16 v[232:235], a[136:139], a[24:27], v[232:235]
    v_exp_f32 v12, v12
    v_mfma_f32_16x16x32_bf16 v[232:235], a[132:135], a[20:23], v[232:235]
    v_exp_f32 v15, v15
    v_mfma_f32_16x16x32_bf16 v[232:235], a[128:131], a[16:19], v[232:235]
    v_exp_f32 v18, v18
    v_mfma_f32_16x16x32_bf16 v[228:231], a[112:115], a[16:19], v[240:243]
    s_addc_u32 s13, s13, 0
    v_exp_f32 v14, v14
    v_mfma_f32_16x16x32_bf16 v[228:231], a[116:119], a[20:23], v[228:231]
    s_sub_u32 s22, s38, 1024
    v_exp_f32 v13, v13
    v_mfma_f32_16x16x32_bf16 v[228:231], a[120:123], a[24:27], v[228:231]
    s_add_u32 s34, s38, 20480
    v_exp_f32 v16, v16
    v_mfma_f32_16x16x32_bf16 v[228:231], a[124:127], a[28:31], v[228:231]
    v_exp_f32 v19, v19
    v_mfma_f32_16x16x32_bf16 v[32:35], v[180:183], a[168:171], v[32:35]
    s_min_u32 s14, s34, 159744
    v_cvt_pk_bf16_f32 v189, v14, v15
    v_cvt_pk_bf16_f32 v188, v12, v13
    v_cvt_pk_bf16_f32 v190, v16, v17
    v_cvt_pk_bf16_f32 v191, v18, v19
    v_smfmac_f32_16x16x64_bf16 a[208:211], a[228:231], v[180:187], v10
    v_exp_f32 v222, v222
    v_mfma_f32_16x16x32_bf16 v[80:83], v[188:191], a[204:207], v[6:9]
    v_exp_f32 v225, v225
    v_mfma_f32_16x16x32_bf16 v[72:75], v[188:191], a[188:191], v[6:9]
    v_cvt_pk_bf16_f32 v182, v224, v225
    v_cvt_pk_bf16_f32 v183, v226, v227
    v_mfma_f32_16x16x32_bf16 v[76:79], v[188:191], a[196:199], v[6:9]
    v_cvt_pk_bf16_f32 v181, v222, v223
    v_cvt_pk_bf16_f32 v180, v220, v221
    v_mfma_f32_16x16x32_bf16 v[68:71], v[188:191], a[180:183], v[6:9]
    s_waitcnt vmcnt(8)
    s_barrier
    ds_read_b128 a[32:35], v5 offset:8704
    v_mfma_f32_16x16x32_bf16 v[220:223], a[80:83], a[16:19], v[240:243]
    v_exp_f32 v230, v230
    v_mfma_f32_16x16x32_bf16 v[220:223], a[84:87], a[20:23], v[220:223]
    s_add_u32 m0, s24, 25344
    v_exp_f32 v235, v235
    v_mfma_f32_16x16x32_bf16 v[220:223], a[88:91], a[24:27], v[220:223]
    ds_read_b128 a[44:47], v5 offset:8896
    buffer_load_dwordx4 v3, s[4:7], 0 offen nt lds
    v_exp_f32 v233, v233
    v_mfma_f32_16x16x32_bf16 v[224:227], a[108:111], a[28:31], v[240:243]
    s_add_u32 m0, s24, 25376
    ds_read_b128 a[36:39], v5 offset:8768
    buffer_load_dwordx4 v3, s[4:7], 0 offen offset:1024 nt lds
    v_exp_f32 v234, v234
    v_mfma_f32_16x16x32_bf16 v[220:223], a[92:95], a[28:31], v[220:223]
    v_exp_f32 v231, v231
    s_waitcnt lgkmcnt(2)
    v_mfma_f32_4x4x4_16b_bf16 v[196:199], a[232:233], a[32:33], 0
    ds_read_b128 a[40:43], v5 offset:8832
    v_mfma_f32_4x4x4_16b_bf16 v[200:203], a[232:233], a[34:35], 0
    v_cvt_pk_bf16_f32 v195, v234, v235
    v_mfma_f32_4x4x4_16b_bf16 v[196:199], a[234:235], a[32:33], v[196:199]
    v_exp_f32 v229, v229
    v_mfma_f32_16x16x32_bf16 v[224:227], a[104:107], a[24:27], v[224:227]
    v_exp_f32 v228, v228
    v_mfma_f32_16x16x32_bf16 v[224:227], a[100:103], a[20:23], v[224:227]
    s_add_u32 s4, s4, 8192
    v_cvt_pk_bf16_f32 v196, v196, v197
    v_cvt_pk_bf16_f32 v197, v198, v199
    v_accvgpr_write_b32 a33, v197
    v_mfma_f32_4x4x4_16b_bf16 v[200:203], a[234:235], a[34:35], v[200:203]
    v_accvgpr_write_b32 a32, v196
    s_waitcnt lgkmcnt(1)
    v_mfma_f32_4x4x4_16b_bf16 v[196:199], a[232:233], a[38:39], 0
    v_cvt_pk_bf16_f32 v193, v230, v231
    v_mfma_f32_4x4x4_16b_bf16 v[244:247], a[232:233], a[36:37], 0
    v_cvt_pk_bf16_f32 v200, v200, v201
    v_cvt_pk_bf16_f32 v201, v202, v203
    v_mfma_f32_4x4x4_16b_bf16 v[244:247], a[234:235], a[36:37], v[244:247]
    v_accvgpr_write_b32 a34, v200
    v_mfma_f32_4x4x4_16b_bf16 v[196:199], a[234:235], a[38:39], v[196:199]
    v_accvgpr_write_b32 a35, v201
    s_waitcnt lgkmcnt(0)
    v_mfma_f32_4x4x4_16b_bf16 v[200:203], a[232:233], a[40:41], 0
    v_cvt_pk_bf16_f32 v244, v244, v245
    v_cvt_pk_bf16_f32 v245, v246, v247
    v_accvgpr_write_b32 a37, v245
    v_accvgpr_write_b32 a36, v244
    v_cvt_pk_bf16_f32 v196, v196, v197
    v_mfma_f32_4x4x4_16b_bf16 v[200:203], a[234:235], a[40:41], v[200:203]
    v_accvgpr_write_b32 a38, v196
    v_mfma_f32_4x4x4_16b_bf16 v[244:247], a[232:233], a[42:43], 0
    v_cvt_pk_bf16_f32 v197, v198, v199
    v_accvgpr_write_b32 a39, v197
    v_mfma_f32_4x4x4_16b_bf16 v[244:247], a[234:235], a[42:43], v[244:247]
    v_cvt_pk_bf16_f32 v200, v200, v201
    v_accvgpr_write_b32 a40, v200
    v_cvt_pk_bf16_f32 v201, v202, v203
    v_mfma_f32_4x4x4_16b_bf16 v[196:199], a[232:233], a[44:45], 0
    v_accvgpr_write_b32 a41, v201
    v_mfma_f32_4x4x4_16b_bf16 v[200:203], a[232:233], a[46:47], 0
    v_cvt_pk_bf16_f32 v244, v244, v245
    v_mfma_f32_4x4x4_16b_bf16 v[196:199], a[234:235], a[44:45], v[196:199]
    v_accvgpr_write_b32 a42, v244
    v_mfma_f32_4x4x4_16b_bf16 v[200:203], a[234:235], a[46:47], v[200:203]
    v_cvt_pk_bf16_f32 v245, v246, v247
    v_accvgpr_write_b32 a43, v245
    v_mfma_f32_16x16x32_bf16 v[60:63], v[188:191], a[160:163], v[6:9]
    s_addc_u32 s5, s5, 0
    v_cvt_pk_bf16_f32 v196, v196, v197
    v_accvgpr_write_b32 a44, v196
    v_mfma_f32_16x16x32_bf16 v[12:15], v[148:151], a[32:35], 0
    v_cvt_pk_bf16_f32 v200, v200, v201
    v_accvgpr_write_b32 a46, v200
    v_mfma_f32_16x16x32_bf16 v[224:227], a[96:99], a[16:19], v[224:227]
    s_sub_u32 s20, s20, 8192
    v_cvt_pk_bf16_f32 v201, v202, v203
    v_accvgpr_write_b32 a47, v201
    v_mfma_f32_16x16x32_bf16 v[12:15], v[152:155], a[36:39], v[12:15]
    v_cvt_pk_bf16_f32 v197, v198, v199
    v_accvgpr_write_b32 a45, v197
    v_mfma_f32_16x16x32_bf16 v[12:15], v[156:159], a[40:43], v[12:15]
    v_exp_f32 v232, v232
    v_mfma_f32_16x16x32_bf16 v[12:15], v[160:163], a[44:47], v[12:15]
    v_cvt_pk_bf16_f32 v192, v228, v229
    v_cvt_pk_bf16_f32 v194, v232, v233
    v_mfma_f32_16x16x32_bf16 v[16:19], v[176:179], a[44:47], 0
    v_exp_f32 v224, v224
    v_mfma_f32_16x16x32_bf16 v[16:19], v[172:175], a[40:43], v[16:19]
    s_max_i32 s6, s20, 0
    v_exp_f32 v223, v223
    v_mfma_f32_16x16x32_bf16 v[16:19], v[168:171], a[36:39], v[16:19]
    s_add_u32 m0, s25, 16640
    v_exp_f32 v227, v227
    v_mfma_f32_16x16x32_bf16 v[16:19], v[164:167], a[32:35], v[16:19]
    buffer_load_dwordx4 v4, s[8:11], 0 offen nt lds
    v_exp_f32 v226, v226
    v_mfma_f32_16x16x32_bf16 v[64:67], v[192:195], a[172:175], v[6:9]
    v_exp_f32 v222, v222
    v_mfma_f32_16x16x32_bf16 v[64:67], v[188:191], a[168:171], v[64:67]
    s_add_u32 m0, s25, 16656
    v_max3_f32 v11, v12, v13, v14
    v_exp_f32 v221, v221
    v_max3_f32 v11, v11, v18, v19
    v_max3_f32 v0, v15, v16, v17
    v_max_f32 v11, v11, v0
    v_mov_b32 v0, v11
    v_mfma_f32_16x16x32_bf16 v[56:59], v[192:195], a[156:159], v[6:9]
    s_nop 0
    v_permlane32_swap_b32 v11, v0
    v_mfma_f32_16x16x32_bf16 v[56:59], v[188:191], a[152:155], v[56:59]
    v_max_f32 v11, v11, v0
    v_mov_b32 v0, v11
    v_mfma_f32_16x16x32_bf16 v[52:55], v[188:191], a[144:147], v[6:9]
    s_nop 0
    v_permlane16_swap_b32 v11, v0
    v_mfma_f32_16x16x32_bf16 v[52:55], v[192:195], a[148:151], v[52:55]
    v_max_f32 v11, v11, v0
    v_sub_f32 v245, s3, v11
    v_sub_f32 v244, s3, v11
    v_sub_f32 v247, s3, v11
    v_sub_f32 v246, s3, v11
    v_pk_add_f32 v[14:15], v[14:15], v[244:245]
    v_exp_f32 v15, v15
    v_pk_add_f32 v[12:13], v[12:13], v[244:245]
    v_pk_add_f32 v[16:17], v[16:17], v[244:245]
    v_pk_add_f32 v[18:19], v[18:19], v[244:245]
    v_mfma_f32_16x16x32_bf16 v[228:231], a[112:115], a[32:35], v[244:247]
    v_exp_f32 v14, v14
    v_mfma_f32_16x16x32_bf16 v[228:231], a[116:119], a[36:39], v[228:231]
    v_exp_f32 v13, v13
    v_mfma_f32_16x16x32_bf16 v[228:231], a[120:123], a[40:43], v[228:231]
    v_exp_f32 v19, v19
    v_mfma_f32_16x16x32_bf16 v[228:231], a[124:127], a[44:47], v[228:231]
    buffer_load_dwordx4 v4, s[8:11], 0 offen offset:1024 nt lds
    v_exp_f32 v18, v18
    v_smfmac_f32_16x16x64_bf16 a[212:215], a[228:231], v[188:195], v10
    v_exp_f32 v16, v16
    v_mfma_f32_16x16x32_bf16 v[232:235], a[140:143], a[44:47], v[244:247]
    s_add_u32 s8, s8, 8064
    v_exp_f32 v12, v12
    v_mfma_f32_16x16x32_bf16 v[232:235], a[136:139], a[40:43], v[232:235]
    v_exp_f32 v17, v17
    v_mfma_f32_16x16x32_bf16 v[232:235], a[132:135], a[36:39], v[232:235]
    s_addc_u32 s9, s9, 0
    v_cvt_pk_bf16_f32 v197, v14, v15
    v_cvt_pk_bf16_f32 v199, v18, v19
    v_mfma_f32_16x16x32_bf16 v[232:235], a[128:131], a[32:35], v[232:235]
    s_sub_u32 s21, s21, 8064
    v_cvt_pk_bf16_f32 v196, v12, v13
    v_cvt_pk_bf16_f32 v198, v16, v17
    v_mfma_f32_16x16x32_bf16 v[60:63], v[192:195], a[164:167], v[60:63]
L_pad1:
    s_cbranch_execz L_warmed
    v_cvt_pk_bf16_f32 v189, v222, v223
    v_cvt_pk_bf16_f32 v191, v226, v227
    v_mfma_f32_16x16x32_bf16 v[100:103], v[196:199], a[180:183], v[6:9]
    v_exp_f32 v225, v225
    v_mfma_f32_16x16x32_bf16 v[112:115], v[196:199], a[204:207], v[6:9]
    s_max_i32 s10, s21, 0
    v_exp_f32 v220, v220
    v_mfma_f32_16x16x32_bf16 v[108:111], v[196:199], a[196:199], v[6:9]
    v_cvt_pk_bf16_f32 v190, v224, v225
    v_cvt_pk_bf16_f32 v188, v220, v221
    v_mfma_f32_16x16x32_bf16 v[104:107], v[196:199], a[188:191], v[6:9]
    s_waitcnt vmcnt(8)
    ds_read_b128 a[48:51], v5 offset:13056
    v_exp_f32 v229, v229
    v_mfma_f32_16x16x32_bf16 v[220:223], a[80:83], a[32:35], v[244:247]
    v_exp_f32 v232, v232
    v_mfma_f32_16x16x32_bf16 v[220:223], a[84:87], a[36:39], v[220:223]
    ds_read_b128 a[52:55], v5 offset:13120
    v_exp_f32 v228, v228
    v_mfma_f32_16x16x32_bf16 v[224:227], a[108:111], a[44:47], v[244:247]
    s_add_u32 m0, s24, 0
    v_exp_f32 v233, v233
    v_mfma_f32_16x16x32_bf16 v[224:227], a[104:107], a[40:43], v[224:227]
    v_exp_f32 v230, v230
    v_mfma_f32_16x16x32_bf16 v[224:227], a[100:103], a[36:39], v[224:227]
    v_exp_f32 v234, v234
    v_mfma_f32_16x16x32_bf16 v[224:227], a[96:99], a[32:35], v[224:227]
    buffer_load_dwordx4 v3, s[4:7], 0 offen nt lds
    s_add_u32 m0, s24, 32
    s_waitcnt lgkmcnt(1)
    v_mfma_f32_4x4x4_16b_bf16 v[208:211], a[232:233], a[50:51], 0
    ds_read_b128 a[56:59], v5 offset:13184
    v_mfma_f32_4x4x4_16b_bf16 v[204:207], a[232:233], a[48:49], 0
    v_cvt_pk_bf16_f32 v202, v232, v233
    v_mfma_f32_4x4x4_16b_bf16 v[208:211], a[234:235], a[50:51], v[208:211]
    s_waitcnt lgkmcnt(1)
    v_mfma_f32_4x4x4_16b_bf16 v[248:251], a[232:233], a[52:53], 0
    ds_read_b128 a[60:63], v5 offset:13248
    v_mfma_f32_4x4x4_16b_bf16 v[204:207], a[234:235], a[48:49], v[204:207]
    v_exp_f32 v226, v226
    v_exp_f32 v225, v225
    v_cvt_pk_bf16_f32 v208, v208, v209
    v_cvt_pk_bf16_f32 v209, v210, v211
    v_mfma_f32_4x4x4_16b_bf16 v[248:251], a[234:235], a[52:53], v[248:251]
    v_cvt_pk_bf16_f32 v204, v204, v205
    v_accvgpr_write_b32 a48, v204
    v_cvt_pk_bf16_f32 v205, v206, v207
    v_accvgpr_write_b32 a49, v205
    v_cvt_pk_bf16_f32 v200, v228, v229
    v_mfma_f32_4x4x4_16b_bf16 v[204:207], a[232:233], a[54:55], 0
    v_cvt_pk_bf16_f32 v248, v248, v249
    v_cvt_pk_bf16_f32 v249, v250, v251
    v_accvgpr_write_b32 a50, v208
    v_accvgpr_write_b32 a51, v209
    v_mfma_f32_4x4x4_16b_bf16 v[204:207], a[234:235], a[54:55], v[204:207]
    s_waitcnt lgkmcnt(1)
    v_mfma_f32_4x4x4_16b_bf16 v[208:211], a[232:233], a[56:57], 0
    v_accvgpr_write_b32 a53, v249
    v_accvgpr_write_b32 a52, v248
    v_mfma_f32_4x4x4_16b_bf16 v[248:251], a[232:233], a[58:59], 0
    v_cvt_pk_bf16_f32 v204, v204, v205
    v_mfma_f32_4x4x4_16b_bf16 v[208:211], a[234:235], a[56:57], v[208:211]
    v_cvt_pk_bf16_f32 v205, v206, v207
    v_accvgpr_write_b32 a55, v205
    v_mfma_f32_16x16x32_bf16 v[220:223], a[88:91], a[40:43], v[220:223]
    buffer_load_dwordx4 v3, s[4:7], 0 offen offset:1024 nt lds
    v_accvgpr_write_b32 a54, v204
    s_waitcnt lgkmcnt(0)
    v_mfma_f32_4x4x4_16b_bf16 v[204:207], a[232:233], a[60:61], 0
    v_cvt_pk_bf16_f32 v208, v208, v209
    v_mfma_f32_4x4x4_16b_bf16 v[248:251], a[234:235], a[58:59], v[248:251]
    v_cvt_pk_bf16_f32 v209, v210, v211
    v_accvgpr_write_b32 a57, v209
    v_mfma_f32_4x4x4_16b_bf16 v[204:207], a[234:235], a[60:61], v[204:207]
    v_accvgpr_write_b32 a56, v208
    v_mfma_f32_4x4x4_16b_bf16 v[208:211], a[232:233], a[62:63], 0
    v_cvt_pk_bf16_f32 v248, v248, v249
    v_accvgpr_write_b32 a58, v248
    v_cvt_pk_bf16_f32 v249, v250, v251
    v_mfma_f32_4x4x4_16b_bf16 v[208:211], a[234:235], a[62:63], v[208:211]
    v_accvgpr_write_b32 a59, v249
    v_cvt_pk_bf16_f32 v204, v204, v205
    v_cvt_pk_bf16_f32 v205, v206, v207
    v_mfma_f32_16x16x32_bf16 v[220:223], a[92:95], a[44:47], v[220:223]
    s_nop 0
    v_cvt_pk_bf16_f32 v208, v208, v209
    v_accvgpr_write_b32 a61, v205
    v_mfma_f32_16x16x32_bf16 v[12:15], v[148:151], a[48:51], 0
    v_accvgpr_write_b32 a62, v208
    v_accvgpr_write_b32 a60, v204
    v_mfma_f32_16x16x32_bf16 v[12:15], v[152:155], a[52:55], v[12:15]
    v_cvt_pk_bf16_f32 v209, v210, v211
    v_accvgpr_write_b32 a63, v209
    v_mfma_f32_16x16x32_bf16 v[12:15], v[156:159], a[56:59], v[12:15]
    v_exp_f32 v227, v227
    v_mfma_f32_16x16x32_bf16 v[12:15], v[160:163], a[60:63], v[12:15]
    v_exp_f32 v235, v235
    v_mfma_f32_16x16x32_bf16 v[16:19], v[176:179], a[60:63], 0
    v_exp_f32 v231, v231
    v_mfma_f32_16x16x32_bf16 v[16:19], v[172:175], a[56:59], v[16:19]
    v_exp_f32 v220, v220
    v_mfma_f32_16x16x32_bf16 v[16:19], v[168:171], a[52:55], v[16:19]
    s_add_u32 s4, s4, 8192
    v_cvt_pk_bf16_f32 v201, v230, v231
    v_cvt_pk_bf16_f32 v203, v234, v235
    v_mfma_f32_16x16x32_bf16 v[16:19], v[164:167], a[48:51], v[16:19]
    s_addc_u32 s5, s5, 0
    v_exp_f32 v221, v221
    v_mfma_f32_16x16x32_bf16 v[96:99], v[200:203], a[172:175], v[6:9]
    s_sub_u32 s20, s20, 8192
    v_exp_f32 v222, v222
    v_mfma_f32_16x16x32_bf16 v[96:99], v[196:199], a[168:171], v[96:99]
    s_max_i32 s6, s20, 0
    v_max3_f32 v11, v12, v13, v14
    v_max3_f32 v0, v15, v16, v17
    v_mfma_f32_16x16x32_bf16 v[88:91], v[200:203], a[156:159], v[6:9]
    s_add_u32 m0, s25, 24960
    v_max3_f32 v11, v11, v18, v19
    v_max_f32 v11, v11, v0
    v_mov_b32 v0, v11
    v_smfmac_f32_16x16x64_bf16 a[216:219], a[228:231], v[196:203], v10
    buffer_load_dwordx4 v4, s[8:11], 0 offen nt lds
    v_permlane32_swap_b32 v11, v0
    v_mfma_f32_16x16x32_bf16 v[92:95], v[196:199], a[160:163], v[6:9]
    s_add_u32 m0, s25, 24976
    v_max_f32 v11, v11, v0
    v_mov_b32 v0, v11
    v_mfma_f32_16x16x32_bf16 v[92:95], v[200:203], a[164:167], v[92:95]
    s_nop 0
    v_permlane16_swap_b32 v11, v0
    v_mfma_f32_16x16x32_bf16 v[84:87], v[196:199], a[144:147], v[6:9]
    buffer_load_dwordx4 v4, s[8:11], 0 offen offset:1024 nt lds
    v_max_f32 v11, v11, v0
    v_sub_f32 v250, s3, v11
    v_sub_f32 v248, s3, v11
    v_sub_f32 v249, s3, v11
    v_pk_add_f32 v[14:15], v[14:15], v[248:249]
    v_pk_add_f32 v[16:17], v[16:17], v[248:249]
    v_pk_add_f32 v[12:13], v[12:13], v[248:249]
    v_exp_f32 v12, v12
    v_pk_add_f32 v[18:19], v[18:19], v[248:249]
    v_mfma_f32_16x16x32_bf16 v[88:91], v[196:199], a[152:155], v[88:91]
    s_add_u32 s8, s8, 8320
    v_exp_f32 v19, v19
    v_sub_f32 v251, s3, v11
    v_mfma_f32_16x16x32_bf16 v[84:87], v[200:203], a[148:151], v[84:87]
    v_exp_f32 v18, v18
    v_mfma_f32_16x16x32_bf16 v[232:235], a[140:143], a[60:63], v[248:251]
    v_exp_f32 v13, v13
    v_mfma_f32_16x16x32_bf16 v[232:235], a[136:139], a[56:59], v[232:235]
    v_exp_f32 v15, v15
    v_mfma_f32_16x16x32_bf16 v[232:235], a[132:135], a[52:55], v[232:235]
    s_addc_u32 s9, s9, 0
    v_exp_f32 v17, v17
    v_mfma_f32_16x16x32_bf16 v[232:235], a[128:131], a[48:51], v[232:235]
    v_exp_f32 v14, v14
    v_mfma_f32_16x16x32_bf16 v[228:231], a[112:115], a[48:51], v[248:251]
    v_cvt_pk_bf16_f32 v205, v14, v15
    v_cvt_pk_bf16_f32 v204, v12, v13
    v_mfma_f32_16x16x32_bf16 v[228:231], a[116:119], a[52:55], v[228:231]
    s_sub_u32 s21, s21, 8320
    v_exp_f32 v16, v16
    v_mfma_f32_16x16x32_bf16 v[228:231], a[120:123], a[56:59], v[228:231]
    v_cvt_pk_bf16_f32 v207, v18, v19
    v_cvt_pk_bf16_f32 v206, v16, v17
    v_mfma_f32_16x16x32_bf16 v[228:231], a[124:127], a[60:63], v[228:231]
    s_max_i32 s10, s21, 0
    v_exp_f32 v224, v224
    v_mfma_f32_16x16x32_bf16 v[140:143], v[204:207], a[196:199], v[6:9]
    s_add_u32 s22, s22, 1024
    v_exp_f32 v223, v223
    v_mfma_f32_16x16x32_bf16 v[144:147], v[204:207], a[204:207], v[6:9]
    s_add_u32 s23, s23, 1088
    v_cvt_pk_bf16_f32 v199, v226, v227
    v_cvt_pk_bf16_f32 v197, v222, v223
    v_mfma_f32_16x16x32_bf16 v[136:139], v[204:207], a[188:191], v[6:9]
    v_cvt_pk_bf16_f32 v198, v224, v225
    v_cvt_pk_bf16_f32 v196, v220, v221
    v_mfma_f32_16x16x32_bf16 v[132:135], v[204:207], a[180:183], v[6:9]
    s_waitcnt vmcnt(8)
    ds_read_b128 a[64:67], v5 offset:17408
    v_exp_f32 v230, v230
    v_mfma_f32_16x16x32_bf16 v[220:223], a[80:83], a[48:51], v[248:251]
    v_exp_f32 v233, v233
    v_mfma_f32_16x16x32_bf16 v[220:223], a[84:87], a[52:55], v[220:223]
    s_min_u32 m0, s23, s48
    v_exp_f32 v229, v229
    v_mfma_f32_16x16x32_bf16 v[224:227], a[108:111], a[60:63], v[248:251]
    ds_read_b128 a[68:71], v5 offset:17472
    v_exp_f32 v234, v234
    v_mfma_f32_16x16x32_bf16 v[220:223], a[88:91], a[56:59], v[220:223]
    v_exp_f32 v231, v231
    v_mfma_f32_16x16x32_bf16 v[220:223], a[92:95], a[60:63], v[220:223]
    buffer_load_dwordx4 v3, s[12:15], s22 offen nt lds
    ds_read_b128 a[76:79], v5 offset:17600
    v_cvt_pk_bf16_f32 v209, v230, v231
    v_mfma_f32_16x16x32_bf16 v[124:127], v[204:207], a[160:163], v[6:9]
    s_add_u32 m0, s24, 8448
    v_exp_f32 v235, v235
    s_waitcnt lgkmcnt(2)
    v_mfma_f32_4x4x4_16b_bf16 v[212:215], a[232:233], a[64:65], 0
    v_exp_f32 v232, v232
    v_mfma_f32_16x16x32_bf16 v[116:119], v[204:207], a[144:147], v[6:9]
    ds_read_b128 a[72:75], v5 offset:17536
    buffer_load_dwordx4 v3, s[4:7], 0 offen nt lds
    v_exp_f32 v222, v222
    v_mfma_f32_4x4x4_16b_bf16 v[216:219], a[232:233], a[66:67], 0
    v_exp_f32 v228, v228
    v_mfma_f32_4x4x4_16b_bf16 v[212:215], a[234:235], a[64:65], v[212:215]
    v_cvt_pk_bf16_f32 v208, v228, v229
    v_mfma_f32_4x4x4_16b_bf16 v[216:219], a[234:235], a[66:67], v[216:219]
    v_cvt_pk_bf16_f32 v210, v232, v233
    s_waitcnt lgkmcnt(2)
    v_mfma_f32_4x4x4_16b_bf16 v[252:255], a[232:233], a[68:69], 0
    v_cvt_pk_bf16_f32 v212, v212, v213
    v_cvt_pk_bf16_f32 v213, v214, v215
    v_accvgpr_write_b32 a65, v213
    v_mfma_f32_4x4x4_16b_bf16 v[252:255], a[234:235], a[68:69], v[252:255]
    v_accvgpr_write_b32 a64, v212
    v_mfma_f32_4x4x4_16b_bf16 v[212:215], a[232:233], a[70:71], 0
    v_cvt_pk_bf16_f32 v216, v216, v217
    v_accvgpr_write_b32 a66, v216
    v_mfma_f32_4x4x4_16b_bf16 v[212:215], a[234:235], a[70:71], v[212:215]
    v_cvt_pk_bf16_f32 v217, v218, v219
    v_cvt_pk_bf16_f32 v252, v252, v253
    v_mfma_f32_16x16x32_bf16 v[224:227], a[104:107], a[56:59], v[224:227]
    v_cvt_pk_bf16_f32 v253, v254, v255
    v_accvgpr_write_b32 a69, v253
    v_mfma_f32_16x16x32_bf16 v[224:227], a[100:103], a[52:55], v[224:227]
    s_add_u32 m0, s24, 8480
    v_cvt_pk_bf16_f32 v212, v212, v213
    v_accvgpr_write_b32 a67, v217
    s_waitcnt lgkmcnt(0)
    v_mfma_f32_4x4x4_16b_bf16 v[216:219], a[232:233], a[72:73], 0
    buffer_load_dwordx4 v3, s[4:7], 0 offen offset:1024 nt lds
    v_cvt_pk_bf16_f32 v213, v214, v215
    v_accvgpr_write_b32 a71, v213
    v_mfma_f32_4x4x4_16b_bf16 v[216:219], a[234:235], a[72:73], v[216:219]
    v_accvgpr_write_b32 a70, v212
    v_mfma_f32_4x4x4_16b_bf16 v[212:215], a[232:233], a[76:77], 0
    v_accvgpr_write_b32 a68, v252
    v_mfma_f32_4x4x4_16b_bf16 v[252:255], a[232:233], a[74:75], 0
    v_cvt_pk_bf16_f32 v211, v234, v235
    v_mfma_f32_4x4x4_16b_bf16 v[212:215], a[234:235], a[76:77], v[212:215]
    v_cvt_pk_bf16_f32 v216, v216, v217
    v_accvgpr_write_b32 a72, v216
    v_mfma_f32_4x4x4_16b_bf16 v[252:255], a[234:235], a[74:75], v[252:255]
    v_cvt_pk_bf16_f32 v217, v218, v219
    v_accvgpr_write_b32 a73, v217
    v_mfma_f32_4x4x4_16b_bf16 v[216:219], a[232:233], a[78:79], 0
    v_cvt_pk_bf16_f32 v212, v212, v213
    v_accvgpr_write_b32 a76, v212
    v_mfma_f32_4x4x4_16b_bf16 v[216:219], a[234:235], a[78:79], v[216:219]
    v_cvt_pk_bf16_f32 v213, v214, v215
    v_cvt_pk_bf16_f32 v252, v252, v253
    v_cvt_pk_bf16_f32 v253, v254, v255
    v_accvgpr_write_b32 a74, v252
    v_mfma_f32_16x16x32_bf16 v[224:227], a[96:99], a[48:51], v[224:227]
    v_accvgpr_write_b32 a75, v253
    v_cvt_pk_bf16_f32 v216, v216, v217
    v_mfma_f32_16x16x32_bf16 v[12:15], v[148:151], a[64:67], 0
    v_cvt_pk_bf16_f32 v217, v218, v219
    v_accvgpr_write_b32 a78, v216
    v_mfma_f32_16x16x32_bf16 v[12:15], v[152:155], a[68:71], v[12:15]
    v_accvgpr_write_b32 a77, v213
    v_accvgpr_write_b32 a79, v217
    v_mfma_f32_16x16x32_bf16 v[12:15], v[156:159], a[72:75], v[12:15]
    v_exp_f32 v221, v221
    v_mfma_f32_16x16x32_bf16 v[12:15], v[160:163], a[76:79], v[12:15]
    v_exp_f32 v220, v220
    v_mfma_f32_16x16x32_bf16 v[16:19], v[176:179], a[76:79], 0
    v_exp_f32 v224, v224
    v_mfma_f32_16x16x32_bf16 v[16:19], v[172:175], a[72:75], v[16:19]
    s_add_u32 s4, s4, 8192
    v_exp_f32 v225, v225
    v_mfma_f32_16x16x32_bf16 v[16:19], v[168:171], a[68:71], v[16:19]
    s_addc_u32 s5, s5, 0
    v_exp_f32 v227, v227
    v_mfma_f32_16x16x32_bf16 v[16:19], v[164:167], a[64:67], v[16:19]
    s_sub_u32 s20, s20, 8192
    v_exp_f32 v226, v226
    v_smfmac_f32_16x16x64_bf16 a[220:223], a[228:231], v[204:211], v10
    s_max_i32 s6, s20, 0
    v_exp_f32 v223, v223
    v_max3_f32 v11, v12, v13, v14
    v_mfma_f32_16x16x32_bf16 v[124:127], v[208:211], a[164:167], v[124:127]
    s_nop 0
    v_max3_f32 v11, v11, v18, v19
    v_max3_f32 v0, v15, v16, v17
    v_mfma_f32_16x16x32_bf16 v[120:123], v[208:211], a[156:159], v[6:9]
    v_max_f32 v11, v11, v0
    v_mov_b32 v0, v11
    v_mfma_f32_16x16x32_bf16 v[120:123], v[204:207], a[152:155], v[120:123]
    s_nop 0
    v_permlane32_swap_b32 v11, v0
    v_mfma_f32_16x16x32_bf16 v[128:131], v[208:211], a[172:175], v[6:9]
    s_add_u32 m0, s25, 0
    v_max_f32 v11, v11, v0
    v_mov_b32 v0, v11
    v_mfma_f32_16x16x32_bf16 v[128:131], v[204:207], a[168:171], v[128:131]
    s_nop 0
    v_permlane16_swap_b32 v11, v0
    v_max3_f32 v11, v11, v0, s54
    v_sub_f32 v254, s3, v11
    v_sub_f32 v253, s3, v11
    v_sub_f32 v252, s3, v11
    v_pk_add_f32 v[18:19], v[18:19], v[252:253]
    v_sub_f32 v255, s3, v11
    v_pk_add_f32 v[16:17], v[16:17], v[252:253]
    v_exp_f32 v16, v16
    v_pk_add_f32 v[14:15], v[14:15], v[252:253]
    v_exp_f32 v14, v14
    v_pk_add_f32 v[12:13], v[12:13], v[252:253]
    v_mfma_f32_16x16x32_bf16 v[116:119], v[208:211], a[148:151], v[116:119]
    v_exp_f32 v19, v19
    v_mfma_f32_16x16x32_bf16 v[232:235], a[140:143], a[76:79], v[252:255]
    v_exp_f32 v18, v18
    v_mfma_f32_16x16x32_bf16 v[232:235], a[136:139], a[72:75], v[232:235]
    v_exp_f32 v17, v17
    v_mfma_f32_16x16x32_bf16 v[232:235], a[132:135], a[68:71], v[232:235]
    v_exp_f32 v15, v15
    v_mfma_f32_16x16x32_bf16 v[232:235], a[128:131], a[64:67], v[232:235]
    buffer_load_dwordx4 v4, s[8:11], 0 offen nt lds
    v_exp_f32 v13, v13
    v_mfma_f32_16x16x32_bf16 v[228:231], a[112:115], a[64:67], v[252:255]
    v_exp_f32 v12, v12
    v_mfma_f32_16x16x32_bf16 v[228:231], a[116:119], a[68:71], v[228:231]
    v_cvt_pk_bf16_f32 v213, v14, v15
    v_cvt_pk_bf16_f32 v214, v16, v17
    v_mfma_f32_16x16x32_bf16 v[228:231], a[120:123], a[72:75], v[228:231]
    v_cvt_pk_bf16_f32 v212, v12, v13
    v_cvt_pk_bf16_f32 v215, v18, v19
    v_mfma_f32_16x16x32_bf16 v[228:231], a[124:127], a[76:79], v[228:231]
    s_waitcnt vmcnt(8)
    s_barrier
    ds_read_b128 a[128:131], v1 offset:25856
    v_cvt_pk_bf16_f32 v207, v226, v227
    v_mfma_f32_16x16x32_bf16 v[172:175], v[212:215], a[196:199], v[6:9]
    s_add_u32 m0, s25, 16
    ds_read_b128 a[132:135], v1 offset:25920
    buffer_load_dwordx4 v4, s[8:11], 0 offen offset:1024 nt lds
    s_add_u32 s8, s8, 8064
    ds_read_b128 a[124:127], v1 offset:25536
    v_mfma_f32_16x16x32_bf16 v[168:171], v[212:215], a[188:191], v[6:9]
    s_addc_u32 s9, s9, 0
    ds_read_b64_tr_b16 a[192:193], v2 offset:16672
    v_cvt_pk_bf16_f32 v206, v224, v225
    v_mfma_f32_16x16x32_bf16 v[164:167], v[212:215], a[180:183], v[6:9]
    s_sub_u32 s21, s21, 8064
    ds_read_b64_tr_b16 a[178:179], v2 offset:17152
    ds_read_b64_tr_b16 a[198:199], v2 offset:21344
    v_accvgpr_write_b32 a232, v6
    v_mfma_f32_16x16x32_bf16 v[224:227], a[108:111], a[76:79], v[252:255]
    s_max_i32 s10, s21, 0
    v_exp_f32 v235, v235
    v_mfma_f32_16x16x32_bf16 v[224:227], a[104:107], a[72:75], v[224:227]
    s_add_u32 s22, s22, 1024
    ds_read_b128 a[116:119], v1 offset:25408
    v_exp_f32 v231, v231
    v_exp_f32 v233, v233
    v_cvt_pk_bf16_f32 v204, v220, v221
    v_cvt_pk_bf16_f32 v205, v222, v223
    v_mfma_f32_16x16x32_bf16 v[220:223], a[80:83], a[64:67], v[252:255]
    s_add_u32 s23, s23, 1088
    v_exp_f32 v234, v234
    v_mfma_f32_16x16x32_bf16 v[220:223], a[84:87], a[68:71], v[220:223]
    s_min_u32 m0, s23, s48
    ds_read_b64_tr_b16 a[200:201], v2 offset:16688
    ds_read_b128 a[120:123], v1 offset:25472
    buffer_load_dwordx4 v3, s[12:15], s22 offen nt lds
    v_exp_f32 v230, v230
    v_mfma_f32_16x16x32_bf16 v[156:159], v[212:215], a[160:163], v[6:9]
    s_add_u32 m0, s24, 16896
    ds_read_b64_tr_b16 a[194:195], v2 offset:17184
    buffer_load_dwordx4 v3, s[4:7], 0 offen nt lds
    v_exp_f32 v232, v232
    v_mfma_f32_16x16x32_bf16 v[224:227], a[100:103], a[68:71], v[224:227]
    s_mov_b64 vcc, 64
    ds_read_b64_tr_b16 a[186:187], v2 offset:17168
    v_cvt_pk_bf16_f32 v219, v234, v235
    v_mfma_f32_16x16x32_bf16 v[224:227], a[96:99], a[64:67], v[224:227]
    s_add_u32 m0, s24, 16928
    ds_read_b128 a[136:139], v1 offset:25984
    buffer_load_dwordx4 v3, s[4:7], 0 offen offset:1024 nt lds
    v_exp_f32 v228, v228
    v_exp_f32 v229, v229
    v_mfma_f32_16x16x32_bf16 v[220:223], a[88:91], a[72:75], v[220:223]
    s_add_u32 s4, s4, 8192
    ds_read_b128 a[140:143], v1 offset:26048
    v_cvt_pk_bf16_f32 v216, v228, v229
    v_mfma_f32_16x16x32_bf16 v[220:223], a[92:95], a[76:79], v[220:223]
    s_addc_u32 s5, s5, 0
    ds_read_b128 a[112:115], v1 offset:25344
    v_cvt_pk_bf16_f32 v218, v232, v233
    v_cvt_pk_bf16_f32 v217, v230, v231
    v_mfma_f32_16x16x32_bf16 v[148:151], v[212:215], a[144:147], v[6:9]
    s_sub_u32 s20, s20, 8192
    ds_read_b64_tr_b16 a[182:183], v2 offset:21312
    ds_read_b64_tr_b16 a[202:203], v2 offset:17200
    v_mfma_f32_16x16x32_bf16 v[152:155], v[216:219], a[156:159], v[6:9]
    s_max_i32 s6, s20, 0
    ds_read_b64_tr_b16 a[196:197], v2 offset:20832
    s_add_u32 m0, s25, 8320
    v_mfma_f32_16x16x32_bf16 v[176:179], v[212:215], a[204:207], v[6:9]
    s_mov_b32 s26, -19584
    ds_read_b64_tr_b16 a[176:177], v2 offset:16640
    ds_read_b64_tr_b16 a[188:189], v2 offset:20816
    buffer_load_dwordx4 v4, s[8:11], 0 offen nt lds
    ds_read_b64_tr_b16 a[204:205], v2 offset:20848
    ds_read_b64_tr_b16 a[180:181], v2 offset:20800
    v_mfma_f32_16x16x32_bf16 v[160:163], v[216:219], a[172:175], v[6:9]
    s_add_u32 m0, s25, 8336
    ds_read_b64_tr_b16 a[184:185], v2 offset:16656
    buffer_load_dwordx4 v4, s[8:11], 0 offen offset:1024 nt lds
    ds_read_b64_tr_b16 a[206:207], v2 offset:21360
    ds_read_b64_tr_b16 a[190:191], v2 offset:21328
    v_mfma_f32_16x16x32_bf16 v[152:155], v[212:215], a[152:155], v[152:155]
    s_add_u32 s8, s8, 8320
    v_accvgpr_read_b32 v6, a252
    v_accvgpr_read_b32 v7, a253
    v_mfma_f32_16x16x32_bf16 v[156:159], v[216:219], a[164:167], v[156:159]
    s_addc_u32 s9, s9, 0
    s_sub_u32 s21, s21, 8320
    s_max_i32 s10, s21, 0
    v_mfma_f32_16x16x32_bf16 v[148:151], v[216:219], a[148:151], v[148:151]
    s_add_u32 s22, s22, 1024
    v_accvgpr_read_b32 v9, a255
    s_add_u32 s23, s23, 1088
    v_accvgpr_read_b32 v8, a254
    s_min_u32 m0, s23, s48
    v_mfma_f32_16x16x32_bf16 v[160:163], v[212:215], a[168:171], v[160:163]
    s_add_u32 s34, s36, 19584
    buffer_load_dwordx4 v3, s[12:15], s22 offen nt lds
    v_lshrrev_b32 v0, 0, v3
    v_add_u32 v0, s34, v0
    v_smfmac_f32_16x16x64_bf16 a[224:227], a[228:231], v[212:219], v10
    s_waitcnt vmcnt(11)
    s_waitcnt lgkmcnt(0)
    s_barrier
L_started:
L_pad0:
    s_cbranch_execz L_warmed
    s_cmp_gt_i32 s54, 0
    s_cbranch_scc1 L_loop0_1
.p2align 3
L_loop0_0:
    v_mfma_f32_16x16x32_bf16 v[48:51], v[184:187], a[200:203], v[48:51]
    v_exp_f32 v224, v224
    v_mfma_f32_16x16x32_bf16 v[48:51], v[180:183], a[204:207], v[48:51]
    s_add_u32 m0, s24, 25344
    ds_read_b128 a[80:83], v1 offset:0
    v_lshlrev_b32 v11, 16, v12
    v_mfma_f32_16x16x32_bf16 v[44:47], v[180:183], a[196:199], v[44:47]
    v_exp_f32 v225, v225
    v_mfma_f32_16x16x32_bf16 v[44:47], v[184:187], a[192:195], v[44:47]
    buffer_load_dwordx4 v3, s[4:7], 0 offen nt lds
    v_mfma_f32_16x16x32_bf16 v[40:43], v[184:187], a[184:187], v[40:43]
    v_exp_f32 v226, v226
    v_mfma_f32_16x16x32_bf16 v[40:43], v[180:183], a[188:191], v[40:43]
    ds_read_b64_tr_b16 a[144:145], v2 offset:24960
    v_and_b32 v12, s29, v12
    v_mfma_f32_16x16x32_bf16 v[36:39], v[180:183], a[180:183], v[36:39]
    v_exp_f32 v227, v227
    v_mfma_f32_16x16x32_bf16 v[36:39], v[184:187], a[176:179], v[36:39]
    ds_read_b128 a[84:87], v1 offset:64
    v_mul_f32 v11, s30, v11
    v_mfma_f32_16x16x32_bf16 v[228:231], a[112:115], a[0:3], v[236:239]
    v_cvt_pk_bf16_f32 v214, v224, v225
    v_cvt_pk_bf16_f32 v215, v226, v227
    v_mfma_f32_16x16x32_bf16 v[228:231], a[116:119], a[4:7], v[228:231]
    v_exp_f32 v220, v220
    v_mfma_f32_16x16x32_bf16 v[228:231], a[120:123], a[8:11], v[228:231]
    v_exp_f32 v221, v221
    v_mfma_f32_16x16x32_bf16 v[228:231], a[124:127], a[12:15], v[228:231]
    ds_read_b64_tr_b16 a[146:147], v2 offset:25472
    v_mul_f32 v12, s30, v12
    v_mfma_f32_16x16x32_bf16 v[232:235], a[140:143], a[12:15], v[236:239]
    v_exp_f32 v222, v222
    v_mfma_f32_16x16x32_bf16 v[232:235], a[136:139], a[8:11], v[232:235]
    v_exp_f32 v223, v223
    v_mfma_f32_16x16x32_bf16 v[232:235], a[132:135], a[4:7], v[232:235]
    v_cvt_pk_bf16_f32 v212, v220, v221
    v_cvt_pk_bf16_f32 v213, v222, v223
    v_mfma_f32_16x16x32_bf16 v[232:235], a[128:131], a[0:3], v[232:235]
    ds_read_b64_tr_b16 a[148:149], v2 offset:29120
    ds_read_b64_tr_b16 a[150:151], v2 offset:29632
    v_mfma_f32_16x16x32_bf16 v[224:227], a[128:131], a[16:19], v[240:243]
    v_exp_f32 v228, v228
    v_mfma_f32_16x16x32_bf16 v[224:227], a[132:135], a[20:23], v[224:227]
    s_add_u32 m0, s24, 25376
    v_exp_f32 v229, v229
    v_mfma_f32_16x16x32_bf16 v[224:227], a[136:139], a[24:27], v[224:227]
    v_exp_f32 v230, v230
    v_mfma_f32_16x16x32_bf16 v[224:227], a[140:143], a[28:31], v[224:227]
    buffer_load_dwordx4 v3, s[4:7], 0 offen offset:1024 nt lds
    v_mfma_f32_16x16x32_bf16 v[220:223], a[124:127], a[28:31], v[240:243]
    s_add_u32 s4, s4, 8192
    v_exp_f32 v231, v231
    v_mfma_f32_16x16x32_bf16 v[220:223], a[120:123], a[24:27], v[220:223]
    s_addc_u32 s5, s5, 0
    v_cvt_pk_bf16_f32 v184, v228, v229
    v_cvt_pk_bf16_f32 v185, v230, v231
    v_mfma_f32_16x16x32_bf16 v[220:223], a[116:119], a[20:23], v[220:223]
    s_sub_u32 s20, s20, 8192
    v_exp_f32 v232, v232
    v_mfma_f32_16x16x32_bf16 v[220:223], a[112:115], a[16:19], v[220:223]
    s_max_i32 s6, s20, 0
    ds_read_b128 a[88:91], v1 offset:128
    v_cvt_pk_bf16_f32 v12, v11, v12
    v_mfma_f32_16x16x32_bf16 v[68:71], v[192:195], a[176:179], v[68:71]
    v_exp_f32 v233, v233
    v_mfma_f32_16x16x32_bf16 v[68:71], v[188:191], a[180:183], v[68:71]
    ds_read_b64_tr_b16 a[152:153], v2 offset:24976
    v_lshlrev_b32 v11, 16, v13
    v_mfma_f32_16x16x32_bf16 v[72:75], v[188:191], a[188:191], v[72:75]
    v_exp_f32 v234, v234
    v_mfma_f32_16x16x32_bf16 v[72:75], v[192:195], a[184:187], v[72:75]
    ds_read_b128 a[92:95], v1 offset:192
    v_and_b32 v13, s29, v13
    v_mfma_f32_16x16x32_bf16 v[76:79], v[192:195], a[192:195], v[76:79]
    v_exp_f32 v235, v235
    v_mfma_f32_16x16x32_bf16 v[76:79], v[188:191], a[196:199], v[76:79]
    ds_read_b64_tr_b16 a[154:155], v2 offset:25488
    v_mul_f32 v11, s30, v11
    v_mfma_f32_16x16x32_bf16 v[80:83], v[188:191], a[204:207], v[80:83]
    v_cvt_pk_bf16_f32 v186, v232, v233
    v_cvt_pk_bf16_f32 v187, v234, v235
    v_mfma_f32_16x16x32_bf16 v[80:83], v[192:195], a[200:203], v[80:83]
    ds_read_b64_tr_b16 a[156:157], v2 offset:29136
    ds_read_b64_tr_b16 a[158:159], v2 offset:29648
    v_mfma_f32_16x16x32_bf16 v[112:115], v[200:203], a[200:203], v[112:115]
    v_exp_f32 v224, v224
    v_mfma_f32_16x16x32_bf16 v[112:115], v[196:199], a[204:207], v[112:115]
    s_add_u32 m0, s25, 16640
    ds_read_b128 a[96:99], v1 offset:512
    v_mul_f32 v13, s30, v13
    v_mfma_f32_16x16x32_bf16 v[108:111], v[196:199], a[196:199], v[108:111]
    v_exp_f32 v225, v225
    v_mfma_f32_16x16x32_bf16 v[108:111], v[200:203], a[192:195], v[108:111]
    buffer_load_dwordx4 v4, s[8:11], 0 offen nt lds
    v_mfma_f32_16x16x32_bf16 v[104:107], v[200:203], a[184:187], v[104:107]
    v_exp_f32 v226, v226
    v_mfma_f32_16x16x32_bf16 v[104:107], v[196:199], a[188:191], v[104:107]
    ds_read_b64_tr_b16 a[160:161], v2 offset:24992
    v_cvt_pk_bf16_f32 v13, v11, v13
    v_mfma_f32_16x16x32_bf16 v[100:103], v[196:199], a[180:183], v[100:103]
    v_exp_f32 v227, v227
    v_mfma_f32_16x16x32_bf16 v[100:103], v[200:203], a[176:179], v[100:103]
    ds_read_b128 a[100:103], v1 offset:576
    v_lshlrev_b32 v11, 16, v14
    v_mfma_f32_16x16x32_bf16 v[228:231], a[112:115], a[32:35], v[244:247]
    v_cvt_pk_bf16_f32 v194, v224, v225
    v_cvt_pk_bf16_f32 v195, v226, v227
    v_mfma_f32_16x16x32_bf16 v[228:231], a[116:119], a[36:39], v[228:231]
    v_exp_f32 v220, v220
    v_mfma_f32_16x16x32_bf16 v[228:231], a[120:123], a[40:43], v[228:231]
    v_exp_f32 v221, v221
    v_mfma_f32_16x16x32_bf16 v[228:231], a[124:127], a[44:47], v[228:231]
    ds_read_b64_tr_b16 a[162:163], v2 offset:25504
    v_and_b32 v14, s29, v14
    v_mfma_f32_16x16x32_bf16 v[232:235], a[140:143], a[44:47], v[244:247]
    v_exp_f32 v222, v222
    v_mfma_f32_16x16x32_bf16 v[232:235], a[136:139], a[40:43], v[232:235]
    v_exp_f32 v223, v223
    v_mfma_f32_16x16x32_bf16 v[232:235], a[132:135], a[36:39], v[232:235]
    v_cvt_pk_bf16_f32 v192, v220, v221
    v_cvt_pk_bf16_f32 v193, v222, v223
    v_mfma_f32_16x16x32_bf16 v[232:235], a[128:131], a[32:35], v[232:235]
    ds_read_b64_tr_b16 a[164:165], v2 offset:29152
    ds_read_b64_tr_b16 a[166:167], v2 offset:29664
    v_mfma_f32_16x16x32_bf16 v[224:227], a[128:131], a[48:51], v[248:251]
    v_exp_f32 v228, v228
    v_mfma_f32_16x16x32_bf16 v[224:227], a[132:135], a[52:55], v[224:227]
    s_add_u32 m0, s25, 16656
    v_exp_f32 v229, v229
    v_mfma_f32_16x16x32_bf16 v[224:227], a[136:139], a[56:59], v[224:227]
    v_exp_f32 v230, v230
    v_mfma_f32_16x16x32_bf16 v[224:227], a[140:143], a[60:63], v[224:227]
    buffer_load_dwordx4 v4, s[8:11], 0 offen offset:1024 nt lds
    v_mfma_f32_16x16x32_bf16 v[220:223], a[124:127], a[60:63], v[248:251]
    s_add_u32 s8, s8, 8064
    v_exp_f32 v231, v231
    v_mfma_f32_16x16x32_bf16 v[220:223], a[120:123], a[56:59], v[220:223]
    s_addc_u32 s9, s9, 0
    v_cvt_pk_bf16_f32 v200, v228, v229
    v_cvt_pk_bf16_f32 v201, v230, v231
    v_mfma_f32_16x16x32_bf16 v[220:223], a[116:119], a[52:55], v[220:223]
    s_sub_u32 s21, s21, 8064
    v_exp_f32 v232, v232
    v_mfma_f32_16x16x32_bf16 v[220:223], a[112:115], a[48:51], v[220:223]
    s_max_i32 s10, s21, 0
    ds_read_b128 a[104:107], v1 offset:640
    v_mul_f32 v11, s30, v11
    v_mfma_f32_16x16x32_bf16 v[132:135], v[208:211], a[176:179], v[132:135]
    v_exp_f32 v233, v233
    v_mfma_f32_16x16x32_bf16 v[132:135], v[204:207], a[180:183], v[132:135]
    ds_read_b64_tr_b16 a[168:169], v2 offset:25008
    v_mul_f32 v14, s30, v14
    v_mfma_f32_16x16x32_bf16 v[136:139], v[204:207], a[188:191], v[136:139]
L_pad2:
    s_cbranch_execz L_pad5
    v_exp_f32 v234, v234
    v_mfma_f32_16x16x32_bf16 v[136:139], v[208:211], a[184:187], v[136:139]
    ds_read_b128 a[108:111], v1 offset:704
    v_cvt_pk_bf16_f32 v14, v11, v14
    v_mfma_f32_16x16x32_bf16 v[140:143], v[208:211], a[192:195], v[140:143]
    v_exp_f32 v235, v235
    v_mfma_f32_16x16x32_bf16 v[140:143], v[204:207], a[196:199], v[140:143]
    ds_read_b64_tr_b16 a[170:171], v2 offset:25520
    v_lshlrev_b32 v11, 16, v15
    v_mfma_f32_16x16x32_bf16 v[144:147], v[204:207], a[204:207], v[144:147]
    v_cvt_pk_bf16_f32 v202, v232, v233
    v_cvt_pk_bf16_f32 v203, v234, v235
    v_mfma_f32_16x16x32_bf16 v[144:147], v[208:211], a[200:203], v[144:147]
    ds_read_b64_tr_b16 a[172:173], v2 offset:29168
    ds_read_b64_tr_b16 a[174:175], v2 offset:29680
    v_mfma_f32_16x16x32_bf16 v[176:179], v[216:219], a[200:203], v[176:179]
    v_exp_f32 v224, v224
    v_mfma_f32_16x16x32_bf16 v[176:179], v[212:215], a[204:207], v[176:179]
    v_and_b32 v15, s29, v15
    v_mul_f32 v11, s30, v11
    v_mfma_f32_16x16x32_bf16 v[172:175], v[212:215], a[196:199], v[172:175]
    v_exp_f32 v225, v225
    v_mfma_f32_16x16x32_bf16 v[172:175], v[216:219], a[192:195], v[172:175]
    v_mul_f32 v15, s30, v15
    v_cvt_pk_bf16_f32 v15, v11, v15
    v_mfma_f32_16x16x32_bf16 v[168:171], v[216:219], a[184:187], v[168:171]
    v_exp_f32 v226, v226
    v_mfma_f32_16x16x32_bf16 v[168:171], v[212:215], a[188:191], v[168:171]
    v_mfma_f32_16x16x32_bf16 v[164:167], v[212:215], a[180:183], v[164:167]
    v_exp_f32 v227, v227
    v_mfma_f32_16x16x32_bf16 v[164:167], v[216:219], a[176:179], v[164:167]
    ds_write_b64 v0, v[12:13] offset:2176
    v_mfma_f32_16x16x32_bf16 v[228:231], a[112:115], a[64:67], v[252:255]
    v_cvt_pk_bf16_f32 v210, v224, v225
    v_cvt_pk_bf16_f32 v211, v226, v227
    v_mfma_f32_16x16x32_bf16 v[228:231], a[116:119], a[68:71], v[228:231]
    v_exp_f32 v220, v220
    v_mfma_f32_16x16x32_bf16 v[228:231], a[120:123], a[72:75], v[228:231]
    s_waitcnt vmcnt(10) lgkmcnt(1)
    v_exp_f32 v221, v221
    v_mfma_f32_16x16x32_bf16 v[228:231], a[124:127], a[76:79], v[228:231]
    s_barrier
    v_mfma_f32_16x16x32_bf16 v[232:235], a[140:143], a[76:79], v[252:255]
    v_exp_f32 v222, v222
    v_mfma_f32_16x16x32_bf16 v[232:235], a[136:139], a[72:75], v[232:235]
    v_exp_f32 v223, v223
    v_mfma_f32_16x16x32_bf16 v[232:235], a[132:135], a[68:71], v[232:235]
    v_cvt_pk_bf16_f32 v208, v220, v221
    v_cvt_pk_bf16_f32 v209, v222, v223
    v_mfma_f32_16x16x32_bf16 v[232:235], a[128:131], a[64:67], v[232:235]
    ds_write_b64 v0, v[14:15] offset:2184
    v_mfma_f32_16x16x32_bf16 v[224:227], a[96:99], a[0:3], v[236:239]
    s_add_u32 s22, s22, 1024
    v_exp_f32 v228, v228
    v_mfma_f32_16x16x32_bf16 v[224:227], a[100:103], a[4:7], v[224:227]
    s_add_u32 m0, s24, 0
    v_exp_f32 v229, v229
    v_mfma_f32_16x16x32_bf16 v[224:227], a[104:107], a[8:11], v[224:227]
    s_add_u32 s23, s23, 1088
    v_exp_f32 v230, v230
    v_mfma_f32_16x16x32_bf16 v[224:227], a[108:111], a[12:15], v[224:227]
    buffer_load_dwordx4 v3, s[4:7], 0 offen nt lds
    v_mfma_f32_16x16x32_bf16 v[220:223], a[92:95], a[12:15], v[236:239]
    v_exp_f32 v231, v231
    v_mfma_f32_16x16x32_bf16 v[220:223], a[88:91], a[8:11], v[220:223]
    v_cvt_pk_bf16_f32 v216, v228, v229
    v_cvt_pk_bf16_f32 v217, v230, v231
    v_mfma_f32_16x16x32_bf16 v[220:223], a[84:87], a[4:7], v[220:223]
    v_exp_f32 v232, v232
    v_mfma_f32_16x16x32_bf16 v[220:223], a[80:83], a[0:3], v[220:223]
    ds_read_b128 a[112:115], v1 offset:8448
    v_add_u32 v0, s26, v0
    v_smfmac_f32_16x16x64_bf16 a[208:211], a[228:231], v[180:187], v10
    ds_read_b64_tr_b16 a[176:177], v2 offset:0
    v_smfmac_f32_16x16x64_bf16 a[212:215], a[228:231], v[188:195], v10
    ds_read_b128 a[116:119], v1 offset:8512
    v_mfma_f32_16x16x32_bf16 v[20:23], v[180:183], a[144:147], v[20:23]
    v_exp_f32 v233, v233
    v_mfma_f32_16x16x32_bf16 v[20:23], v[184:187], a[148:151], v[20:23]
    ds_read_b64_tr_b16 a[178:179], v2 offset:512
    v_mfma_f32_16x16x32_bf16 v[24:27], v[184:187], a[156:159], v[24:27]
    v_exp_f32 v234, v234
    v_mfma_f32_16x16x32_bf16 v[24:27], v[180:183], a[152:155], v[24:27]
    ds_read_b64_tr_b16 a[180:181], v2 offset:4160
    v_mfma_f32_16x16x32_bf16 v[28:31], v[180:183], a[160:163], v[28:31]
    v_exp_f32 v235, v235
    v_mfma_f32_16x16x32_bf16 v[28:31], v[184:187], a[164:167], v[28:31]
    ds_read_b64_tr_b16 a[182:183], v2 offset:4672
    v_mfma_f32_16x16x32_bf16 v[32:35], v[184:187], a[172:175], v[32:35]
    v_cvt_pk_bf16_f32 v218, v232, v233
    v_cvt_pk_bf16_f32 v219, v234, v235
    v_mfma_f32_16x16x32_bf16 v[32:35], v[180:183], a[168:171], v[32:35]
    ds_read_b128 a[120:123], v1 offset:8576
    v_mfma_f32_16x16x32_bf16 v[64:67], v[188:191], a[168:171], v[64:67]
    v_exp_f32 v224, v224
    v_mfma_f32_16x16x32_bf16 v[64:67], v[192:195], a[172:175], v[64:67]
    s_add_u32 m0, s24, 32
    ds_read_b64_tr_b16 a[184:185], v2 offset:16
    v_mfma_f32_16x16x32_bf16 v[60:63], v[192:195], a[164:167], v[60:63]
    v_exp_f32 v225, v225
    v_mfma_f32_16x16x32_bf16 v[60:63], v[188:191], a[160:163], v[60:63]
    buffer_load_dwordx4 v3, s[4:7], 0 offen offset:1024 nt lds
    v_mfma_f32_16x16x32_bf16 v[56:59], v[188:191], a[152:155], v[56:59]
    s_add_u32 s4, s4, 8192
    v_exp_f32 v226, v226
    v_mfma_f32_16x16x32_bf16 v[56:59], v[192:195], a[156:159], v[56:59]
    s_addc_u32 s5, s5, 0
    ds_read_b128 a[124:127], v1 offset:8640
    v_mfma_f32_16x16x32_bf16 v[52:55], v[192:195], a[148:151], v[52:55]
    s_sub_u32 s20, s20, 8192
    v_exp_f32 v227, v227
    v_mfma_f32_16x16x32_bf16 v[52:55], v[188:191], a[144:147], v[52:55]
    s_max_i32 s6, s20, 0
    ds_read_b64_tr_b16 a[186:187], v2 offset:528
    v_mfma_f32_16x16x32_bf16 v[228:231], a[80:83], a[16:19], v[240:243]
    v_cvt_pk_bf16_f32 v182, v224, v225
    v_cvt_pk_bf16_f32 v183, v226, v227
    v_mfma_f32_16x16x32_bf16 v[228:231], a[84:87], a[20:23], v[228:231]
    v_exp_f32 v220, v220
    v_mfma_f32_16x16x32_bf16 v[228:231], a[88:91], a[24:27], v[228:231]
    v_exp_f32 v221, v221
    v_mfma_f32_16x16x32_bf16 v[228:231], a[92:95], a[28:31], v[228:231]
    ds_read_b64_tr_b16 a[188:189], v2 offset:4176
    v_mfma_f32_16x16x32_bf16 v[232:235], a[108:111], a[28:31], v[240:243]
    v_exp_f32 v222, v222
    v_mfma_f32_16x16x32_bf16 v[232:235], a[104:107], a[24:27], v[232:235]
    v_exp_f32 v223, v223
    v_mfma_f32_16x16x32_bf16 v[232:235], a[100:103], a[20:23], v[232:235]
    v_cvt_pk_bf16_f32 v180, v220, v221
    v_cvt_pk_bf16_f32 v181, v222, v223
    v_mfma_f32_16x16x32_bf16 v[232:235], a[96:99], a[16:19], v[232:235]
    ds_read_b64_tr_b16 a[190:191], v2 offset:4688
    v_mfma_f32_16x16x32_bf16 v[224:227], a[96:99], a[32:35], v[244:247]
    v_exp_f32 v228, v228
    v_mfma_f32_16x16x32_bf16 v[224:227], a[100:103], a[36:39], v[224:227]
    s_add_u32 m0, s25, 24960
    v_exp_f32 v229, v229
    v_mfma_f32_16x16x32_bf16 v[224:227], a[104:107], a[40:43], v[224:227]
    v_exp_f32 v230, v230
    v_mfma_f32_16x16x32_bf16 v[224:227], a[108:111], a[44:47], v[224:227]
    buffer_load_dwordx4 v4, s[8:11], 0 offen nt lds
    v_mfma_f32_16x16x32_bf16 v[220:223], a[92:95], a[44:47], v[244:247]
    v_exp_f32 v231, v231
    v_mfma_f32_16x16x32_bf16 v[220:223], a[88:91], a[40:43], v[220:223]
    v_cvt_pk_bf16_f32 v188, v228, v229
    v_cvt_pk_bf16_f32 v189, v230, v231
    v_mfma_f32_16x16x32_bf16 v[220:223], a[84:87], a[36:39], v[220:223]
    v_exp_f32 v232, v232
    v_mfma_f32_16x16x32_bf16 v[220:223], a[80:83], a[32:35], v[220:223]
    ds_read_b128 a[128:131], v1 offset:8960
    v_smfmac_f32_16x16x64_bf16 a[216:219], a[228:231], v[196:203], v10
    ds_read_b64_tr_b16 a[192:193], v2 offset:32
    v_smfmac_f32_16x16x64_bf16 a[220:223], a[228:231], v[204:211], v10
    ds_read_b128 a[132:135], v1 offset:9024
    v_smfmac_f32_16x16x64_bf16 a[224:227], a[228:231], v[212:219], v10
    ds_read_b64_tr_b16 a[194:195], v2 offset:544
    v_mfma_f32_16x16x32_bf16 v[84:87], v[196:199], a[144:147], v[84:87]
    v_exp_f32 v233, v233
    v_mfma_f32_16x16x32_bf16 v[84:87], v[200:203], a[148:151], v[84:87]
    ds_read_b64_tr_b16 a[196:197], v2 offset:4192
    v_mfma_f32_16x16x32_bf16 v[88:91], v[200:203], a[156:159], v[88:91]
    v_exp_f32 v234, v234
    v_mfma_f32_16x16x32_bf16 v[88:91], v[196:199], a[152:155], v[88:91]
    ds_read_b64_tr_b16 a[198:199], v2 offset:4704
    v_mfma_f32_16x16x32_bf16 v[92:95], v[196:199], a[160:163], v[92:95]
    v_exp_f32 v235, v235
    v_mfma_f32_16x16x32_bf16 v[92:95], v[200:203], a[164:167], v[92:95]
    ds_read_b128 a[136:139], v1 offset:9088
    v_mfma_f32_16x16x32_bf16 v[96:99], v[200:203], a[172:175], v[96:99]
    v_cvt_pk_bf16_f32 v190, v232, v233
    v_cvt_pk_bf16_f32 v191, v234, v235
    v_mfma_f32_16x16x32_bf16 v[96:99], v[196:199], a[168:171], v[96:99]
    ds_read_b64_tr_b16 a[200:201], v2 offset:48
    v_mfma_f32_16x16x32_bf16 v[128:131], v[204:207], a[168:171], v[128:131]
    v_exp_f32 v224, v224
    v_mfma_f32_16x16x32_bf16 v[128:131], v[208:211], a[172:175], v[128:131]
    s_add_u32 m0, s25, 24976
    ds_read_b128 a[140:143], v1 offset:9152
    v_mfma_f32_16x16x32_bf16 v[124:127], v[208:211], a[164:167], v[124:127]
    v_exp_f32 v225, v225
    v_mfma_f32_16x16x32_bf16 v[124:127], v[204:207], a[160:163], v[124:127]
    buffer_load_dwordx4 v4, s[8:11], 0 offen offset:1024 nt lds
    v_mfma_f32_16x16x32_bf16 v[120:123], v[204:207], a[152:155], v[120:123]
    s_add_u32 s8, s8, 8320
    v_exp_f32 v226, v226
    v_mfma_f32_16x16x32_bf16 v[120:123], v[208:211], a[156:159], v[120:123]
    s_addc_u32 s9, s9, 0
    ds_read_b64_tr_b16 a[202:203], v2 offset:560
    v_mfma_f32_16x16x32_bf16 v[116:119], v[208:211], a[148:151], v[116:119]
    s_sub_u32 s21, s21, 8320
    v_exp_f32 v227, v227
    v_mfma_f32_16x16x32_bf16 v[116:119], v[204:207], a[144:147], v[116:119]
    s_max_i32 s10, s21, 0
    ds_read_b64_tr_b16 a[204:205], v2 offset:4208
    v_mfma_f32_16x16x32_bf16 v[228:231], a[80:83], a[48:51], v[248:251]
    v_cvt_pk_bf16_f32 v198, v224, v225
    v_cvt_pk_bf16_f32 v199, v226, v227
    v_mfma_f32_16x16x32_bf16 v[228:231], a[84:87], a[52:55], v[228:231]
    v_exp_f32 v220, v220
    v_mfma_f32_16x16x32_bf16 v[228:231], a[88:91], a[56:59], v[228:231]
    v_exp_f32 v221, v221
    v_mfma_f32_16x16x32_bf16 v[228:231], a[92:95], a[60:63], v[228:231]
    ds_read_b64_tr_b16 a[206:207], v2 offset:4720
    v_mfma_f32_16x16x32_bf16 v[232:235], a[108:111], a[60:63], v[248:251]
    v_exp_f32 v222, v222
    v_mfma_f32_16x16x32_bf16 v[232:235], a[104:107], a[56:59], v[232:235]
    v_exp_f32 v223, v223
    v_mfma_f32_16x16x32_bf16 v[232:235], a[100:103], a[52:55], v[232:235]
    v_cvt_pk_bf16_f32 v196, v220, v221
    v_cvt_pk_bf16_f32 v197, v222, v223
    v_mfma_f32_16x16x32_bf16 v[232:235], a[96:99], a[48:51], v[232:235]
    v_mfma_f32_16x16x32_bf16 v[224:227], a[96:99], a[64:67], v[252:255]
    v_exp_f32 v228, v228
    v_mfma_f32_16x16x32_bf16 v[224:227], a[100:103], a[68:71], v[224:227]
    s_min_u32 m0, s23, s48
    v_exp_f32 v229, v229
    v_mfma_f32_16x16x32_bf16 v[224:227], a[104:107], a[72:75], v[224:227]
    v_exp_f32 v230, v230
    v_mfma_f32_16x16x32_bf16 v[224:227], a[108:111], a[76:79], v[224:227]
    buffer_load_dwordx4 v3, s[12:15], s22 offen nt lds
    v_mfma_f32_16x16x32_bf16 v[220:223], a[92:95], a[76:79], v[252:255]
    v_exp_f32 v231, v231
    v_mfma_f32_16x16x32_bf16 v[220:223], a[88:91], a[72:75], v[220:223]
    v_cvt_pk_bf16_f32 v204, v228, v229
    v_cvt_pk_bf16_f32 v205, v230, v231
    v_mfma_f32_16x16x32_bf16 v[220:223], a[84:87], a[68:71], v[220:223]
    v_exp_f32 v232, v232
    v_mfma_f32_16x16x32_bf16 v[220:223], a[80:83], a[64:67], v[220:223]
    ds_read_b128 v[12:15], v0 offset:0
    v_mfma_f32_16x16x32_bf16 v[148:151], v[212:215], a[144:147], v[148:151]
    v_exp_f32 v233, v233
    v_mfma_f32_16x16x32_bf16 v[148:151], v[216:219], a[148:151], v[148:151]
    v_mfma_f32_16x16x32_bf16 v[152:155], v[216:219], a[156:159], v[152:155]
    v_exp_f32 v234, v234
    v_mfma_f32_16x16x32_bf16 v[152:155], v[212:215], a[152:155], v[152:155]
    v_mfma_f32_16x16x32_bf16 v[156:159], v[212:215], a[160:163], v[156:159]
    s_waitcnt vmcnt(10) lgkmcnt(0)
    v_exp_f32 v235, v235
    v_mfma_f32_16x16x32_bf16 v[156:159], v[216:219], a[164:167], v[156:159]
    s_barrier
    v_mfma_f32_16x16x32_bf16 v[160:163], v[216:219], a[172:175], v[160:163]
    v_cvt_pk_bf16_f32 v206, v232, v233
    v_cvt_pk_bf16_f32 v207, v234, v235
    v_mfma_f32_16x16x32_bf16 v[160:163], v[212:215], a[168:171], v[160:163]
    v_mfma_f32_16x16x32_bf16 v[48:51], v[184:187], a[200:203], v[48:51]
    s_add_u32 s22, s22, 1024
    v_exp_f32 v224, v224
    v_mfma_f32_16x16x32_bf16 v[48:51], v[180:183], a[204:207], v[48:51]
    s_add_u32 m0, s24, 8448
    ds_read_b128 a[80:83], v1 offset:16896
    v_lshlrev_b32 v11, 16, v12
    v_mfma_f32_16x16x32_bf16 v[44:47], v[180:183], a[196:199], v[44:47]
    s_add_u32 s23, s23, 1088
    v_exp_f32 v225, v225
    v_mfma_f32_16x16x32_bf16 v[44:47], v[184:187], a[192:195], v[44:47]
    buffer_load_dwordx4 v3, s[4:7], 0 offen nt lds
    v_mfma_f32_16x16x32_bf16 v[40:43], v[184:187], a[184:187], v[40:43]
    s_movk_i32 s26, 3264
    v_exp_f32 v226, v226
    v_mfma_f32_16x16x32_bf16 v[40:43], v[180:183], a[188:191], v[40:43]
    ds_read_b64_tr_b16 a[144:145], v2 offset:8320
    v_and_b32 v12, s29, v12
    v_mfma_f32_16x16x32_bf16 v[36:39], v[180:183], a[180:183], v[36:39]
    v_exp_f32 v227, v227
    v_mfma_f32_16x16x32_bf16 v[36:39], v[184:187], a[176:179], v[36:39]
    ds_read_b128 a[84:87], v1 offset:16960
    v_mul_f32 v11, s30, v11
    v_mfma_f32_16x16x32_bf16 v[228:231], a[112:115], a[0:3], v[236:239]
    v_cvt_pk_bf16_f32 v214, v224, v225
    v_cvt_pk_bf16_f32 v215, v226, v227
    v_mfma_f32_16x16x32_bf16 v[228:231], a[116:119], a[4:7], v[228:231]
    v_exp_f32 v220, v220
    v_mfma_f32_16x16x32_bf16 v[228:231], a[120:123], a[8:11], v[228:231]
    v_exp_f32 v221, v221
    v_mfma_f32_16x16x32_bf16 v[228:231], a[124:127], a[12:15], v[228:231]
    ds_read_b64_tr_b16 a[146:147], v2 offset:8832
    v_mul_f32 v12, s30, v12
    v_mfma_f32_16x16x32_bf16 v[232:235], a[140:143], a[12:15], v[236:239]
    v_exp_f32 v222, v222
    v_mfma_f32_16x16x32_bf16 v[232:235], a[136:139], a[8:11], v[232:235]
    v_exp_f32 v223, v223
    v_mfma_f32_16x16x32_bf16 v[232:235], a[132:135], a[4:7], v[232:235]
    v_cvt_pk_bf16_f32 v212, v220, v221
    v_cvt_pk_bf16_f32 v213, v222, v223
    v_mfma_f32_16x16x32_bf16 v[232:235], a[128:131], a[0:3], v[232:235]
    ds_read_b64_tr_b16 a[148:149], v2 offset:12480
    ds_read_b64_tr_b16 a[150:151], v2 offset:12992
    v_mfma_f32_16x16x32_bf16 v[224:227], a[128:131], a[16:19], v[240:243]
    v_exp_f32 v228, v228
    v_mfma_f32_16x16x32_bf16 v[224:227], a[132:135], a[20:23], v[224:227]
    s_add_u32 m0, s24, 8480
    v_exp_f32 v229, v229
    v_mfma_f32_16x16x32_bf16 v[224:227], a[136:139], a[24:27], v[224:227]
    v_exp_f32 v230, v230
    v_mfma_f32_16x16x32_bf16 v[224:227], a[140:143], a[28:31], v[224:227]
    buffer_load_dwordx4 v3, s[4:7], 0 offen offset:1024 nt lds
    v_mfma_f32_16x16x32_bf16 v[220:223], a[124:127], a[28:31], v[240:243]
    s_add_u32 s4, s4, 8192
    v_exp_f32 v231, v231
    v_mfma_f32_16x16x32_bf16 v[220:223], a[120:123], a[24:27], v[220:223]
    s_addc_u32 s5, s5, 0
    v_cvt_pk_bf16_f32 v184, v228, v229
    v_cvt_pk_bf16_f32 v185, v230, v231
    v_mfma_f32_16x16x32_bf16 v[220:223], a[116:119], a[20:23], v[220:223]
    s_sub_u32 s20, s20, 8192
    v_exp_f32 v232, v232
    v_mfma_f32_16x16x32_bf16 v[220:223], a[112:115], a[16:19], v[220:223]
    s_max_i32 s6, s20, 0
    ds_read_b128 a[88:91], v1 offset:17024
    v_cvt_pk_bf16_f32 v12, v11, v12
    v_mfma_f32_16x16x32_bf16 v[68:71], v[192:195], a[176:179], v[68:71]
    v_exp_f32 v233, v233
    v_mfma_f32_16x16x32_bf16 v[68:71], v[188:191], a[180:183], v[68:71]
    ds_read_b64_tr_b16 a[152:153], v2 offset:8336
    v_lshlrev_b32 v11, 16, v13
    v_mfma_f32_16x16x32_bf16 v[72:75], v[188:191], a[188:191], v[72:75]
    v_exp_f32 v234, v234
    v_mfma_f32_16x16x32_bf16 v[72:75], v[192:195], a[184:187], v[72:75]
    ds_read_b128 a[92:95], v1 offset:17088
    v_and_b32 v13, s29, v13
    v_mfma_f32_16x16x32_bf16 v[76:79], v[192:195], a[192:195], v[76:79]
    v_exp_f32 v235, v235
    v_mfma_f32_16x16x32_bf16 v[76:79], v[188:191], a[196:199], v[76:79]
    ds_read_b64_tr_b16 a[154:155], v2 offset:8848
    v_mul_f32 v11, s30, v11
    v_mfma_f32_16x16x32_bf16 v[80:83], v[188:191], a[204:207], v[80:83]
    v_cvt_pk_bf16_f32 v186, v232, v233
    v_cvt_pk_bf16_f32 v187, v234, v235
    v_mfma_f32_16x16x32_bf16 v[80:83], v[192:195], a[200:203], v[80:83]
    ds_read_b64_tr_b16 a[156:157], v2 offset:12496
    ds_read_b64_tr_b16 a[158:159], v2 offset:13008
    v_mfma_f32_16x16x32_bf16 v[112:115], v[200:203], a[200:203], v[112:115]
    v_exp_f32 v224, v224
    v_mfma_f32_16x16x32_bf16 v[112:115], v[196:199], a[204:207], v[112:115]
    s_add_u32 m0, s25, 0
    ds_read_b128 a[96:99], v1 offset:17408
    v_mul_f32 v13, s30, v13
    v_mfma_f32_16x16x32_bf16 v[108:111], v[196:199], a[196:199], v[108:111]
    v_exp_f32 v225, v225
    v_mfma_f32_16x16x32_bf16 v[108:111], v[200:203], a[192:195], v[108:111]
    buffer_load_dwordx4 v4, s[8:11], 0 offen nt lds
    v_mfma_f32_16x16x32_bf16 v[104:107], v[200:203], a[184:187], v[104:107]
    v_exp_f32 v226, v226
    v_mfma_f32_16x16x32_bf16 v[104:107], v[196:199], a[188:191], v[104:107]
    ds_read_b64_tr_b16 a[160:161], v2 offset:8352
    v_cvt_pk_bf16_f32 v13, v11, v13
    v_mfma_f32_16x16x32_bf16 v[100:103], v[196:199], a[180:183], v[100:103]
    v_exp_f32 v227, v227
    v_mfma_f32_16x16x32_bf16 v[100:103], v[200:203], a[176:179], v[100:103]
    ds_read_b128 a[100:103], v1 offset:17472
    v_lshlrev_b32 v11, 16, v14
    v_mfma_f32_16x16x32_bf16 v[228:231], a[112:115], a[32:35], v[244:247]
    v_cvt_pk_bf16_f32 v194, v224, v225
    v_cvt_pk_bf16_f32 v195, v226, v227
    v_mfma_f32_16x16x32_bf16 v[228:231], a[116:119], a[36:39], v[228:231]
    v_exp_f32 v220, v220
    v_mfma_f32_16x16x32_bf16 v[228:231], a[120:123], a[40:43], v[228:231]
    v_exp_f32 v221, v221
    v_mfma_f32_16x16x32_bf16 v[228:231], a[124:127], a[44:47], v[228:231]
    ds_read_b64_tr_b16 a[162:163], v2 offset:8864
    v_and_b32 v14, s29, v14
    v_mfma_f32_16x16x32_bf16 v[232:235], a[140:143], a[44:47], v[244:247]
    v_exp_f32 v222, v222
    v_mfma_f32_16x16x32_bf16 v[232:235], a[136:139], a[40:43], v[232:235]
    v_exp_f32 v223, v223
    v_mfma_f32_16x16x32_bf16 v[232:235], a[132:135], a[36:39], v[232:235]
    v_cvt_pk_bf16_f32 v192, v220, v221
    v_cvt_pk_bf16_f32 v193, v222, v223
    v_mfma_f32_16x16x32_bf16 v[232:235], a[128:131], a[32:35], v[232:235]
    ds_read_b64_tr_b16 a[164:165], v2 offset:12512
    ds_read_b64_tr_b16 a[166:167], v2 offset:13024
    v_mfma_f32_16x16x32_bf16 v[224:227], a[128:131], a[48:51], v[248:251]
    v_exp_f32 v228, v228
    v_mfma_f32_16x16x32_bf16 v[224:227], a[132:135], a[52:55], v[224:227]
    s_add_u32 m0, s25, 16
    v_exp_f32 v229, v229
    v_mfma_f32_16x16x32_bf16 v[224:227], a[136:139], a[56:59], v[224:227]
    v_exp_f32 v230, v230
    v_mfma_f32_16x16x32_bf16 v[224:227], a[140:143], a[60:63], v[224:227]
    buffer_load_dwordx4 v4, s[8:11], 0 offen offset:1024 nt lds
    v_mfma_f32_16x16x32_bf16 v[220:223], a[124:127], a[60:63], v[248:251]
    s_add_u32 s8, s8, 8064
    v_exp_f32 v231, v231
    v_mfma_f32_16x16x32_bf16 v[220:223], a[120:123], a[56:59], v[220:223]
    s_addc_u32 s9, s9, 0
    v_cvt_pk_bf16_f32 v200, v228, v229
    v_cvt_pk_bf16_f32 v201, v230, v231
    v_mfma_f32_16x16x32_bf16 v[220:223], a[116:119], a[52:55], v[220:223]
    s_sub_u32 s21, s21, 8064
    v_exp_f32 v232, v232
    v_mfma_f32_16x16x32_bf16 v[220:223], a[112:115], a[48:51], v[220:223]
    s_max_i32 s10, s21, 0
    ds_read_b128 a[104:107], v1 offset:17536
    v_mul_f32 v11, s30, v11
    v_mfma_f32_16x16x32_bf16 v[132:135], v[208:211], a[176:179], v[132:135]
    v_exp_f32 v233, v233
    v_mfma_f32_16x16x32_bf16 v[132:135], v[204:207], a[180:183], v[132:135]
    ds_read_b64_tr_b16 a[168:169], v2 offset:8368
    v_mul_f32 v14, s30, v14
    v_mfma_f32_16x16x32_bf16 v[136:139], v[204:207], a[188:191], v[136:139]
    v_exp_f32 v234, v234
    v_mfma_f32_16x16x32_bf16 v[136:139], v[208:211], a[184:187], v[136:139]
    ds_read_b128 a[108:111], v1 offset:17600
    v_cvt_pk_bf16_f32 v14, v11, v14
    v_mfma_f32_16x16x32_bf16 v[140:143], v[208:211], a[192:195], v[140:143]
    v_exp_f32 v235, v235
    v_mfma_f32_16x16x32_bf16 v[140:143], v[204:207], a[196:199], v[140:143]
    ds_read_b64_tr_b16 a[170:171], v2 offset:8880
    v_lshlrev_b32 v11, 16, v15
    v_mfma_f32_16x16x32_bf16 v[144:147], v[204:207], a[204:207], v[144:147]
    v_cvt_pk_bf16_f32 v202, v232, v233
    v_cvt_pk_bf16_f32 v203, v234, v235
    v_mfma_f32_16x16x32_bf16 v[144:147], v[208:211], a[200:203], v[144:147]
    ds_read_b64_tr_b16 a[172:173], v2 offset:12528
    ds_read_b64_tr_b16 a[174:175], v2 offset:13040
    v_mfma_f32_16x16x32_bf16 v[176:179], v[216:219], a[200:203], v[176:179]
    v_exp_f32 v224, v224
    v_mfma_f32_16x16x32_bf16 v[176:179], v[212:215], a[204:207], v[176:179]
    s_min_u32 m0, s23, s48
    ds_read_b128 v[16:19], v0 offset:1088
    v_and_b32 v15, s29, v15
    v_mfma_f32_16x16x32_bf16 v[172:175], v[212:215], a[196:199], v[172:175]
    v_exp_f32 v225, v225
    v_mfma_f32_16x16x32_bf16 v[172:175], v[216:219], a[192:195], v[172:175]
    buffer_load_dwordx4 v3, s[12:15], s22 offen nt lds
    v_mfma_f32_16x16x32_bf16 v[168:171], v[216:219], a[184:187], v[168:171]
    v_exp_f32 v226, v226
    v_mfma_f32_16x16x32_bf16 v[168:171], v[212:215], a[188:191], v[168:171]
    v_mul_f32 v11, s30, v11
    v_mul_f32 v15, s30, v15
    v_cvt_pk_bf16_f32 v15, v11, v15
    v_mfma_f32_16x16x32_bf16 v[164:167], v[212:215], a[180:183], v[164:167]
    v_exp_f32 v227, v227
    v_mfma_f32_16x16x32_bf16 v[164:167], v[216:219], a[176:179], v[164:167]
    ds_write_b64 v0, v[12:13] offset:0
    v_mfma_f32_16x16x32_bf16 v[228:231], a[112:115], a[64:67], v[252:255]
    v_cvt_pk_bf16_f32 v210, v224, v225
    v_cvt_pk_bf16_f32 v211, v226, v227
    v_mfma_f32_16x16x32_bf16 v[228:231], a[116:119], a[68:71], v[228:231]
    v_exp_f32 v220, v220
    v_mfma_f32_16x16x32_bf16 v[228:231], a[120:123], a[72:75], v[228:231]
    s_waitcnt vmcnt(10) lgkmcnt(1)
    v_exp_f32 v221, v221
    v_mfma_f32_16x16x32_bf16 v[228:231], a[124:127], a[76:79], v[228:231]
    s_barrier
    v_mfma_f32_16x16x32_bf16 v[232:235], a[140:143], a[76:79], v[252:255]
    v_exp_f32 v222, v222
    v_mfma_f32_16x16x32_bf16 v[232:235], a[136:139], a[72:75], v[232:235]
    v_exp_f32 v223, v223
    v_mfma_f32_16x16x32_bf16 v[232:235], a[132:135], a[68:71], v[232:235]
    v_cvt_pk_bf16_f32 v208, v220, v221
    v_cvt_pk_bf16_f32 v209, v222, v223
    v_mfma_f32_16x16x32_bf16 v[232:235], a[128:131], a[64:67], v[232:235]
    ds_write_b64 v0, v[14:15] offset:8
    v_mfma_f32_16x16x32_bf16 v[224:227], a[96:99], a[0:3], v[236:239]
    s_add_u32 s22, s22, 1024
    v_exp_f32 v228, v228
    v_mfma_f32_16x16x32_bf16 v[224:227], a[100:103], a[4:7], v[224:227]
    s_add_u32 m0, s24, 16896
    v_exp_f32 v229, v229
    v_mfma_f32_16x16x32_bf16 v[224:227], a[104:107], a[8:11], v[224:227]
    s_add_u32 s23, s23, 1088
    v_exp_f32 v230, v230
    v_mfma_f32_16x16x32_bf16 v[224:227], a[108:111], a[12:15], v[224:227]
    buffer_load_dwordx4 v3, s[4:7], 0 offen nt lds
    v_mfma_f32_16x16x32_bf16 v[220:223], a[92:95], a[12:15], v[236:239]
    v_exp_f32 v231, v231
    v_mfma_f32_16x16x32_bf16 v[220:223], a[88:91], a[8:11], v[220:223]
    v_cvt_pk_bf16_f32 v216, v228, v229
    v_cvt_pk_bf16_f32 v217, v230, v231
    v_mfma_f32_16x16x32_bf16 v[220:223], a[84:87], a[4:7], v[220:223]
    v_exp_f32 v232, v232
    v_mfma_f32_16x16x32_bf16 v[220:223], a[80:83], a[0:3], v[220:223]
    ds_read_b128 a[112:115], v1 offset:25344
    v_lshlrev_b32 v11, 16, v16
    v_smfmac_f32_16x16x64_bf16 a[208:211], a[228:231], v[180:187], v10
    ds_read_b64_tr_b16 a[176:177], v2 offset:16640
    v_and_b32 v16, s29, v16
    v_smfmac_f32_16x16x64_bf16 a[212:215], a[228:231], v[188:195], v10
    ds_read_b128 a[116:119], v1 offset:25408
    v_mul_f32 v11, s30, v11
    v_mfma_f32_16x16x32_bf16 v[20:23], v[180:183], a[144:147], v[20:23]
    v_exp_f32 v233, v233
    v_mfma_f32_16x16x32_bf16 v[20:23], v[184:187], a[148:151], v[20:23]
    ds_read_b64_tr_b16 a[178:179], v2 offset:17152
    v_mul_f32 v16, s30, v16
    v_mfma_f32_16x16x32_bf16 v[24:27], v[184:187], a[156:159], v[24:27]
    v_exp_f32 v234, v234
    v_mfma_f32_16x16x32_bf16 v[24:27], v[180:183], a[152:155], v[24:27]
    ds_read_b64_tr_b16 a[180:181], v2 offset:20800
    v_cvt_pk_bf16_f32 v16, v11, v16
    v_mfma_f32_16x16x32_bf16 v[28:31], v[180:183], a[160:163], v[28:31]
    v_exp_f32 v235, v235
    v_mfma_f32_16x16x32_bf16 v[28:31], v[184:187], a[164:167], v[28:31]
    ds_read_b64_tr_b16 a[182:183], v2 offset:21312
    v_lshlrev_b32 v11, 16, v17
    v_mfma_f32_16x16x32_bf16 v[32:35], v[184:187], a[172:175], v[32:35]
    v_cvt_pk_bf16_f32 v218, v232, v233
    v_cvt_pk_bf16_f32 v219, v234, v235
    v_mfma_f32_16x16x32_bf16 v[32:35], v[180:183], a[168:171], v[32:35]
    ds_read_b128 a[120:123], v1 offset:25472
    v_and_b32 v17, s29, v17
    v_mfma_f32_16x16x32_bf16 v[64:67], v[188:191], a[168:171], v[64:67]
    v_exp_f32 v224, v224
    v_mfma_f32_16x16x32_bf16 v[64:67], v[192:195], a[172:175], v[64:67]
    s_add_u32 m0, s24, 16928
    ds_read_b64_tr_b16 a[184:185], v2 offset:16656
    v_mul_f32 v11, s30, v11
    v_mfma_f32_16x16x32_bf16 v[60:63], v[192:195], a[164:167], v[60:63]
    v_exp_f32 v225, v225
    v_mfma_f32_16x16x32_bf16 v[60:63], v[188:191], a[160:163], v[60:63]
    buffer_load_dwordx4 v3, s[4:7], 0 offen offset:1024 nt lds
    v_mfma_f32_16x16x32_bf16 v[56:59], v[188:191], a[152:155], v[56:59]
    s_add_u32 s4, s4, 8192
    v_exp_f32 v226, v226
    v_mfma_f32_16x16x32_bf16 v[56:59], v[192:195], a[156:159], v[56:59]
    s_addc_u32 s5, s5, 0
    ds_read_b128 a[124:127], v1 offset:25536
    v_mul_f32 v17, s30, v17
    v_mfma_f32_16x16x32_bf16 v[52:55], v[192:195], a[148:151], v[52:55]
    s_sub_u32 s20, s20, 8192
    v_exp_f32 v227, v227
    v_mfma_f32_16x16x32_bf16 v[52:55], v[188:191], a[144:147], v[52:55]
    s_max_i32 s6, s20, 0
    ds_read_b64_tr_b16 a[186:187], v2 offset:17168
    v_cvt_pk_bf16_f32 v17, v11, v17
    v_mfma_f32_16x16x32_bf16 v[228:231], a[80:83], a[16:19], v[240:243]
    v_cvt_pk_bf16_f32 v182, v224, v225
    v_cvt_pk_bf16_f32 v183, v226, v227
    v_mfma_f32_16x16x32_bf16 v[228:231], a[84:87], a[20:23], v[228:231]
    v_exp_f32 v220, v220
    v_mfma_f32_16x16x32_bf16 v[228:231], a[88:91], a[24:27], v[228:231]
    v_exp_f32 v221, v221
    v_mfma_f32_16x16x32_bf16 v[228:231], a[92:95], a[28:31], v[228:231]
    ds_read_b64_tr_b16 a[188:189], v2 offset:20816
    v_lshlrev_b32 v11, 16, v18
    v_mfma_f32_16x16x32_bf16 v[232:235], a[108:111], a[28:31], v[240:243]
    v_exp_f32 v222, v222
    v_mfma_f32_16x16x32_bf16 v[232:235], a[104:107], a[24:27], v[232:235]
    v_exp_f32 v223, v223
    v_mfma_f32_16x16x32_bf16 v[232:235], a[100:103], a[20:23], v[232:235]
    v_cvt_pk_bf16_f32 v180, v220, v221
    v_cvt_pk_bf16_f32 v181, v222, v223
    v_mfma_f32_16x16x32_bf16 v[232:235], a[96:99], a[16:19], v[232:235]
    ds_read_b64_tr_b16 a[190:191], v2 offset:21328
    v_and_b32 v18, s29, v18
    v_mfma_f32_16x16x32_bf16 v[224:227], a[96:99], a[32:35], v[244:247]
    v_exp_f32 v228, v228
    v_mfma_f32_16x16x32_bf16 v[224:227], a[100:103], a[36:39], v[224:227]
    s_add_u32 m0, s25, 8320
    v_exp_f32 v229, v229
    v_mfma_f32_16x16x32_bf16 v[224:227], a[104:107], a[40:43], v[224:227]
    v_exp_f32 v230, v230
    v_mfma_f32_16x16x32_bf16 v[224:227], a[108:111], a[44:47], v[224:227]
    buffer_load_dwordx4 v4, s[8:11], 0 offen nt lds
    v_mfma_f32_16x16x32_bf16 v[220:223], a[92:95], a[44:47], v[244:247]
    v_exp_f32 v231, v231
    v_mfma_f32_16x16x32_bf16 v[220:223], a[88:91], a[40:43], v[220:223]
    v_cvt_pk_bf16_f32 v188, v228, v229
    v_cvt_pk_bf16_f32 v189, v230, v231
    v_mfma_f32_16x16x32_bf16 v[220:223], a[84:87], a[36:39], v[220:223]
    v_exp_f32 v232, v232
    v_mfma_f32_16x16x32_bf16 v[220:223], a[80:83], a[32:35], v[220:223]
    ds_read_b128 a[128:131], v1 offset:25856
    v_mul_f32 v11, s30, v11
    v_smfmac_f32_16x16x64_bf16 a[216:219], a[228:231], v[196:203], v10
    ds_read_b64_tr_b16 a[192:193], v2 offset:16672
    v_mul_f32 v18, s30, v18
    v_smfmac_f32_16x16x64_bf16 a[220:223], a[228:231], v[204:211], v10
    ds_read_b128 a[132:135], v1 offset:25920
    v_cvt_pk_bf16_f32 v18, v11, v18
    v_smfmac_f32_16x16x64_bf16 a[224:227], a[228:231], v[212:219], v10
    ds_read_b64_tr_b16 a[194:195], v2 offset:17184
    v_lshlrev_b32 v11, 16, v19
    v_mfma_f32_16x16x32_bf16 v[84:87], v[196:199], a[144:147], v[84:87]
    v_exp_f32 v233, v233
    v_mfma_f32_16x16x32_bf16 v[84:87], v[200:203], a[148:151], v[84:87]
    ds_read_b64_tr_b16 a[196:197], v2 offset:20832
    v_and_b32 v19, s29, v19
    v_mfma_f32_16x16x32_bf16 v[88:91], v[200:203], a[156:159], v[88:91]
    v_exp_f32 v234, v234
    v_mfma_f32_16x16x32_bf16 v[88:91], v[196:199], a[152:155], v[88:91]
    ds_read_b64_tr_b16 a[198:199], v2 offset:21344
    v_mul_f32 v11, s30, v11
    v_mfma_f32_16x16x32_bf16 v[92:95], v[196:199], a[160:163], v[92:95]
    v_exp_f32 v235, v235
    v_mfma_f32_16x16x32_bf16 v[92:95], v[200:203], a[164:167], v[92:95]
    ds_read_b128 a[136:139], v1 offset:25984
    v_mul_f32 v19, s30, v19
    v_mfma_f32_16x16x32_bf16 v[96:99], v[200:203], a[172:175], v[96:99]
    v_cvt_pk_bf16_f32 v190, v232, v233
    v_cvt_pk_bf16_f32 v191, v234, v235
    v_mfma_f32_16x16x32_bf16 v[96:99], v[196:199], a[168:171], v[96:99]
    ds_read_b64_tr_b16 a[200:201], v2 offset:16688
    v_cvt_pk_bf16_f32 v19, v11, v19
    v_mfma_f32_16x16x32_bf16 v[128:131], v[204:207], a[168:171], v[128:131]
    v_exp_f32 v224, v224
    v_mfma_f32_16x16x32_bf16 v[128:131], v[208:211], a[172:175], v[128:131]
    s_add_u32 m0, s25, 8336
    ds_read_b128 a[140:143], v1 offset:26048
    v_mfma_f32_16x16x32_bf16 v[124:127], v[208:211], a[164:167], v[124:127]
L_pad3:
    s_cbranch_execz L_pad6
    v_exp_f32 v225, v225
    v_mfma_f32_16x16x32_bf16 v[124:127], v[204:207], a[160:163], v[124:127]
    buffer_load_dwordx4 v4, s[8:11], 0 offen offset:1024 nt lds
    v_mfma_f32_16x16x32_bf16 v[120:123], v[204:207], a[152:155], v[120:123]
    s_add_u32 s8, s8, 8320
    v_exp_f32 v226, v226
    v_mfma_f32_16x16x32_bf16 v[120:123], v[208:211], a[156:159], v[120:123]
    s_addc_u32 s9, s9, 0
    ds_read_b64_tr_b16 a[202:203], v2 offset:17200
    v_mfma_f32_16x16x32_bf16 v[116:119], v[208:211], a[148:151], v[116:119]
    s_sub_u32 s21, s21, 8320
    v_exp_f32 v227, v227
    v_mfma_f32_16x16x32_bf16 v[116:119], v[204:207], a[144:147], v[116:119]
    s_max_i32 s10, s21, 0
    ds_read_b64_tr_b16 a[204:205], v2 offset:20848
    v_mfma_f32_16x16x32_bf16 v[228:231], a[80:83], a[48:51], v[248:251]
    v_cvt_pk_bf16_f32 v198, v224, v225
    v_cvt_pk_bf16_f32 v199, v226, v227
    v_mfma_f32_16x16x32_bf16 v[228:231], a[84:87], a[52:55], v[228:231]
    v_exp_f32 v220, v220
    v_mfma_f32_16x16x32_bf16 v[228:231], a[88:91], a[56:59], v[228:231]
    v_exp_f32 v221, v221
    v_mfma_f32_16x16x32_bf16 v[228:231], a[92:95], a[60:63], v[228:231]
    ds_read_b64_tr_b16 a[206:207], v2 offset:21360
    v_mfma_f32_16x16x32_bf16 v[232:235], a[108:111], a[60:63], v[248:251]
    v_exp_f32 v222, v222
    v_mfma_f32_16x16x32_bf16 v[232:235], a[104:107], a[56:59], v[232:235]
    v_exp_f32 v223, v223
    v_mfma_f32_16x16x32_bf16 v[232:235], a[100:103], a[52:55], v[232:235]
    v_cvt_pk_bf16_f32 v196, v220, v221
    v_cvt_pk_bf16_f32 v197, v222, v223
    v_mfma_f32_16x16x32_bf16 v[232:235], a[96:99], a[48:51], v[232:235]
    v_mfma_f32_16x16x32_bf16 v[224:227], a[96:99], a[64:67], v[252:255]
    s_lshr_b64 vcc, vcc, 1
    v_exp_f32 v228, v228
    v_mfma_f32_16x16x32_bf16 v[224:227], a[100:103], a[68:71], v[224:227]
    s_min_u32 m0, s23, s48
    v_exp_f32 v229, v229
    v_mfma_f32_16x16x32_bf16 v[224:227], a[104:107], a[72:75], v[224:227]
    v_exp_f32 v230, v230
    v_mfma_f32_16x16x32_bf16 v[224:227], a[108:111], a[76:79], v[224:227]
    buffer_load_dwordx4 v3, s[12:15], s22 offen nt lds
    v_mfma_f32_16x16x32_bf16 v[220:223], a[92:95], a[76:79], v[252:255]
    v_exp_f32 v231, v231
    v_mfma_f32_16x16x32_bf16 v[220:223], a[88:91], a[72:75], v[220:223]
    v_cvt_pk_bf16_f32 v204, v228, v229
    v_cvt_pk_bf16_f32 v205, v230, v231
    v_mfma_f32_16x16x32_bf16 v[220:223], a[84:87], a[68:71], v[220:223]
    v_exp_f32 v232, v232
    v_mfma_f32_16x16x32_bf16 v[220:223], a[80:83], a[64:67], v[220:223]
    ds_read_b128 v[12:15], v0 offset:2176
    v_mfma_f32_16x16x32_bf16 v[148:151], v[212:215], a[144:147], v[148:151]
    v_exp_f32 v233, v233
    v_mfma_f32_16x16x32_bf16 v[148:151], v[216:219], a[148:151], v[148:151]
    ds_write_b64 v0, v[16:17] offset:1088
    v_mfma_f32_16x16x32_bf16 v[152:155], v[216:219], a[156:159], v[152:155]
    v_exp_f32 v234, v234
    v_mfma_f32_16x16x32_bf16 v[152:155], v[212:215], a[152:155], v[152:155]
    ds_write_b64 v0, v[18:19] offset:1096
    v_mfma_f32_16x16x32_bf16 v[156:159], v[212:215], a[160:163], v[156:159]
    s_waitcnt vmcnt(11) lgkmcnt(2)
    v_exp_f32 v235, v235
    v_mfma_f32_16x16x32_bf16 v[156:159], v[216:219], a[164:167], v[156:159]
    s_barrier
    v_mfma_f32_16x16x32_bf16 v[160:163], v[216:219], a[172:175], v[160:163]
    v_cvt_pk_bf16_f32 v206, v232, v233
    v_cvt_pk_bf16_f32 v207, v234, v235
    v_mfma_f32_16x16x32_bf16 v[160:163], v[212:215], a[168:171], v[160:163]
    s_cbranch_vccnz L_loop0_0
L_trans:
    v_mfma_f32_16x16x32_bf16 v[228:231], a[112:115], a[0:3], v[236:239]
    ds_read_b64_tr_b16 a[146:147], v2 offset:25472
    ds_read_b64_tr_b16 a[156:157], v2 offset:29136
    v_mfma_f32_16x16x32_bf16 v[228:231], a[116:119], a[4:7], v[228:231]
    v_exp_f32 v226, v226
    v_mfma_f32_16x16x32_bf16 v[228:231], a[120:123], a[8:11], v[228:231]
    s_add_u32 m0, s24, 25344
    ds_read_b64_tr_b16 a[170:171], v2 offset:25520
    v_accvgpr_read_b32 v12, a232
    v_mfma_f32_16x16x32_bf16 v[228:231], a[124:127], a[12:15], v[228:231]
    buffer_load_dwordx4 v3, s[4:7], 0 offen nt lds
    ds_read_b64_tr_b16 a[152:153], v2 offset:24976
    ds_read_b64_tr_b16 a[164:165], v2 offset:29152
    v_mfma_f32_16x16x32_bf16 v[80:83], v[188:191], a[204:207], v[80:83]
    ds_read_b64_tr_b16 a[166:167], v2 offset:29664
    ds_read_b64_tr_b16 a[144:145], v2 offset:24960
    v_mfma_f32_16x16x32_bf16 v[80:83], v[192:195], a[200:203], v[80:83]
    ds_read_b64_tr_b16 a[154:155], v2 offset:25488
    ds_read_b128 a[92:95], v1 offset:192
    v_mfma_f32_16x16x32_bf16 v[232:235], a[140:143], a[12:15], v[236:239]
    v_exp_f32 v231, v231
    v_mfma_f32_16x16x32_bf16 v[232:235], a[136:139], a[8:11], v[232:235]
    v_exp_f32 v223, v223
    v_mfma_f32_16x16x32_bf16 v[232:235], a[132:135], a[4:7], v[232:235]
    ds_read_b64_tr_b16 a[168:169], v2 offset:25008
    ds_read_b128 a[104:107], v1 offset:640
    v_mfma_f32_16x16x32_bf16 v[232:235], a[128:131], a[0:3], v[232:235]
    s_add_u32 m0, s24, 25376
    ds_read_b128 a[88:91], v1 offset:128
    s_waitcnt lgkmcnt(5)
    v_mfma_f32_16x16x32_bf16 v[52:55], v[188:191], a[144:147], v[52:55]
    buffer_load_dwordx4 v3, s[4:7], 0 offen offset:1024 nt lds
    v_exp_f32 v225, v225
    v_mfma_f32_16x16x32_bf16 v[40:43], v[180:183], a[188:191], v[40:43]
    ds_read_b64_tr_b16 a[158:159], v2 offset:29648
    ds_read_b128 a[0:3], v5 offset:0
    v_mfma_f32_16x16x32_bf16 v[40:43], v[184:187], a[184:187], v[40:43]
    s_add_u32 s4, s4, 8192
    v_exp_f32 v221, v221
    v_mfma_f32_16x16x32_bf16 v[48:51], v[180:183], a[204:207], v[48:51]
    v_exp_f32 v222, v222
    v_mfma_f32_16x16x32_bf16 v[48:51], v[184:187], a[200:203], v[48:51]
    s_addc_u32 s5, s5, 0
    v_exp_f32 v234, v234
    v_mfma_f32_16x16x32_bf16 v[72:75], v[188:191], a[188:191], v[72:75]
    v_exp_f32 v235, v235
    v_mfma_f32_16x16x32_bf16 v[20:23], v[180:183], a[144:147], v[20:23]
    v_exp_f32 v220, v220
    v_mfma_f32_16x16x32_bf16 v[44:47], v[184:187], a[192:195], v[44:47]
    ds_read_b64_tr_b16 a[162:163], v2 offset:25504
    ds_read_b128 a[84:87], v1 offset:64
    v_mfma_f32_16x16x32_bf16 v[44:47], v[180:183], a[196:199], v[44:47]
    s_sub_u32 s20, s20, 8192
    v_exp_f32 v233, v233
    v_mfma_f32_16x16x32_bf16 v[108:111], v[200:203], a[192:195], v[108:111]
    s_max_i32 s6, s20, 0
    ds_read_b128 a[96:99], v1 offset:512
    s_add_u32 m0, s25, 16640
    v_mfma_f32_16x16x32_bf16 v[108:111], v[196:199], a[196:199], v[108:111]
    buffer_load_dwordx4 v4, s[8:11], 0 offen nt lds
    ds_read_b64_tr_b16 a[160:161], v2 offset:24992
    v_mfma_f32_16x16x32_bf16 v[136:139], v[204:207], a[188:191], v[136:139]
    ds_read_b64_tr_b16 a[148:149], v2 offset:29120
    ds_read_b128 a[100:103], v1 offset:576
    v_mfma_f32_16x16x32_bf16 v[36:39], v[184:187], a[176:179], v[36:39]
    s_add_u32 m0, s25, 16656
    v_exp_f32 v229, v229
    v_mfma_f32_16x16x32_bf16 v[36:39], v[180:183], a[180:183], v[36:39]
    v_cvt_pk_bf16_f32 v213, v222, v223
    v_cvt_pk_bf16_f32 v212, v220, v221
    v_mfma_f32_16x16x32_bf16 v[220:223], a[112:115], a[16:19], v[240:243]
    v_exp_f32 v227, v227
    v_mfma_f32_16x16x32_bf16 v[220:223], a[116:119], a[20:23], v[220:223]
    s_mov_b64 s[44:45], 0
    v_exp_f32 v224, v224
    v_mfma_f32_16x16x32_bf16 v[220:223], a[120:123], a[24:27], v[220:223]
    ds_read_b128 a[108:111], v1 offset:704
    v_cvt_pk_bf16_f32 v214, v224, v225
    v_mfma_f32_16x16x32_bf16 v[220:223], a[124:127], a[28:31], v[220:223]
    buffer_load_dwordx4 v4, s[8:11], 0 offen offset:1024 nt lds
    v_cvt_pk_bf16_f32 v187, v234, v235
    v_cvt_pk_bf16_f32 v215, v226, v227
    v_mfma_f32_16x16x32_bf16 v[224:227], a[140:143], a[28:31], v[240:243]
    ds_read_b64_tr_b16 a[150:151], v2 offset:29632
    ds_read_b64_tr_b16 a[174:175], v2 offset:29680
    v_mfma_f32_16x16x32_bf16 v[224:227], a[136:139], a[24:27], v[224:227]
    ds_read_b64_tr_b16 a[172:173], v2 offset:29168
    ds_read_b128 a[80:83], v1 offset:0
    v_mfma_f32_16x16x32_bf16 v[224:227], a[132:135], a[20:23], v[224:227]
    v_exp_f32 v221, v221
    v_mfma_f32_16x16x32_bf16 v[224:227], a[128:131], a[16:19], v[224:227]
    v_exp_f32 v228, v228
    v_mfma_f32_16x16x32_bf16 v[76:79], v[192:195], a[192:195], v[76:79]
    v_exp_f32 v230, v230
    v_mfma_f32_16x16x32_bf16 v[76:79], v[188:191], a[196:199], v[76:79]
    v_cvt_pk_bf16_f32 v185, v230, v231
    v_cvt_pk_bf16_f32 v184, v228, v229
    v_mfma_f32_16x16x32_bf16 v[228:231], a[112:115], a[32:35], v[244:247]
    s_waitcnt vmcnt(10)
    v_exp_f32 v232, v232
    v_mfma_f32_16x16x32_bf16 v[228:231], a[116:119], a[36:39], v[228:231]
    s_waitcnt lgkmcnt(0)
    s_barrier
    ds_read_b64_tr_b16 a[240:241], v2 offset:16
    v_mfma_f32_16x16x32_bf16 v[228:231], a[120:123], a[40:43], v[228:231]
    ds_read_b64_tr_b16 a[248:249], v2 offset:48
    v_cvt_pk_bf16_f32 v186, v232, v233
    v_mfma_f32_16x16x32_bf16 v[228:231], a[124:127], a[44:47], v[228:231]
    ds_read_b64_tr_b16 a[244:245], v2 offset:32
    ds_read_b64_tr_b16 a[242:243], v2 offset:528
    v_mfma_f32_16x16x32_bf16 v[24:27], v[184:187], a[156:159], v[24:27]
    ds_read_b64_tr_b16 a[246:247], v2 offset:544
    ds_read_b128 a[4:7], v5 offset:64
    v_mfma_f32_16x16x32_bf16 v[24:27], v[180:183], a[152:155], v[24:27]
    v_exp_f32 v224, v224
    v_smfmac_f32_16x16x64_bf16 a[208:211], a[228:231], v[180:187], v10
    v_exp_f32 v229, v229
    v_mfma_f32_16x16x32_bf16 v[232:235], a[140:143], a[44:47], v[244:247]
    s_add_u32 s8, s8, 8064
    v_exp_f32 v220, v220
    v_mfma_f32_16x16x32_bf16 v[232:235], a[136:139], a[40:43], v[232:235]
    v_exp_f32 v225, v225
    v_mfma_f32_16x16x32_bf16 v[232:235], a[132:135], a[36:39], v[232:235]
    v_exp_f32 v230, v230
    v_mfma_f32_16x16x32_bf16 v[232:235], a[128:131], a[32:35], v[232:235]
    v_exp_f32 v222, v222
    v_mfma_f32_16x16x32_bf16 v[104:107], v[196:199], a[188:191], v[104:107]
    ds_read_b128 a[28:31], v5 offset:4544
    v_accvgpr_read_b32 v14, a209
    v_mfma_f32_16x16x32_bf16 v[104:107], v[200:203], a[184:187], v[104:107]
    s_addc_u32 s9, s9, 0
    v_accvgpr_read_b32 v13, a208
    v_add_f32 v13, v13, v14
    v_mfma_f32_16x16x32_bf16 v[132:135], v[208:211], a[176:179], v[132:135]
    s_sub_u32 s21, s21, 8064
    v_rcp_f32 v14, v13
    s_waitcnt lgkmcnt(2)
    v_mfma_f32_16x16x32_bf16 v[44:47], v[184:187], a[244:247], v[44:47]
    ds_write_b32 v8, v14
    v_mfma_f32_16x16x32_bf16 v[32:35], v[184:187], a[172:175], v[32:35]
    ds_read_b64_tr_b16 a[236:237], v2 offset:0
    ds_read_b64_tr_b16 a[250:251], v2 offset:560
    v_mfma_f32_16x16x32_bf16 v[32:35], v[180:183], a[168:171], v[32:35]
    ds_read_b64_tr_b16 a[238:239], v2 offset:512
    ds_read_b128 a[16:19], v5 offset:4352
    v_mfma_f32_16x16x32_bf16 v[72:75], v[192:195], a[184:187], v[72:75]
    s_max_i32 s10, s21, 0
    v_exp_f32 v233, v233
    v_mfma_f32_16x16x32_bf16 v[100:103], v[200:203], a[176:179], v[100:103]
    v_exp_f32 v226, v226
    v_mfma_f32_16x16x32_bf16 v[100:103], v[196:199], a[180:183], v[100:103]
    s_add_u32 m0, s24, 0
    ds_read_b128 v[236:239], v9
    v_exp_f32 v227, v227
    v_mfma_f32_16x16x32_bf16 v[68:71], v[192:195], a[176:179], v[68:71]
    ds_read_b128 a[12:15], v5 offset:192
    v_cvt_pk_bf16_f32 v192, v220, v221
    v_mfma_f32_16x16x32_bf16 v[68:71], v[188:191], a[180:183], v[68:71]
    buffer_load_dwordx4 v3, s[4:7], 0 offen nt lds
    v_exp_f32 v228, v228
    v_mfma_f32_16x16x32_bf16 v[20:23], v[184:187], a[148:151], v[20:23]
    v_exp_f32 v235, v235
    v_mfma_f32_16x16x32_bf16 v[28:31], v[180:183], a[160:163], v[28:31]
    v_exp_f32 v223, v223
    v_mfma_f32_16x16x32_bf16 v[28:31], v[184:187], a[164:167], v[28:31]
    s_waitcnt lgkmcnt(1)
    v_mul_f32 v18, v12, v238
    v_cvt_pk_bf16_f32 v193, v222, v223
    v_mfma_f32_16x16x32_bf16 v[40:43], v[184:187], a[240:243], v[40:43]
    ds_read_b128 a[40:43], v5 offset:8832
    v_cvt_pk_bf16_f32 v195, v226, v227
    v_mfma_f32_16x16x32_bf16 v[48:51], v[184:187], a[248:251], v[48:51]
    v_mul_f32 v16, v12, v236
    v_mul_f32 v19, v12, v239
    v_mfma_f32_16x16x32_bf16 v[36:39], v[184:187], a[236:239], v[36:39]
    ds_read_b128 a[36:39], v5 offset:8768
    v_mul_f32 v17, v12, v237
    v_exp_f32 v231, v231
    v_cvt_pk_bf16_f32 v194, v224, v225
    v_pk_fma_f32 v[24:25], v[24:25], v[236:237], v[16:17] neg_lo:[0,0,1] neg_hi:[0,0,1]
    v_pk_fma_f32 v[30:31], v[30:31], v[238:239], v[18:19] neg_lo:[0,0,1] neg_hi:[0,0,1]
    v_pk_fma_f32 v[26:27], v[26:27], v[238:239], v[18:19] neg_lo:[0,0,1] neg_hi:[0,0,1]
    v_pk_fma_f32 v[28:29], v[28:29], v[236:237], v[16:17] neg_lo:[0,0,1] neg_hi:[0,0,1]
    v_pk_fma_f32 v[42:43], v[42:43], v[238:239], v[18:19] neg_lo:[0,0,1] neg_hi:[0,0,1]
    v_pk_fma_f32 v[38:39], v[38:39], v[238:239], v[18:19] neg_lo:[0,0,1] neg_hi:[0,0,1]
    v_pk_fma_f32 v[50:51], v[50:51], v[238:239], v[18:19] neg_lo:[0,0,1] neg_hi:[0,0,1]
    v_pk_fma_f32 v[44:45], v[44:45], v[236:237], v[16:17] neg_lo:[0,0,1] neg_hi:[0,0,1]
    v_pk_fma_f32 v[32:33], v[32:33], v[236:237], v[16:17] neg_lo:[0,0,1] neg_hi:[0,0,1]
    v_cvt_pk_bf16_f32 v181, v28, v32
    v_pk_fma_f32 v[22:23], v[22:23], v[238:239], v[18:19] neg_lo:[0,0,1] neg_hi:[0,0,1]
    v_pk_fma_f32 v[34:35], v[34:35], v[238:239], v[18:19] neg_lo:[0,0,1] neg_hi:[0,0,1]
    v_pk_fma_f32 v[46:47], v[46:47], v[238:239], v[18:19] neg_lo:[0,0,1] neg_hi:[0,0,1]
    v_pk_fma_f32 v[40:41], v[40:41], v[236:237], v[16:17] neg_lo:[0,0,1] neg_hi:[0,0,1]
    v_pk_fma_f32 v[20:21], v[20:21], v[236:237], v[16:17] neg_lo:[0,0,1] neg_hi:[0,0,1]
    v_pk_fma_f32 v[48:49], v[48:49], v[236:237], v[16:17] neg_lo:[0,0,1] neg_hi:[0,0,1]
    v_pk_fma_f32 v[36:37], v[36:37], v[236:237], v[16:17] neg_lo:[0,0,1] neg_hi:[0,0,1]
    v_cvt_pk_bf16_f32 v182, v36, v40
    v_mfma_f32_16x16x32_bf16 v[56:59], v[192:195], a[156:159], v[56:59]
    ds_read_b128 a[24:27], v5 offset:4480
    v_cmp_ngt_f32 s[46:47], s39, v13
    v_mfma_f32_16x16x32_bf16 v[56:59], v[188:191], a[152:155], v[56:59]
    v_cvt_pk_bf16_f32 v185, v29, v33
    v_cvt_pk_bf16_f32 v183, v44, v48
    v_mfma_f32_16x16x32_bf16 v[112:115], v[196:199], a[204:207], v[112:115]
    s_add_u32 m0, s24, 32
    ds_read_b128 a[8:11], v5 offset:128
    v_cvt_pk_bf16_f32 v180, v20, v24
    v_mfma_f32_16x16x32_bf16 v[112:115], v[200:203], a[200:203], v[112:115]
    v_exp_f32 v232, v232
    v_smfmac_f32_16x16x64_bf16 a[212:215], a[228:231], v[188:195], v10
    ds_write_b64 v6, v[180:181] offset:0
    v_cvt_pk_bf16_f32 v180, v22, v26
    v_mfma_f32_16x16x32_bf16 v[76:79], v[192:195], a[244:247], v[76:79]
    buffer_load_dwordx4 v3, s[4:7], 0 offen offset:1024 nt lds
    ds_write_b64 v6, v[182:183] offset:128
    v_mfma_f32_16x16x32_bf16 v[72:75], v[192:195], a[240:243], v[72:75]
    v_cvt_pk_bf16_f32 v184, v21, v25
    v_cvt_pk_bf16_f32 v183, v46, v50
    v_mfma_f32_16x16x32_bf16 v[220:223], a[112:115], a[48:51], v[248:251]
    ds_read_b128 a[20:23], v5 offset:4416
    v_cvt_pk_bf16_f32 v187, v45, v49
    v_mfma_f32_16x16x32_bf16 v[220:223], a[116:119], a[52:55], v[220:223]
    v_accvgpr_read_b32 v13, a212
    v_accvgpr_read_b32 v14, a213
    v_mfma_f32_16x16x32_bf16 v[220:223], a[120:123], a[56:59], v[220:223]
    v_add_f32 v13, v13, v14
    v_accvgpr_write_b32 a213, 0
    v_mfma_f32_16x16x32_bf16 v[220:223], a[124:127], a[60:63], v[220:223]
    v_cvt_pk_bf16_f32 v202, v232, v233
    v_rcp_f32 v14, v13
    v_mfma_f32_16x16x32_bf16 v[64:67], v[192:195], a[172:175], v[64:67]
    v_exp_f32 v234, v234
    v_mfma_f32_16x16x32_bf16 v[64:67], v[188:191], a[168:171], v[64:67]
    ds_write_b32 v8, v14
    v_mfma_f32_16x16x32_bf16 v[224:227], a[140:143], a[60:63], v[248:251]
    ds_read_b128 v[240:243], v9
    v_cvt_pk_bf16_f32 v203, v234, v235
    v_mfma_f32_16x16x32_bf16 v[224:227], a[136:139], a[56:59], v[224:227]
    ds_read_b128 a[32:35], v5 offset:8704
    v_accvgpr_write_b32 a212, 0
    v_mfma_f32_16x16x32_bf16 v[224:227], a[132:135], a[52:55], v[224:227]
    v_exp_f32 v221, v221
    v_mfma_f32_16x16x32_bf16 v[224:227], a[128:131], a[48:51], v[224:227]
    s_add_u32 s4, s4, 8192
    v_exp_f32 v223, v223
    v_mfma_f32_16x16x32_bf16 v[52:55], v[192:195], a[148:151], v[52:55]
    ds_write_b64 v6, v[184:185] offset:1088
    v_cvt_pk_bf16_f32 v186, v37, v41
    v_mfma_f32_16x16x32_bf16 v[84:87], v[196:199], a[144:147], v[84:87]
    v_cvt_pk_bf16_f32 v185, v31, v35
    v_accvgpr_write_b32 a208, 0
    v_mfma_f32_16x16x32_bf16 v[80:83], v[192:195], a[248:251], v[80:83]
    s_addc_u32 s5, s5, 0
    ds_write_b64 v6, v[186:187] offset:1216
    v_mfma_f32_16x16x32_bf16 v[60:63], v[188:191], a[160:163], v[60:63]
    v_cvt_pk_bf16_f32 v200, v228, v229
    v_cvt_pk_bf16_f32 v182, v38, v42
    v_mfma_f32_16x16x32_bf16 v[60:63], v[192:195], a[164:167], v[60:63]
    s_waitcnt lgkmcnt(3)
    v_mul_f32 v18, v12, v242
    v_cvt_pk_bf16_f32 v184, v23, v27
    v_mfma_f32_16x16x32_bf16 v[68:71], v[192:195], a[236:239], v[68:71]
    v_mul_f32 v19, v12, v243
    v_mul_f32 v17, v12, v241
    v_exp_f32 v227, v227
    v_mul_f32 v16, v12, v240
    v_pk_fma_f32 v[60:61], v[60:61], v[240:241], v[16:17] neg_lo:[0,0,1] neg_hi:[0,0,1]
    v_cvt_pk_bf16_f32 v181, v30, v34
    v_pk_fma_f32 v[64:65], v[64:65], v[240:241], v[16:17] neg_lo:[0,0,1] neg_hi:[0,0,1]
    v_pk_fma_f32 v[54:55], v[54:55], v[242:243], v[18:19] neg_lo:[0,0,1] neg_hi:[0,0,1]
    v_pk_fma_f32 v[68:69], v[68:69], v[240:241], v[16:17] neg_lo:[0,0,1] neg_hi:[0,0,1]
    v_pk_fma_f32 v[72:73], v[72:73], v[240:241], v[16:17] neg_lo:[0,0,1] neg_hi:[0,0,1]
    v_pk_fma_f32 v[56:57], v[56:57], v[240:241], v[16:17] neg_lo:[0,0,1] neg_hi:[0,0,1]
    v_pk_fma_f32 v[70:71], v[70:71], v[242:243], v[18:19] neg_lo:[0,0,1] neg_hi:[0,0,1]
    v_pk_fma_f32 v[78:79], v[78:79], v[242:243], v[18:19] neg_lo:[0,0,1] neg_hi:[0,0,1]
    v_pk_fma_f32 v[58:59], v[58:59], v[242:243], v[18:19] neg_lo:[0,0,1] neg_hi:[0,0,1]
    v_pk_fma_f32 v[74:75], v[74:75], v[242:243], v[18:19] neg_lo:[0,0,1] neg_hi:[0,0,1]
    v_pk_fma_f32 v[80:81], v[80:81], v[240:241], v[16:17] neg_lo:[0,0,1] neg_hi:[0,0,1]
    v_pk_fma_f32 v[62:63], v[62:63], v[242:243], v[18:19] neg_lo:[0,0,1] neg_hi:[0,0,1]
    v_pk_fma_f32 v[82:83], v[82:83], v[242:243], v[18:19] neg_lo:[0,0,1] neg_hi:[0,0,1]
    v_pk_fma_f32 v[76:77], v[76:77], v[240:241], v[16:17] neg_lo:[0,0,1] neg_hi:[0,0,1]
    v_pk_fma_f32 v[52:53], v[52:53], v[240:241], v[16:17] neg_lo:[0,0,1] neg_hi:[0,0,1]
    v_pk_fma_f32 v[66:67], v[66:67], v[242:243], v[18:19] neg_lo:[0,0,1] neg_hi:[0,0,1]
    v_mfma_f32_16x16x32_bf16 v[136:139], v[208:211], a[184:187], v[136:139]
    s_or_b64 s[44:45], s[44:45], s[46:47]
    ds_write_b64 v6, v[180:181] offset:2176
    v_mfma_f32_16x16x32_bf16 v[176:179], v[212:215], a[204:207], v[176:179]
    v_exp_f32 v222, v222
    v_mfma_f32_16x16x32_bf16 v[144:147], v[204:207], a[204:207], v[144:147]
    ds_read_b128 a[60:63], v5 offset:13248
    v_cvt_pk_bf16_f32 v188, v52, v56
    v_mfma_f32_16x16x32_bf16 v[144:147], v[208:211], a[200:203], v[144:147]
    v_exp_f32 v224, v224
    v_mfma_f32_16x16x32_bf16 v[232:235], a[140:143], a[76:79], v[252:255]
    v_exp_f32 v220, v220
    v_mfma_f32_16x16x32_bf16 v[232:235], a[136:139], a[72:75], v[232:235]
    s_sub_u32 s20, s20, 8192
    v_cvt_pk_bf16_f32 v189, v60, v64
    v_cvt_pk_bf16_f32 v201, v230, v231
    v_mfma_f32_16x16x32_bf16 v[232:235], a[132:135], a[68:71], v[232:235]
    s_max_i32 s6, s20, 0
    ds_read_b128 a[44:47], v5 offset:8896
    v_accvgpr_write_b32 a209, 0
    v_mfma_f32_16x16x32_bf16 v[232:235], a[128:131], a[64:67], v[232:235]
    v_exp_f32 v225, v225
    v_smfmac_f32_16x16x64_bf16 a[216:219], a[228:231], v[196:203], v10
    s_add_u32 m0, s25, 24960
    ds_write_b64 v6, v[188:189] offset:4352
    v_mfma_f32_16x16x32_bf16 v[104:107], v[200:203], a[240:243], v[104:107]
    buffer_load_dwordx4 v4, s[8:11], 0 offen nt lds
    ds_write_b64 v6, v[182:183] offset:2304
    v_mfma_f32_16x16x32_bf16 v[140:143], v[208:211], a[192:195], v[140:143]
    v_exp_f32 v232, v232
    v_mfma_f32_16x16x32_bf16 v[140:143], v[204:207], a[196:199], v[140:143]
    ds_write_b64 v6, v[184:185] offset:3264
    v_cvt_pk_bf16_f32 v208, v220, v221
    v_mfma_f32_16x16x32_bf16 v[228:231], a[112:115], a[64:67], v[252:255]
    v_cvt_pk_bf16_f32 v189, v62, v66
    v_cvt_pk_bf16_f32 v194, v69, v73
    v_mfma_f32_16x16x32_bf16 v[228:231], a[116:119], a[68:71], v[228:231]
    s_add_u32 m0, s25, 24976
    v_cvt_pk_bf16_f32 v195, v77, v81
    v_cvt_pk_bf16_f32 v191, v76, v80
    v_mfma_f32_16x16x32_bf16 v[228:231], a[120:123], a[72:75], v[228:231]
    ds_read_b128 a[72:75], v5 offset:17536
    v_cvt_pk_bf16_f32 v192, v53, v57
    v_mfma_f32_16x16x32_bf16 v[228:231], a[124:127], a[76:79], v[228:231]
    buffer_load_dwordx4 v4, s[8:11], 0 offen offset:1024 nt lds
    v_cvt_pk_bf16_f32 v190, v68, v72
    v_exp_f32 v226, v226
    v_mfma_f32_16x16x32_bf16 v[132:135], v[204:207], a[180:183], v[132:135]
    ds_read_b128 a[48:51], v5 offset:13056
    v_cmp_ngt_f32 s[46:47], s39, v13
    v_mfma_f32_16x16x32_bf16 v[88:91], v[200:203], a[156:159], v[88:91]
    v_accvgpr_read_b32 v13, a216
    v_cvt_pk_bf16_f32 v188, v54, v58
    v_mfma_f32_16x16x32_bf16 v[88:91], v[196:199], a[152:155], v[88:91]
    ds_read_b128 a[140:143], v1 offset:9152
    v_cvt_pk_bf16_f32 v193, v61, v65
    v_mfma_f32_16x16x32_bf16 v[112:115], v[200:203], a[248:251], v[112:115]
    ds_write_b64 v6, v[190:191] offset:4480
    v_mfma_f32_16x16x32_bf16 v[116:119], v[204:207], a[144:147], v[116:119]
    s_add_u32 s8, s8, 8320
    v_accvgpr_read_b32 v14, a217
    v_add_f32 v13, v13, v14
    v_mfma_f32_16x16x32_bf16 v[84:87], v[200:203], a[148:151], v[84:87]
    ds_write_b64 v6, v[192:193] offset:5440
    v_cvt_pk_bf16_f32 v210, v224, v225
    v_cvt_pk_bf16_f32 v209, v222, v223
    v_mfma_f32_16x16x32_bf16 v[108:111], v[200:203], a[244:247], v[108:111]
    s_addc_u32 s9, s9, 0
    ds_read_b128 a[76:79], v5 offset:17600
    v_rcp_f32 v14, v13
    v_mfma_f32_16x16x32_bf16 v[100:103], v[200:203], a[236:239], v[100:103]
    s_sub_u32 s21, s21, 8320
    v_cvt_pk_bf16_f32 v192, v55, v59
    v_cvt_pk_bf16_f32 v193, v63, v67
    v_mfma_f32_16x16x32_bf16 v[20:23], a[80:83], a[0:3], 0
    ds_read_b64_tr_b16 a[204:205], v2 offset:4208
    v_cvt_pk_bf16_f32 v211, v226, v227
    v_mfma_f32_16x16x32_bf16 v[20:23], a[84:87], a[4:7], v[20:23]
    s_max_i32 s10, s21, 0
    v_exp_f32 v230, v230
    v_mfma_f32_16x16x32_bf16 v[164:167], v[216:219], a[176:179], v[164:167]
    s_or_b64 s[44:45], s[44:45], s[46:47]
    ds_write_b32 v8, v14
    ds_read_b128 v[244:247], v9
    v_mfma_f32_16x16x32_bf16 v[132:135], v[208:211], a[236:239], v[132:135]
    v_exp_f32 v228, v228
    v_smfmac_f32_16x16x64_bf16 a[220:223], a[228:231], v[204:211], v10
    ds_write_b64 v6, v[194:195] offset:5568
    v_mfma_f32_16x16x32_bf16 v[96:99], v[200:203], a[172:175], v[96:99]
    v_exp_f32 v229, v229
    v_mfma_f32_16x16x32_bf16 v[96:99], v[196:199], a[168:171], v[96:99]
    ds_read_b128 a[52:55], v5 offset:13120
    v_cvt_pk_bf16_f32 v186, v39, v43
    v_mfma_f32_16x16x32_bf16 v[24:27], a[108:111], a[12:15], 0
    v_exp_f32 v231, v231
    v_mfma_f32_16x16x32_bf16 v[128:131], v[208:211], a[172:175], v[128:131]
    ds_read_b128 a[136:139], v1 offset:9088
    v_cmp_ngt_f32 s[46:47], s39, v13
    v_mfma_f32_16x16x32_bf16 v[128:131], v[204:207], a[168:171], v[128:131]
    ds_read_b128 a[132:135], v1 offset:9024
    v_accvgpr_read_b32 v13, a220
    v_mfma_f32_16x16x32_bf16 v[20:23], a[88:91], a[8:11], v[20:23]
    ds_read_b128 a[128:131], v1 offset:8960
    v_cvt_pk_bf16_f32 v195, v79, v83
    v_mfma_f32_16x16x32_bf16 v[20:23], a[92:95], a[12:15], v[20:23]
    ds_write_b64 v6, v[188:189] offset:6528
    v_mfma_f32_16x16x32_bf16 v[176:179], v[216:219], a[200:203], v[176:179]
    s_waitcnt lgkmcnt(6)
    v_mul_f32 v16, v12, v244
    v_accvgpr_read_b32 v14, a221
    v_mfma_f32_16x16x32_bf16 v[92:95], v[196:199], a[160:163], v[92:95]
    ds_read_b128 a[64:67], v5 offset:17408
    v_add_f32 v13, v13, v14
    v_mfma_f32_16x16x32_bf16 v[92:95], v[200:203], a[164:167], v[92:95]
    s_or_b64 s[44:45], s[44:45], s[46:47]
    v_cvt_pk_bf16_f32 v191, v78, v82
    v_mul_f32 v17, v12, v245
    v_accvgpr_write_b32 a221, 0
    v_mul_f32 v18, v12, v246
    v_mul_f32 v19, v12, v247
    v_pk_fma_f32 v[106:107], v[106:107], v[246:247], v[18:19] neg_lo:[0,0,1] neg_hi:[0,0,1]
    v_pk_fma_f32 v[104:105], v[104:105], v[244:245], v[16:17] neg_lo:[0,0,1] neg_hi:[0,0,1]
    v_pk_fma_f32 v[112:113], v[112:113], v[244:245], v[16:17] neg_lo:[0,0,1] neg_hi:[0,0,1]
    v_pk_fma_f32 v[96:97], v[96:97], v[244:245], v[16:17] neg_lo:[0,0,1] neg_hi:[0,0,1]
    v_pk_fma_f32 v[108:109], v[108:109], v[244:245], v[16:17] neg_lo:[0,0,1] neg_hi:[0,0,1]
    v_pk_fma_f32 v[92:93], v[92:93], v[244:245], v[16:17] neg_lo:[0,0,1] neg_hi:[0,0,1]
    v_pk_fma_f32 v[100:101], v[100:101], v[244:245], v[16:17] neg_lo:[0,0,1] neg_hi:[0,0,1]
    v_pk_fma_f32 v[84:85], v[84:85], v[244:245], v[16:17] neg_lo:[0,0,1] neg_hi:[0,0,1]
    v_rcp_f32 v14, v13
    v_pk_fma_f32 v[110:111], v[110:111], v[246:247], v[18:19] neg_lo:[0,0,1] neg_hi:[0,0,1]
    v_mfma_f32_16x16x32_bf16 v[168:171], v[212:215], a[188:191], v[168:171]
    ds_read_b64_tr_b16 a[188:189], v2 offset:4176
    v_cvt_pk_bf16_f32 v197, v92, v96
    v_mfma_f32_16x16x32_bf16 v[168:171], v[216:219], a[184:187], v[168:171]
    ds_write_b32 v8, v14
    ds_read_b128 v[248:251], v9
    v_exp_f32 v233, v233
    v_pk_fma_f32 v[90:91], v[90:91], v[246:247], v[18:19] neg_lo:[0,0,1] neg_hi:[0,0,1]
    v_pk_fma_f32 v[102:103], v[102:103], v[246:247], v[18:19] neg_lo:[0,0,1] neg_hi:[0,0,1]
    v_pk_fma_f32 v[88:89], v[88:89], v[244:245], v[16:17] neg_lo:[0,0,1] neg_hi:[0,0,1]
    v_mfma_f32_16x16x32_bf16 v[124:127], v[204:207], a[160:163], v[124:127]
    ds_read_b128 a[124:127], v1 offset:8640
    v_cvt_pk_bf16_f32 v190, v70, v74
    v_mfma_f32_16x16x32_bf16 v[124:127], v[208:211], a[164:167], v[124:127]
    v_cvt_pk_bf16_f32 v199, v108, v112
    v_cvt_pk_bf16_f32 v194, v71, v75
    v_cvt_pk_bf16_f32 v196, v84, v88
    v_mfma_f32_16x16x32_bf16 v[164:167], v[212:215], a[180:183], v[164:167]
    ds_write_b64 v6, v[196:197] offset:8704
    v_mfma_f32_16x16x32_bf16 v[172:175], v[216:219], a[192:195], v[172:175]
    v_cvt_pk_bf16_f32 v216, v228, v229
    v_cvt_pk_bf16_f32 v218, v232, v233
    v_mfma_f32_16x16x32_bf16 v[172:175], v[212:215], a[196:199], v[172:175]
    ds_read_b64_tr_b16 a[182:183], v2 offset:4672
    ds_write_b64 v6, v[190:191] offset:6656
    v_mfma_f32_16x16x32_bf16 v[24:27], a[104:107], a[8:11], v[24:27]
    v_exp_f32 v235, v235
    v_mfma_f32_16x16x32_bf16 v[24:27], a[100:103], a[4:7], v[24:27]
    v_exp_f32 v234, v234
    v_mfma_f32_16x16x32_bf16 v[24:27], a[96:99], a[0:3], v[24:27]
    ds_write_b64 v6, v[192:193] offset:7616
    v_mfma_f32_16x16x32_bf16 v[28:31], a[80:83], a[16:19], 0
    s_waitcnt lgkmcnt(5)
    v_mul_f32 v17, v12, v249
    v_cvt_pk_bf16_f32 v198, v100, v104
    v_max3_f32 v11, v20, v21, v22
    v_mul_f32 v16, v12, v248
    v_mfma_f32_16x16x32_bf16 v[136:139], v[208:211], a[240:243], v[136:139]
    ds_write_b64 v6, v[194:195] offset:7744
    v_max3_f32 v11, v11, v26, v27
    v_max3_f32 v0, v23, v24, v25
    v_max_f32 v11, v11, v0
    v_mov_b32 v0, v11
    v_pk_fma_f32 v[98:99], v[98:99], v[246:247], v[18:19] neg_lo:[0,0,1] neg_hi:[0,0,1]
    v_mfma_f32_16x16x32_bf16 v[140:143], v[208:211], a[244:247], v[140:143]
    v_permlane32_swap_b32 v11, v0
    v_max_f32 v11, v11, v0
    v_mfma_f32_16x16x32_bf16 v[116:119], v[208:211], a[148:151], v[116:119]
    ds_read_b64_tr_b16 a[196:197], v2 offset:4192
    v_cmp_ngt_f32 s[46:47], s39, v13
    v_mfma_f32_16x16x32_bf16 v[32:35], a[108:111], a[28:31], 0
    v_cvt_pk_bf16_f32 v200, v85, v89
    v_mov_b32 v0, v11
    v_mfma_f32_16x16x32_bf16 v[32:35], a[104:107], a[24:27], v[32:35]
    v_cvt_pk_bf16_f32 v217, v230, v231
    v_cvt_pk_bf16_f32 v201, v93, v97
    v_mfma_f32_16x16x32_bf16 v[32:35], a[100:103], a[20:23], v[32:35]
    ds_read_b64_tr_b16 v[96:97], v2 offset:4192
    ds_read_b128 a[112:115], v1 offset:8448
    v_mfma_f32_16x16x32_bf16 v[32:35], a[96:99], a[16:19], v[32:35]
    s_waitcnt vmcnt(9)
    ds_read_b128 a[56:59], v5 offset:13184
    v_permlane16_swap_b32 v11, v0
    v_max_f32 v11, v11, v0
    v_mfma_f32_16x16x32_bf16 v[144:147], v[208:211], a[248:251], v[144:147]
    v_cvt_pk_bf16_f32 v219, v234, v235
    v_sub_f32 v236, s3, v11
    v_cvt_pk_bf16_f32 v203, v109, v113
    v_smfmac_f32_16x16x64_bf16 a[224:227], a[228:231], v[212:219], v10
    ds_write_b64 v6, v[198:199] offset:8832
    v_sub_f32 v239, s3, v11
    v_cvt_pk_bf16_f32 v202, v101, v105
    v_pk_fma_f32 v[128:129], v[128:129], v[248:249], v[16:17] neg_lo:[0,0,1] neg_hi:[0,0,1]
    v_pk_fma_f32 v[86:87], v[86:87], v[246:247], v[18:19] neg_lo:[0,0,1] neg_hi:[0,0,1]
    v_sub_f32 v237, s3, v11
    v_pk_add_f32 v[24:25], v[24:25], v[236:237]
    v_pk_fma_f32 v[144:145], v[144:145], v[248:249], v[16:17] neg_lo:[0,0,1] neg_hi:[0,0,1]
    v_mfma_f32_16x16x32_bf16 v[120:123], v[208:211], a[156:159], v[120:123]
    ds_read_b64_tr_b16 a[180:181], v2 offset:4160
    ds_read_b128 a[120:123], v1 offset:8576
    v_mfma_f32_16x16x32_bf16 v[120:123], v[204:207], a[152:155], v[120:123]
    ds_read_b64_tr_b16 a[198:199], v2 offset:4704
    v_cvt_pk_bf16_f32 v198, v102, v106
    v_mfma_f32_16x16x32_bf16 v[160:163], v[216:219], a[172:175], v[160:163]
    ds_read_b64_tr_b16 a[206:207], v2 offset:4720
    v_accvgpr_read_b32 v14, a225
    v_mfma_f32_16x16x32_bf16 v[160:163], v[212:215], a[168:171], v[160:163]
    ds_read_b64_tr_b16 v[92:93], v2 offset:4160
    ds_write_b64 v6, v[200:201] offset:9792
L_pad4:
    s_cbranch_execz L_pad7
    v_accvgpr_read_b32 v13, a224
    v_cvt_pk_bf16_f32 v196, v86, v90
    v_pk_add_f32 v[26:27], v[26:27], v[236:237]
    v_exp_f32 v26, v26
    v_add_f32 v13, v13, v14
    v_pk_add_f32 v[22:23], v[22:23], v[236:237]
    v_pk_fma_f32 v[120:121], v[120:121], v[248:249], v[16:17] neg_lo:[0,0,1] neg_hi:[0,0,1]
    v_pk_fma_f32 v[114:115], v[114:115], v[246:247], v[18:19] neg_lo:[0,0,1] neg_hi:[0,0,1]
    v_pk_fma_f32 v[94:95], v[94:95], v[246:247], v[18:19] neg_lo:[0,0,1] neg_hi:[0,0,1]
    v_cvt_pk_bf16_f32 v197, v94, v98
    v_mul_f32 v19, v12, v251
    v_pk_fma_f32 v[116:117], v[116:117], v[248:249], v[16:17] neg_lo:[0,0,1] neg_hi:[0,0,1]
    v_mfma_f32_16x16x32_bf16 v[168:171], v[216:219], a[240:243], v[168:171]
    ds_write_b64 v6, v[202:203] offset:9920
    v_mul_f32 v18, v12, v250
    v_rcp_f32 v14, v13
    v_cvt_pk_bf16_f32 v201, v95, v99
    v_pk_fma_f32 v[122:123], v[122:123], v[250:251], v[18:19] neg_lo:[0,0,1] neg_hi:[0,0,1]
    v_pk_fma_f32 v[130:131], v[130:131], v[250:251], v[18:19] neg_lo:[0,0,1] neg_hi:[0,0,1]
    v_pk_fma_f32 v[118:119], v[118:119], v[250:251], v[18:19] neg_lo:[0,0,1] neg_hi:[0,0,1]
    v_pk_add_f32 v[20:21], v[20:21], v[236:237]
    v_cvt_pk_bf16_f32 v200, v87, v91
    v_cvt_pk_bf16_f32 v208, v117, v121
    v_pk_fma_f32 v[140:141], v[140:141], v[248:249], v[16:17] neg_lo:[0,0,1] neg_hi:[0,0,1]
    v_mfma_f32_16x16x32_bf16 v[28:31], a[84:87], a[20:23], v[28:31]
    v_exp_f32 v27, v27
    v_mfma_f32_16x16x32_bf16 v[28:31], a[88:91], a[24:27], v[28:31]
    ds_read_b64_tr_b16 v[94:95], v2 offset:4176
    ds_read_b128 a[116:119], v1 offset:8512
    v_mfma_f32_16x16x32_bf16 v[28:31], a[92:95], a[28:31], v[28:31]
    ds_write_b32 v8, v14
    v_sub_f32 v238, s3, v11
    v_exp_f32 v21, v21
    v_mfma_f32_16x16x32_bf16 v[156:159], v[212:215], a[160:163], v[156:159]
    ds_read_b128 v[252:255], v9
    v_cvt_pk_bf16_f32 v187, v47, v51
    v_mfma_f32_16x16x32_bf16 v[156:159], v[216:219], a[164:167], v[156:159]
    s_or_b64 s[44:45], s[44:45], s[46:47]
    ds_read_b64_tr_b16 a[190:191], v2 offset:4688
    ds_read_b64_tr_b16 v[98:99], v2 offset:4208
    ds_write_b64 v6, v[196:197] offset:10880
    v_pk_fma_f32 v[124:125], v[124:125], v[248:249], v[16:17] neg_lo:[0,0,1] neg_hi:[0,0,1]
    v_pk_fma_f32 v[138:139], v[138:139], v[250:251], v[18:19] neg_lo:[0,0,1] neg_hi:[0,0,1]
    v_pk_fma_f32 v[142:143], v[142:143], v[250:251], v[18:19] neg_lo:[0,0,1] neg_hi:[0,0,1]
    v_pk_fma_f32 v[132:133], v[132:133], v[248:249], v[16:17] neg_lo:[0,0,1] neg_hi:[0,0,1]
    v_pk_fma_f32 v[136:137], v[136:137], v[248:249], v[16:17] neg_lo:[0,0,1] neg_hi:[0,0,1]
    v_cvt_pk_bf16_f32 v209, v125, v129
    v_cmp_ngt_f32 s[46:47], s39, v13
    v_max3_f32 v11, v28, v29, v30
    v_max3_f32 v11, v11, v34, v35
    v_cvt_pk_bf16_f32 v202, v103, v107
    v_mfma_f32_16x16x32_bf16 v[164:167], v[216:219], a[236:239], v[164:167]
    ds_write_b64 v6, v[186:187] offset:3392
    v_max3_f32 v0, v31, v32, v33
    v_cvt_pk_bf16_f32 v204, v116, v120
    v_mfma_f32_16x16x32_bf16 v[176:179], v[216:219], a[248:251], v[176:179]
    ds_read_b128 a[68:71], v5 offset:17472
    v_cvt_pk_bf16_f32 v199, v110, v114
    v_mfma_f32_16x16x32_bf16 v[148:151], v[212:215], a[144:147], v[148:151]
    v_cvt_pk_bf16_f32 v205, v124, v128
    v_accvgpr_write_b32 a216, 0
    v_mfma_f32_16x16x32_bf16 v[148:151], v[216:219], a[148:151], v[148:151]
    s_waitcnt lgkmcnt(3)
    s_barrier
    ds_read_b64_tr_b16 v[90:91], v2 offset:8368
    ds_read_b64_tr_b16 a[164:165], v2 offset:12512
    ds_write_b64 v6, v[204:205] offset:13056
    v_cvt_pk_bf16_f32 v211, v141, v145
    v_mul_f32 v17, v12, v253
    v_mul_f32 v16, v12, v252
    v_pk_fma_f32 v[148:149], v[148:149], v[252:253], v[16:17] neg_lo:[0,0,1] neg_hi:[0,0,1]
    v_pk_fma_f32 v[126:127], v[126:127], v[250:251], v[18:19] neg_lo:[0,0,1] neg_hi:[0,0,1]
    v_cvt_pk_bf16_f32 v204, v118, v122
    v_exp_f32 v24, v24
    v_exp_f32 v22, v22
    v_pk_fma_f32 v[134:135], v[134:135], v[250:251], v[18:19] neg_lo:[0,0,1] neg_hi:[0,0,1]
    v_pk_fma_f32 v[160:161], v[160:161], v[252:253], v[16:17] neg_lo:[0,0,1] neg_hi:[0,0,1]
    v_max_f32 v11, v11, v0
    v_pk_fma_f32 v[168:169], v[168:169], v[252:253], v[16:17] neg_lo:[0,0,1] neg_hi:[0,0,1]
    v_mov_b32 v0, v11
    v_pk_fma_f32 v[146:147], v[146:147], v[250:251], v[18:19] neg_lo:[0,0,1] neg_hi:[0,0,1]
    v_mfma_f32_16x16x32_bf16 v[172:175], v[216:219], a[244:247], v[172:175]
    v_permlane32_swap_b32 v11, v0
    v_max_f32 v11, v11, v0
    v_exp_f32 v23, v23
    v_mov_b32 v0, v11
    v_mfma_f32_16x16x32_bf16 v[228:231], a[112:115], a[0:3], v[236:239]
    v_max_f32 v94, abs(v94), abs(v95)
    v_max_f32 v92, abs(v92), abs(v93)
    v_mfma_f32_16x16x32_bf16 v[228:231], a[116:119], a[4:7], v[228:231]
    v_cvt_pk_bf16_f32 v206, v132, v136
    v_cvt_pk_bf16_f32 v207, v140, v144
    v_mfma_f32_16x16x32_bf16 v[228:231], a[120:123], a[8:11], v[228:231]
    ds_write_b64 v6, v[206:207] offset:13184
    v_cvt_pk_bf16_f32 v206, v134, v138
    v_permlane16_swap_b32 v11, v0
    v_mfma_f32_16x16x32_bf16 v[232:235], a[140:143], a[12:15], v[236:239]
    v_cvt_pk_bf16_f32 v203, v111, v115
    v_max_f32 v11, v11, v0
    v_mfma_f32_16x16x32_bf16 v[232:235], a[136:139], a[8:11], v[232:235]
    v_exp_f32 v20, v20
    v_mfma_f32_16x16x32_bf16 v[232:235], a[132:135], a[4:7], v[232:235]
    s_waitcnt lgkmcnt(3)
    v_max_f32 v90, abs(v90), abs(v91)
    v_max_f32 v96, abs(v96), abs(v97)
    v_mfma_f32_16x16x32_bf16 v[232:235], a[128:131], a[0:3], v[232:235]
    ds_write_b64 v6, v[198:199] offset:11008
    v_sub_f32 v240, s3, v11
    v_sub_f32 v241, s3, v11
    v_cvt_pk_bf16_f32 v183, v26, v27
    v_cvt_pk_bf16_f32 v181, v22, v23
    v_pk_add_f32 v[34:35], v[34:35], v[240:241]
    v_pk_add_f32 v[32:33], v[32:33], v[240:241]
    v_pk_add_f32 v[28:29], v[28:29], v[240:241]
    v_cvt_pk_bf16_f32 v210, v133, v137
    v_mfma_f32_16x16x32_bf16 v[152:155], v[216:219], a[156:159], v[152:155]
    v_exp_f32 v29, v29
    v_mfma_f32_16x16x32_bf16 v[152:155], v[212:215], a[152:155], v[152:155]
    ds_write_b64 v6, v[208:209] offset:14144
    v_max_f32 v98, abs(v98), abs(v99)
    v_exp_f32 v25, v25
    v_pk_fma_f32 v[164:165], v[164:165], v[252:253], v[16:17] neg_lo:[0,0,1] neg_hi:[0,0,1]
    v_mfma_f32_16x16x32_bf16 v[228:231], a[124:127], a[12:15], v[228:231]
    ds_write_b64 v6, v[200:201] offset:11968
    v_cvt_pk_bf16_f32 v180, v20, v21
    v_mfma_f32_16x16x32_bf16 v[20:23], a[80:83], a[32:35], 0
    v_cvt_pk_bf16_f32 v214, v164, v168
    v_sub_f32 v243, s3, v11
    v_mfma_f32_16x16x32_bf16 v[20:23], a[84:87], a[36:39], v[20:23]
    v_cvt_pk_bf16_f32 v205, v126, v130
    v_sub_f32 v242, s3, v11
    v_mfma_f32_16x16x32_bf16 v[20:23], a[88:91], a[40:43], v[20:23]
    v_exp_f32 v33, v33
    v_mfma_f32_16x16x32_bf16 v[20:23], a[92:95], a[44:47], v[20:23]
    ds_read_b64_tr_b16 v[88:89], v2 offset:8352
    v_cvt_pk_bf16_f32 v209, v127, v131
    v_cvt_pk_bf16_f32 v182, v24, v25
    v_mfma_f32_16x16x32_bf16 v[24:27], a[108:111], a[44:47], 0
    s_or_b64 s[44:45], s[44:45], s[46:47]
    ds_read_b64_tr_b16 v[84:85], v2 offset:8320
    v_cvt_pk_bf16_f32 v207, v142, v146
    v_mfma_f32_16x16x32_bf16 v[24:27], a[104:107], a[40:43], v[24:27]
    ds_read_b64_tr_b16 a[166:167], v2 offset:13024
    ds_read_b64_tr_b16 a[154:155], v2 offset:8848
    v_mfma_f32_16x16x32_bf16 v[24:27], a[100:103], a[36:39], v[24:27]
    v_mul_f32 v19, v12, v255
    v_mul_f32 v18, v12, v254
    v_mfma_f32_16x16x32_bf16 v[24:27], a[96:99], a[32:35], v[24:27]
    ds_read_b64_tr_b16 a[148:149], v2 offset:12480
    ds_read_b64_tr_b16 v[86:87], v2 offset:8336
    ds_write_b64 v6, v[202:203] offset:12096
    v_pk_add_f32 v[30:31], v[30:31], v[240:241]
    v_exp_f32 v31, v31
    v_mfma_f32_16x16x32_bf16 v[220:223], a[112:115], a[16:19], v[240:243]
    v_exp_f32 v232, v232
    v_mfma_f32_16x16x32_bf16 v[220:223], a[116:119], a[20:23], v[220:223]
    v_exp_f32 v34, v34
    v_mfma_f32_16x16x32_bf16 v[220:223], a[120:123], a[24:27], v[220:223]
    s_add_u32 m0, s24, 8448
    ds_write_b64 v6, v[210:211] offset:14272
    buffer_load_dwordx4 v3, s[4:7], 0 offen nt lds
    v_exp_f32 v30, v30
    v_exp_f32 v35, v35
    v_max3_f32 v11, v20, v21, v22
    v_cvt_pk_bf16_f32 v191, v34, v35
    v_pk_fma_f32 v[152:153], v[152:153], v[252:253], v[16:17] neg_lo:[0,0,1] neg_hi:[0,0,1]
    v_max3_f32 v0, v23, v24, v25
    v_max3_f32 v11, v11, v26, v27
    v_pk_fma_f32 v[174:175], v[174:175], v[254:255], v[18:19] neg_lo:[0,0,1] neg_hi:[0,0,1]
    v_pk_fma_f32 v[156:157], v[156:157], v[252:253], v[16:17] neg_lo:[0,0,1] neg_hi:[0,0,1]
    v_mfma_f32_16x16x32_bf16 v[224:227], a[140:143], a[28:31], v[240:243]
    s_waitcnt lgkmcnt(2)
    v_max_f32 v86, abs(v86), abs(v87)
    v_cvt_pk_bf16_f32 v213, v156, v160
    v_mfma_f32_16x16x32_bf16 v[224:227], a[136:139], a[24:27], v[224:227]
    s_add_u32 m0, s24, 8480
    ds_read_b64_tr_b16 a[172:173], v2 offset:12528
    v_max_f32 v11, v11, v0
    v_mfma_f32_16x16x32_bf16 v[224:227], a[132:135], a[20:23], v[224:227]
    v_max_f32 v84, abs(v84), abs(v85)
    v_mov_b32 v0, v11
    v_mfma_f32_16x16x32_bf16 v[224:227], a[128:131], a[16:19], v[224:227]
    ds_write_b64 v6, v[204:205] offset:15232
    v_permlane32_swap_b32 v11, v0
    v_pk_fma_f32 v[166:167], v[166:167], v[254:255], v[18:19] neg_lo:[0,0,1] neg_hi:[0,0,1]
    v_cvt_pk_bf16_f32 v212, v148, v152
    v_pk_fma_f32 v[176:177], v[176:177], v[252:253], v[16:17] neg_lo:[0,0,1] neg_hi:[0,0,1]
    v_max_f32 v88, abs(v88), abs(v89)
    v_min3_f32 v84, v84, v86, v88
    v_exp_f32 v28, v28
    v_pk_fma_f32 v[172:173], v[172:173], v[252:253], v[16:17] neg_lo:[0,0,1] neg_hi:[0,0,1]
    v_cvt_pk_bf16_f32 v215, v172, v176
    v_exp_f32 v233, v233
    v_accvgpr_write_b32 a217, 0
    v_max_f32 v11, v11, v0
    v_mov_b32 v0, v11
    v_min3_f32 v90, v90, v92, v94
    v_mfma_f32_16x16x32_bf16 v[220:223], a[124:127], a[28:31], v[220:223]
    ds_write_b64 v6, v[212:213] offset:17408
    buffer_load_dwordx4 v3, s[4:7], 0 offen offset:1024 nt lds
    v_cvt_pk_bf16_f32 v208, v119, v123
    v_permlane16_swap_b32 v11, v0
    v_max_f32 v11, v11, v0
    v_sub_f32 v244, s3, v11
    v_sub_f32 v245, s3, v11
    v_sub_f32 v246, s3, v11
    v_pk_fma_f32 v[178:179], v[178:179], v[254:255], v[18:19] neg_lo:[0,0,1] neg_hi:[0,0,1]
    v_cvt_pk_bf16_f32 v189, v30, v31
    v_pk_fma_f32 v[158:159], v[158:159], v[254:255], v[18:19] neg_lo:[0,0,1] neg_hi:[0,0,1]
    v_pk_add_f32 v[22:23], v[22:23], v[244:245]
    v_exp_f32 v22, v22
    v_pk_add_f32 v[24:25], v[24:25], v[244:245]
    v_min3_f32 v84, v84, v96, v98
    v_exp_f32 v221, v221
    v_pk_add_f32 v[20:21], v[20:21], v[244:245]
    v_exp_f32 v20, v20
    v_exp_f32 v21, v21
    v_exp_f32 v228, v228
    v_cvt_pk_bf16_f32 v188, v28, v29
    v_cvt_pk_bf16_f32 v196, v20, v21
    v_exp_f32 v234, v234
    v_pk_fma_f32 v[170:171], v[170:171], v[254:255], v[18:19] neg_lo:[0,0,1] neg_hi:[0,0,1]
    v_mfma_f32_16x16x32_bf16 v[28:31], a[80:83], a[48:51], 0
    v_exp_f32 v235, v235
    v_mfma_f32_16x16x32_bf16 v[28:31], a[84:87], a[52:55], v[28:31]
    v_exp_f32 v23, v23
    v_mfma_f32_16x16x32_bf16 v[28:31], a[88:91], a[56:59], v[28:31]
    v_min_f32 v84, v84, v90
    v_and_b32 v84, s58, v84
    v_mfma_f32_16x16x32_bf16 v[28:31], a[92:95], a[60:63], v[28:31]
    ds_write_b64 v6, v[214:215] offset:17536
    v_exp_f32 v227, v227
    v_sub_f32 v247, s3, v11
    v_pk_fma_f32 v[150:151], v[150:151], v[254:255], v[18:19] neg_lo:[0,0,1] neg_hi:[0,0,1]
    v_exp_f32 v32, v32
    v_exp_f32 v231, v231
    v_cvt_pk_bf16_f32 v215, v174, v178
    v_pk_add_f32 v[26:27], v[26:27], v[244:245]
    v_pk_fma_f32 v[154:155], v[154:155], v[254:255], v[18:19] neg_lo:[0,0,1] neg_hi:[0,0,1]
    v_exp_f32 v27, v27
    v_cvt_pk_bf16_f32 v190, v32, v33
    v_mfma_f32_16x16x32_bf16 v[32:35], a[108:111], a[60:63], 0
    v_exp_f32 v26, v26
    v_mfma_f32_16x16x32_bf16 v[32:35], a[104:107], a[56:59], v[32:35]
    v_cvt_pk_bf16_f32 v186, v232, v233
    v_cvt_pk_bf16_f32 v187, v234, v235
    v_mfma_f32_16x16x32_bf16 v[32:35], a[100:103], a[52:55], v[32:35]
    v_accvgpr_write_b32 a224, 0
    v_cvt_pk_bf16_f32 v214, v166, v170
    v_mfma_f32_16x16x32_bf16 v[32:35], a[96:99], a[48:51], v[32:35]
    ds_write_b64 v6, v[206:207] offset:15360
    v_mfma_f32_16x16x32_bf16 v[232:235], a[140:143], a[44:47], v[244:247]
    v_exp_f32 v25, v25
    v_mfma_f32_16x16x32_bf16 v[232:235], a[136:139], a[40:43], v[232:235]
    v_cvt_pk_bf16_f32 v216, v149, v153
    v_cvt_pk_bf16_f32 v212, v150, v154
    v_mfma_f32_16x16x32_bf16 v[232:235], a[132:135], a[36:39], v[232:235]
    s_add_u32 s4, s4, 8192
    v_cvt_pk_bf16_f32 v211, v143, v147
    v_cvt_pk_bf16_f32 v217, v157, v161
    v_mfma_f32_16x16x32_bf16 v[232:235], a[128:131], a[32:35], v[232:235]
    ds_write_b64 v6, v[216:217] offset:18496
    v_exp_f32 v229, v229
    v_mov_b32 v85, v84
    v_max3_f32 v11, v28, v29, v30
    v_max3_f32 v0, v31, v32, v33
    v_max3_f32 v11, v11, v34, v35
    v_max_f32 v11, v11, v0
    v_permlane32_swap_b32 v84, v85
    v_mov_b32 v0, v11
    v_max_f32 v84, v84, v85
    v_exp_f32 v24, v24
    v_cvt_pk_bf16_f32 v197, v22, v23
    v_mov_b32 v85, v84
    v_permlane32_swap_b32 v11, v0
    v_exp_f32 v234, v234
    v_permlane16_swap_b32 v84, v85
    v_max_f32 v11, v11, v0
    v_mov_b32 v0, v11
    v_exp_f32 v224, v224
    v_exp_f32 v223, v223
    v_pk_fma_f32 v[162:163], v[162:163], v[254:255], v[18:19] neg_lo:[0,0,1] neg_hi:[0,0,1]
    v_exp_f32 v226, v226
    v_permlane16_swap_b32 v11, v0
    v_max_f32 v11, v11, v0
    v_sub_f32 v249, s3, v11
    v_cvt_pk_bf16_f32 v184, v228, v229
    v_cvt_pk_bf16_f32 v213, v158, v162
    v_sub_f32 v248, s3, v11
    v_pk_add_f32 v[30:31], v[30:31], v[248:249]
    v_cvt_pk_bf16_f32 v198, v24, v25
    v_exp_f32 v31, v31
    v_exp_f32 v220, v220
    v_pk_add_f32 v[28:29], v[28:29], v[248:249]
    v_exp_f32 v235, v235
    v_mfma_f32_16x16x32_bf16 v[20:23], a[80:83], a[64:67], 0
    v_exp_f32 v29, v29
    v_mfma_f32_16x16x32_bf16 v[20:23], a[84:87], a[68:71], v[20:23]
    v_exp_f32 v30, v30
    v_mfma_f32_16x16x32_bf16 v[20:23], a[88:91], a[72:75], v[20:23]
    s_addc_u32 s5, s5, 0
    v_exp_f32 v28, v28
    v_mfma_f32_16x16x32_bf16 v[20:23], a[92:95], a[76:79], v[20:23]
    ds_write_b64 v6, v[208:209] offset:16320
    v_cvt_pk_bf16_f32 v210, v135, v139
    v_exp_f32 v230, v230
    v_max_f32 v84, v84, v85
    v_mul_f32 v16, s59, v84
    v_sub_f32 v250, s3, v11
    v_cvt_pk_bf16_f32 v216, v151, v155
    v_cvt_pk_bf16_f32 v185, v230, v231
    v_pk_add_f32 v[34:35], v[34:35], v[248:249]
    v_mul_f32 v18, s59, v84
    v_mfma_f32_16x16x32_bf16 v[228:231], a[112:115], a[32:35], v[244:247]
    v_exp_f32 v222, v222
    v_mfma_f32_16x16x32_bf16 v[228:231], a[116:119], a[36:39], v[228:231]
    v_exp_f32 v225, v225
    v_mfma_f32_16x16x32_bf16 v[228:231], a[120:123], a[40:43], v[228:231]
    v_cvt_pk_bf16_f32 v199, v26, v27
    v_cvt_pk_bf16_f32 v219, v173, v177
    v_mfma_f32_16x16x32_bf16 v[228:231], a[124:127], a[44:47], v[228:231]
    v_cvt_pk_bf16_f32 v192, v220, v221
    v_mul_f32 v17, s59, v84
    v_mfma_f32_16x16x32_bf16 v[24:27], a[108:111], a[76:79], 0
    s_sub_u32 s20, s20, 8192
    v_cvt_pk_bf16_f32 v217, v159, v163
    v_mul_f32 v19, s59, v84
    v_mfma_f32_16x16x32_bf16 v[24:27], a[104:107], a[72:75], v[24:27]
    v_exp_f32 v35, v35
    v_mfma_f32_16x16x32_bf16 v[24:27], a[100:103], a[68:71], v[24:27]
    ds_read_b128 a[100:103], v1 offset:17472
    v_cvt_pk_bf16_f32 v218, v165, v169
    v_mfma_f32_16x16x32_bf16 v[24:27], a[96:99], a[64:67], v[24:27]
    ds_read_b64_tr_b16 a[150:151], v2 offset:12992
    ds_write_b64 v6, v[218:219] offset:18624
    v_sub_f32 v251, s3, v11
    v_max3_f32 v11, v20, v21, v22
    v_pk_add_f32 v[32:33], v[32:33], v[248:249]
    v_cvt_pk_bf16_f32 v203, v234, v235
    v_mfma_f32_16x16x32_bf16 v[40:43], v[180:183], a[188:191], v[16:19]
    ds_read_b64_tr_b16 a[160:161], v2 offset:8352
    ds_read_b128 a[104:107], v1 offset:17536
    v_max3_f32 v0, v23, v24, v25
    v_cvt_pk_bf16_f32 v219, v175, v179
    v_cvt_pk_bf16_f32 v194, v224, v225
    v_exp_f32 v233, v233
    v_mfma_f32_16x16x32_bf16 v[68:71], v[188:191], a[180:183], v[16:19]
    ds_read_b64_tr_b16 a[146:147], v2 offset:8832
    ds_read_b128 a[84:87], v1 offset:16960
    v_max3_f32 v11, v11, v26, v27
    v_mfma_f32_16x16x32_bf16 v[36:39], v[180:183], a[180:183], v[16:19]
    s_max_i32 s6, s20, 0
    v_cvt_pk_bf16_f32 v195, v226, v227
    v_max_f32 v11, v11, v0
    v_mov_b32 v0, v11
    v_exp_f32 v33, v33
    v_mfma_f32_16x16x32_bf16 v[100:103], v[196:199], a[180:183], v[16:19]
    v_permlane32_swap_b32 v11, v0
    v_mfma_f32_16x16x32_bf16 v[80:83], v[188:191], a[204:207], v[16:19]
    v_max_f32 v11, v11, v0
    v_accvgpr_write_b32 a220, 0
    v_mov_b32 v0, v11
    v_mfma_f32_16x16x32_bf16 v[72:75], v[188:191], a[188:191], v[16:19]
    s_add_u32 m0, s25, 0
    v_permlane16_swap_b32 v11, v0
    v_mfma_f32_16x16x32_bf16 v[44:47], v[180:183], a[196:199], v[16:19]
    ds_read_b128 a[88:91], v1 offset:17024
    v_exp_f32 v232, v232
    v_max3_f32 v11, v11, v0, s55
    v_exp_f32 v231, v231
    v_sub_f32 v252, s3, v11
    v_sub_f32 v253, s3, v11
    v_pk_add_f32 v[26:27], v[26:27], v[252:253]
    v_cvt_pk_bf16_f32 v193, v222, v223
    v_sub_f32 v255, s3, v11
    v_pk_add_f32 v[22:23], v[22:23], v[252:253]
    v_pk_add_f32 v[20:21], v[20:21], v[252:253]
    v_exp_f32 v26, v26
    v_mfma_f32_16x16x32_bf16 v[108:111], v[196:199], a[196:199], v[16:19]
    ds_read_b128 a[92:95], v1 offset:17088
    v_exp_f32 v228, v228
    v_exp_f32 v21, v21
    v_cvt_pk_bf16_f32 v205, v30, v31
    v_pk_add_f32 v[24:25], v[24:25], v[252:253]
    v_exp_f32 v24, v24
    v_mfma_f32_16x16x32_bf16 v[76:79], v[188:191], a[196:199], v[16:19]
    v_exp_f32 v22, v22
    v_mfma_f32_16x16x32_bf16 v[220:223], a[112:115], a[48:51], v[248:251]
    v_exp_f32 v230, v230
    v_mfma_f32_16x16x32_bf16 v[220:223], a[116:119], a[52:55], v[220:223]
    v_exp_f32 v23, v23
    v_mfma_f32_16x16x32_bf16 v[220:223], a[120:123], a[56:59], v[220:223]
    v_exp_f32 v32, v32
    v_mfma_f32_16x16x32_bf16 v[220:223], a[124:127], a[60:63], v[220:223]
    ds_write_b64 v6, v[212:213] offset:19584
    v_mfma_f32_16x16x32_bf16 v[224:227], a[140:143], a[60:63], v[248:251]
    v_cvt_pk_bf16_f32 v204, v28, v29
    v_cvt_pk_bf16_f32 v213, v22, v23
    v_mfma_f32_16x16x32_bf16 v[224:227], a[136:139], a[56:59], v[224:227]
    v_exp_f32 v34, v34
    v_mfma_f32_16x16x32_bf16 v[224:227], a[132:135], a[52:55], v[224:227]
    ds_read_b64_tr_b16 a[156:157], v2 offset:12496
    v_accvgpr_write_b32 a225, 0
    v_mfma_f32_16x16x32_bf16 v[224:227], a[128:131], a[48:51], v[224:227]
    ds_read_b64_tr_b16 a[152:153], v2 offset:8336
    buffer_load_dwordx4 v4, s[8:11], 0 offen nt lds
    v_exp_f32 v229, v229
    v_cvt_pk_bf16_f32 v206, v32, v33
    v_mfma_f32_16x16x32_bf16 v[48:51], v[180:183], a[204:207], v[16:19]
    s_add_u32 m0, s25, 16
    ds_read_b64_tr_b16 a[158:159], v2 offset:13008
    buffer_load_dwordx4 v4, s[8:11], 0 offen offset:1024 nt lds
    v_exp_f32 v20, v20
    v_sub_f32 v254, s3, v11
    v_cvt_pk_bf16_f32 v202, v232, v233
    v_exp_f32 v25, v25
    v_exp_f32 v226, v226
    v_mfma_f32_16x16x32_bf16 v[104:107], v[196:199], a[188:191], v[16:19]
    ds_write_b64 v6, v[214:215] offset:19712
    v_mfma_f32_16x16x32_bf16 v[232:235], a[140:143], a[76:79], v[252:255]
    s_add_u32 s8, s8, 8064
    v_exp_f32 v221, v221
    v_mfma_f32_16x16x32_bf16 v[232:235], a[136:139], a[72:75], v[232:235]
    v_exp_f32 v223, v223
    v_mfma_f32_16x16x32_bf16 v[232:235], a[132:135], a[68:71], v[232:235]
    ds_read_b64_tr_b16 a[168:169], v2 offset:8368
    ds_read_b64_tr_b16 a[170:171], v2 offset:8880
    v_mfma_f32_16x16x32_bf16 v[232:235], a[128:131], a[64:67], v[232:235]
    s_addc_u32 s9, s9, 0
    v_cvt_pk_bf16_f32 v200, v228, v229
    v_cvt_pk_bf16_f32 v207, v34, v35
    v_cvt_pk_bf16_f32 v201, v230, v231
    v_exp_f32 v220, v220
    v_mfma_f32_16x16x32_bf16 v[228:231], a[112:115], a[64:67], v[252:255]
    ds_read_b128 a[80:83], v1 offset:16896
    v_cvt_pk_bf16_f32 v208, v220, v221
    v_mfma_f32_16x16x32_bf16 v[228:231], a[116:119], a[68:71], v[228:231]
    ds_read_b128 a[108:111], v1 offset:17600
    v_cvt_pk_bf16_f32 v214, v24, v25
    v_mfma_f32_16x16x32_bf16 v[228:231], a[120:123], a[72:75], v[228:231]
    v_exp_f32 v27, v27
    v_mfma_f32_16x16x32_bf16 v[228:231], a[124:127], a[76:79], v[228:231]
    ds_read_b64_tr_b16 a[144:145], v2 offset:8320
    ds_read_b128 a[96:99], v1 offset:17408
    v_cvt_pk_bf16_f32 v212, v20, v21
    v_mfma_f32_16x16x32_bf16 v[132:135], v[204:207], a[180:183], v[16:19]
    s_sub_u32 s21, s21, 8064
    ds_read_b64_tr_b16 a[174:175], v2 offset:13040
    v_cvt_pk_bf16_f32 v215, v26, v27
    v_mfma_f32_16x16x32_bf16 v[144:147], v[204:207], a[204:207], v[16:19]
    v_exp_f32 v224, v224
    v_mfma_f32_16x16x32_bf16 v[176:179], v[212:215], a[204:207], v[16:19]
    s_max_i32 s10, s21, 0
    ds_read_b64_tr_b16 a[162:163], v2 offset:8864
    v_exp_f32 v227, v227
    v_cvt_pk_bf16_f32 v218, v167, v171
    v_exp_f32 v225, v225
    v_mfma_f32_16x16x32_bf16 v[136:139], v[204:207], a[188:191], v[16:19]
    s_cmp_lg_u64 s[44:45], 0
    ds_write_b64 v6, v[210:211] offset:16448
    v_mfma_f32_16x16x32_bf16 v[168:171], v[212:215], a[188:191], v[16:19]
    v_exp_f32 v222, v222
    v_mfma_f32_16x16x32_bf16 v[172:175], v[212:215], a[196:199], v[16:19]
    s_cselect_b32 s34, 1, 0
    ds_write_b64 v6, v[216:217] offset:20672
    v_accvgpr_write_b32 a232, v16
    v_cvt_pk_bf16_f32 v209, v222, v223
    v_mfma_f32_16x16x32_bf16 v[164:167], v[212:215], a[180:183], v[16:19]
    ds_write_b64 v6, v[218:219] offset:20800
    v_mfma_f32_16x16x32_bf16 v[112:115], v[196:199], a[204:207], v[16:19]
    s_or_b32 s28, s28, s34
    v_cvt_pk_bf16_f32 v211, v226, v227
    v_cvt_pk_bf16_f32 v210, v224, v225
    v_mfma_f32_16x16x32_bf16 v[140:143], v[204:207], a[196:199], v[16:19]
    s_waitcnt vmcnt(8)
    s_waitcnt lgkmcnt(3)
    s_barrier
L_block2:
    v_mfma_f32_16x16x32_bf16 v[224:227], a[96:99], a[0:3], v[236:239]
    s_mov_b64 vcc, 64
    v_exp_f32 v228, v228
    v_mfma_f32_16x16x32_bf16 v[224:227], a[100:103], a[4:7], v[224:227]
    s_add_u32 m0, s24, 16896
    v_exp_f32 v229, v229
    v_mfma_f32_16x16x32_bf16 v[224:227], a[104:107], a[8:11], v[224:227]
    v_exp_f32 v230, v230
    v_mfma_f32_16x16x32_bf16 v[224:227], a[108:111], a[12:15], v[224:227]
    buffer_load_dwordx4 v3, s[4:7], 0 offen nt lds
    v_mfma_f32_16x16x32_bf16 v[220:223], a[92:95], a[12:15], v[236:239]
    v_exp_f32 v231, v231
    v_mfma_f32_16x16x32_bf16 v[220:223], a[88:91], a[8:11], v[220:223]
    v_cvt_pk_bf16_f32 v216, v228, v229
    v_cvt_pk_bf16_f32 v217, v230, v231
    v_mfma_f32_16x16x32_bf16 v[220:223], a[84:87], a[4:7], v[220:223]
    v_exp_f32 v232, v232
    v_mfma_f32_16x16x32_bf16 v[220:223], a[80:83], a[0:3], v[220:223]
    ds_read_b128 a[112:115], v1 offset:25344
    v_mov_b32 v0, v7
    v_smfmac_f32_16x16x64_bf16 a[208:211], a[228:231], v[180:187], v10
    ds_read_b64_tr_b16 a[176:177], v2 offset:16640
    v_smfmac_f32_16x16x64_bf16 a[212:215], a[228:231], v[188:195], v10
    ds_read_b128 a[116:119], v1 offset:25408
    v_mfma_f32_16x16x32_bf16 v[20:23], v[180:183], a[144:147], v[16:19]
    v_exp_f32 v233, v233
    v_mfma_f32_16x16x32_bf16 v[20:23], v[184:187], a[148:151], v[20:23]
    ds_read_b64_tr_b16 a[178:179], v2 offset:17152
    v_mfma_f32_16x16x32_bf16 v[24:27], v[184:187], a[156:159], v[16:19]
    v_exp_f32 v234, v234
    v_mfma_f32_16x16x32_bf16 v[24:27], v[180:183], a[152:155], v[24:27]
    ds_read_b64_tr_b16 a[180:181], v2 offset:20800
    v_mfma_f32_16x16x32_bf16 v[28:31], v[180:183], a[160:163], v[16:19]
    v_exp_f32 v235, v235
    v_mfma_f32_16x16x32_bf16 v[28:31], v[184:187], a[164:167], v[28:31]
    ds_read_b64_tr_b16 a[182:183], v2 offset:21312
    v_mfma_f32_16x16x32_bf16 v[32:35], v[184:187], a[172:175], v[16:19]
    v_cvt_pk_bf16_f32 v218, v232, v233
    v_cvt_pk_bf16_f32 v219, v234, v235
    v_mfma_f32_16x16x32_bf16 v[32:35], v[180:183], a[168:171], v[32:35]
    ds_read_b128 a[120:123], v1 offset:25472
    v_mfma_f32_16x16x32_bf16 v[64:67], v[188:191], a[168:171], v[16:19]
    v_exp_f32 v224, v224
    v_mfma_f32_16x16x32_bf16 v[64:67], v[192:195], a[172:175], v[64:67]
    s_add_u32 m0, s24, 16928
    ds_read_b64_tr_b16 a[184:185], v2 offset:16656
    v_mfma_f32_16x16x32_bf16 v[60:63], v[192:195], a[164:167], v[16:19]
    v_exp_f32 v225, v225
    v_mfma_f32_16x16x32_bf16 v[60:63], v[188:191], a[160:163], v[60:63]
    buffer_load_dwordx4 v3, s[4:7], 0 offen offset:1024 nt lds
    v_mfma_f32_16x16x32_bf16 v[56:59], v[188:191], a[152:155], v[16:19]
    s_add_u32 s4, s4, 8192
    v_exp_f32 v226, v226
    v_mfma_f32_16x16x32_bf16 v[56:59], v[192:195], a[156:159], v[56:59]
    s_addc_u32 s5, s5, 0
    ds_read_b128 a[124:127], v1 offset:25536
    v_mfma_f32_16x16x32_bf16 v[52:55], v[192:195], a[148:151], v[16:19]
    s_sub_u32 s20, s20, 8192
    v_exp_f32 v227, v227
    v_mfma_f32_16x16x32_bf16 v[52:55], v[188:191], a[144:147], v[52:55]
    s_max_i32 s6, s20, 0
    ds_read_b64_tr_b16 a[186:187], v2 offset:17168
    v_mfma_f32_16x16x32_bf16 v[228:231], a[80:83], a[16:19], v[240:243]
    v_cvt_pk_bf16_f32 v182, v224, v225
    v_cvt_pk_bf16_f32 v183, v226, v227
    v_mfma_f32_16x16x32_bf16 v[228:231], a[84:87], a[20:23], v[228:231]
    v_exp_f32 v220, v220
    v_mfma_f32_16x16x32_bf16 v[228:231], a[88:91], a[24:27], v[228:231]
    v_exp_f32 v221, v221
    v_mfma_f32_16x16x32_bf16 v[228:231], a[92:95], a[28:31], v[228:231]
    ds_read_b64_tr_b16 a[188:189], v2 offset:20816
    v_mfma_f32_16x16x32_bf16 v[232:235], a[108:111], a[28:31], v[240:243]
    v_exp_f32 v222, v222
    v_mfma_f32_16x16x32_bf16 v[232:235], a[104:107], a[24:27], v[232:235]
    v_exp_f32 v223, v223
    v_mfma_f32_16x16x32_bf16 v[232:235], a[100:103], a[20:23], v[232:235]
    v_cvt_pk_bf16_f32 v180, v220, v221
    v_cvt_pk_bf16_f32 v181, v222, v223
    v_mfma_f32_16x16x32_bf16 v[232:235], a[96:99], a[16:19], v[232:235]
    ds_read_b64_tr_b16 a[190:191], v2 offset:21328
    v_mfma_f32_16x16x32_bf16 v[224:227], a[96:99], a[32:35], v[244:247]
    v_exp_f32 v228, v228
    v_mfma_f32_16x16x32_bf16 v[224:227], a[100:103], a[36:39], v[224:227]
    s_add_u32 m0, s25, 8320
    v_exp_f32 v229, v229
    v_mfma_f32_16x16x32_bf16 v[224:227], a[104:107], a[40:43], v[224:227]
    v_exp_f32 v230, v230
    v_mfma_f32_16x16x32_bf16 v[224:227], a[108:111], a[44:47], v[224:227]
    buffer_load_dwordx4 v4, s[8:11], 0 offen nt lds
    v_mfma_f32_16x16x32_bf16 v[220:223], a[92:95], a[44:47], v[244:247]
    v_exp_f32 v231, v231
    v_mfma_f32_16x16x32_bf16 v[220:223], a[88:91], a[40:43], v[220:223]
    v_cvt_pk_bf16_f32 v188, v228, v229
    v_cvt_pk_bf16_f32 v189, v230, v231
    v_mfma_f32_16x16x32_bf16 v[220:223], a[84:87], a[36:39], v[220:223]
    v_exp_f32 v232, v232
    v_mfma_f32_16x16x32_bf16 v[220:223], a[80:83], a[32:35], v[220:223]
    ds_read_b128 a[128:131], v1 offset:25856
    v_smfmac_f32_16x16x64_bf16 a[216:219], a[228:231], v[196:203], v10
    ds_read_b64_tr_b16 a[192:193], v2 offset:16672
    v_smfmac_f32_16x16x64_bf16 a[220:223], a[228:231], v[204:211], v10
    ds_read_b128 a[132:135], v1 offset:25920
    v_smfmac_f32_16x16x64_bf16 a[224:227], a[228:231], v[212:219], v10
    ds_read_b64_tr_b16 a[194:195], v2 offset:17184
    v_mfma_f32_16x16x32_bf16 v[84:87], v[196:199], a[144:147], v[16:19]
    v_exp_f32 v233, v233
    v_mfma_f32_16x16x32_bf16 v[84:87], v[200:203], a[148:151], v[84:87]
    ds_read_b64_tr_b16 a[196:197], v2 offset:20832
    v_mfma_f32_16x16x32_bf16 v[88:91], v[200:203], a[156:159], v[16:19]
    v_exp_f32 v234, v234
    v_mfma_f32_16x16x32_bf16 v[88:91], v[196:199], a[152:155], v[88:91]
    ds_read_b64_tr_b16 a[198:199], v2 offset:21344
    v_mfma_f32_16x16x32_bf16 v[92:95], v[196:199], a[160:163], v[16:19]
    v_exp_f32 v235, v235
    v_mfma_f32_16x16x32_bf16 v[92:95], v[200:203], a[164:167], v[92:95]
    ds_read_b128 a[136:139], v1 offset:25984
    v_mfma_f32_16x16x32_bf16 v[96:99], v[200:203], a[172:175], v[16:19]
    v_cvt_pk_bf16_f32 v190, v232, v233
    v_cvt_pk_bf16_f32 v191, v234, v235
    v_mfma_f32_16x16x32_bf16 v[96:99], v[196:199], a[168:171], v[96:99]
    ds_read_b64_tr_b16 a[200:201], v2 offset:16688
    v_mfma_f32_16x16x32_bf16 v[128:131], v[204:207], a[168:171], v[16:19]
    v_exp_f32 v224, v224
    v_mfma_f32_16x16x32_bf16 v[128:131], v[208:211], a[172:175], v[128:131]
    s_add_u32 m0, s25, 8336
    ds_read_b128 a[140:143], v1 offset:26048
    v_mfma_f32_16x16x32_bf16 v[124:127], v[208:211], a[164:167], v[16:19]
L_pad5:
    s_cbranch_execz L_warmed
    v_exp_f32 v225, v225
    v_mfma_f32_16x16x32_bf16 v[124:127], v[204:207], a[160:163], v[124:127]
    buffer_load_dwordx4 v4, s[8:11], 0 offen offset:1024 nt lds
    v_mfma_f32_16x16x32_bf16 v[120:123], v[204:207], a[152:155], v[16:19]
    s_add_u32 s8, s8, 8320
    v_exp_f32 v226, v226
    v_mfma_f32_16x16x32_bf16 v[120:123], v[208:211], a[156:159], v[120:123]
    s_addc_u32 s9, s9, 0
    ds_read_b64_tr_b16 a[202:203], v2 offset:17200
    v_mfma_f32_16x16x32_bf16 v[116:119], v[208:211], a[148:151], v[16:19]
    s_sub_u32 s21, s21, 8320
    v_exp_f32 v227, v227
    v_mfma_f32_16x16x32_bf16 v[116:119], v[204:207], a[144:147], v[116:119]
    s_max_i32 s10, s21, 0
    ds_read_b64_tr_b16 a[204:205], v2 offset:20848
    v_mfma_f32_16x16x32_bf16 v[228:231], a[80:83], a[48:51], v[248:251]
    v_cvt_pk_bf16_f32 v198, v224, v225
    v_cvt_pk_bf16_f32 v199, v226, v227
    v_mfma_f32_16x16x32_bf16 v[228:231], a[84:87], a[52:55], v[228:231]
    v_exp_f32 v220, v220
    v_mfma_f32_16x16x32_bf16 v[228:231], a[88:91], a[56:59], v[228:231]
    v_exp_f32 v221, v221
    v_mfma_f32_16x16x32_bf16 v[228:231], a[92:95], a[60:63], v[228:231]
    ds_read_b64_tr_b16 a[206:207], v2 offset:21360
    v_mfma_f32_16x16x32_bf16 v[232:235], a[108:111], a[60:63], v[248:251]
    v_exp_f32 v222, v222
    v_mfma_f32_16x16x32_bf16 v[232:235], a[104:107], a[56:59], v[232:235]
    v_exp_f32 v223, v223
    v_mfma_f32_16x16x32_bf16 v[232:235], a[100:103], a[52:55], v[232:235]
    v_cvt_pk_bf16_f32 v196, v220, v221
    v_cvt_pk_bf16_f32 v197, v222, v223
    v_mfma_f32_16x16x32_bf16 v[232:235], a[96:99], a[48:51], v[232:235]
    v_mfma_f32_16x16x32_bf16 v[224:227], a[96:99], a[64:67], v[252:255]
    v_exp_f32 v228, v228
    v_mfma_f32_16x16x32_bf16 v[224:227], a[100:103], a[68:71], v[224:227]
    v_exp_f32 v229, v229
    v_mfma_f32_16x16x32_bf16 v[224:227], a[104:107], a[72:75], v[224:227]
    v_exp_f32 v230, v230
    v_mfma_f32_16x16x32_bf16 v[224:227], a[108:111], a[76:79], v[224:227]
    ds_read_b64_tr_b16 a[236:237], v0 offset:0
    ds_read_b64_tr_b16 a[238:239], v0 offset:32
    v_mfma_f32_16x16x32_bf16 v[220:223], a[92:95], a[76:79], v[252:255]
    v_exp_f32 v231, v231
    v_mfma_f32_16x16x32_bf16 v[220:223], a[88:91], a[72:75], v[220:223]
    v_cvt_pk_bf16_f32 v204, v228, v229
    v_cvt_pk_bf16_f32 v205, v230, v231
    v_mfma_f32_16x16x32_bf16 v[220:223], a[84:87], a[68:71], v[220:223]
    v_exp_f32 v232, v232
    v_mfma_f32_16x16x32_bf16 v[220:223], a[80:83], a[64:67], v[220:223]
    ds_read_b64_tr_b16 a[240:241], v0 offset:1088
    ds_read_b64_tr_b16 a[242:243], v0 offset:1120
    v_mfma_f32_16x16x32_bf16 v[148:151], v[212:215], a[144:147], v[16:19]
    v_exp_f32 v233, v233
    v_mfma_f32_16x16x32_bf16 v[148:151], v[216:219], a[148:151], v[148:151]
    ds_read_b64_tr_b16 a[244:245], v0 offset:2176
    ds_read_b64_tr_b16 a[246:247], v0 offset:2208
    v_mfma_f32_16x16x32_bf16 v[152:155], v[216:219], a[156:159], v[16:19]
    v_exp_f32 v234, v234
    v_mfma_f32_16x16x32_bf16 v[152:155], v[212:215], a[152:155], v[152:155]
    v_mfma_f32_16x16x32_bf16 v[156:159], v[212:215], a[160:163], v[16:19]
    s_waitcnt vmcnt(8) lgkmcnt(0)
    v_exp_f32 v235, v235
    v_mfma_f32_16x16x32_bf16 v[156:159], v[216:219], a[164:167], v[156:159]
    s_barrier
    v_mfma_f32_16x16x32_bf16 v[160:163], v[216:219], a[172:175], v[16:19]
    v_cvt_pk_bf16_f32 v206, v232, v233
    v_cvt_pk_bf16_f32 v207, v234, v235
    v_mfma_f32_16x16x32_bf16 v[160:163], v[212:215], a[168:171], v[160:163]
    s_cmp_gt_i32 s55, 0
    s_cbranch_scc1 L_loop1_1
.p2align 3
L_loop1_0:
    v_mfma_f32_16x16x32_bf16 v[48:51], v[184:187], a[200:203], v[48:51]
    s_add_u32 s32, s32, 3072
    v_exp_f32 v224, v224
    v_mfma_f32_16x16x32_bf16 v[48:51], v[180:183], a[204:207], v[48:51]
    s_add_u32 m0, s24, 25344
    ds_read_b128 a[80:83], v1 offset:0
    v_add_u32 v0, 3264, v0
    v_mfma_f32_16x16x32_bf16 v[44:47], v[180:183], a[196:199], v[44:47]
    v_exp_f32 v225, v225
    v_mfma_f32_16x16x32_bf16 v[44:47], v[184:187], a[192:195], v[44:47]
    buffer_load_dwordx4 v3, s[4:7], 0 offen nt lds
    v_mfma_f32_16x16x32_bf16 v[40:43], v[184:187], a[184:187], v[40:43]
    v_exp_f32 v226, v226
    v_mfma_f32_16x16x32_bf16 v[40:43], v[180:183], a[188:191], v[40:43]
    ds_read_b64_tr_b16 a[144:145], v2 offset:24960
    v_mfma_f32_16x16x32_bf16 v[36:39], v[180:183], a[180:183], v[36:39]
    v_exp_f32 v227, v227
    v_mfma_f32_16x16x32_bf16 v[36:39], v[184:187], a[176:179], v[36:39]
    ds_read_b128 a[84:87], v1 offset:64
    v_mfma_f32_16x16x32_bf16 v[228:231], a[112:115], a[0:3], v[236:239]
    v_cvt_pk_bf16_f32 v214, v224, v225
    v_cvt_pk_bf16_f32 v215, v226, v227
    v_mfma_f32_16x16x32_bf16 v[228:231], a[116:119], a[4:7], v[228:231]
    v_exp_f32 v220, v220
    v_mfma_f32_16x16x32_bf16 v[228:231], a[120:123], a[8:11], v[228:231]
    v_exp_f32 v221, v221
    v_mfma_f32_16x16x32_bf16 v[228:231], a[124:127], a[12:15], v[228:231]
    ds_read_b64_tr_b16 a[146:147], v2 offset:25472
    v_mfma_f32_16x16x32_bf16 v[232:235], a[140:143], a[12:15], v[236:239]
    v_exp_f32 v222, v222
    v_mfma_f32_16x16x32_bf16 v[232:235], a[136:139], a[8:11], v[232:235]
    v_exp_f32 v223, v223
    v_mfma_f32_16x16x32_bf16 v[232:235], a[132:135], a[4:7], v[232:235]
    v_cvt_pk_bf16_f32 v212, v220, v221
    v_cvt_pk_bf16_f32 v213, v222, v223
    v_mfma_f32_16x16x32_bf16 v[232:235], a[128:131], a[0:3], v[232:235]
    ds_read_b64_tr_b16 a[148:149], v2 offset:29120
    ds_read_b64_tr_b16 a[150:151], v2 offset:29632
    v_mfma_f32_16x16x32_bf16 v[224:227], a[128:131], a[16:19], v[240:243]
    v_exp_f32 v228, v228
    v_mfma_f32_16x16x32_bf16 v[224:227], a[132:135], a[20:23], v[224:227]
    s_add_u32 m0, s24, 25376
    v_exp_f32 v229, v229
    v_mfma_f32_16x16x32_bf16 v[224:227], a[136:139], a[24:27], v[224:227]
    v_exp_f32 v230, v230
    v_mfma_f32_16x16x32_bf16 v[224:227], a[140:143], a[28:31], v[224:227]
    buffer_load_dwordx4 v3, s[4:7], 0 offen offset:1024 nt lds
    v_mfma_f32_16x16x32_bf16 v[220:223], a[124:127], a[28:31], v[240:243]
    s_add_u32 s4, s4, 8192
    v_exp_f32 v231, v231
    v_mfma_f32_16x16x32_bf16 v[220:223], a[120:123], a[24:27], v[220:223]
    s_addc_u32 s5, s5, 0
    v_cvt_pk_bf16_f32 v184, v228, v229
    v_cvt_pk_bf16_f32 v185, v230, v231
    v_mfma_f32_16x16x32_bf16 v[220:223], a[116:119], a[20:23], v[220:223]
    s_sub_u32 s20, s20, 8192
    v_exp_f32 v232, v232
    v_mfma_f32_16x16x32_bf16 v[220:223], a[112:115], a[16:19], v[220:223]
    s_max_i32 s6, s20, 0
    ds_read_b128 a[88:91], v1 offset:128
    v_mfma_f32_16x16x32_bf16 v[68:71], v[192:195], a[176:179], v[68:71]
    v_exp_f32 v233, v233
    v_mfma_f32_16x16x32_bf16 v[68:71], v[188:191], a[180:183], v[68:71]
    ds_read_b64_tr_b16 a[152:153], v2 offset:24976
    v_mfma_f32_16x16x32_bf16 v[72:75], v[188:191], a[188:191], v[72:75]
    v_exp_f32 v234, v234
    v_mfma_f32_16x16x32_bf16 v[72:75], v[192:195], a[184:187], v[72:75]
    ds_read_b128 a[92:95], v1 offset:192
    v_mfma_f32_16x16x32_bf16 v[76:79], v[192:195], a[192:195], v[76:79]
    v_exp_f32 v235, v235
    v_mfma_f32_16x16x32_bf16 v[76:79], v[188:191], a[196:199], v[76:79]
    ds_read_b64_tr_b16 a[154:155], v2 offset:25488
    v_mfma_f32_16x16x32_bf16 v[80:83], v[188:191], a[204:207], v[80:83]
    v_cvt_pk_bf16_f32 v186, v232, v233
    v_cvt_pk_bf16_f32 v187, v234, v235
    v_mfma_f32_16x16x32_bf16 v[80:83], v[192:195], a[200:203], v[80:83]
    ds_read_b64_tr_b16 a[156:157], v2 offset:29136
    ds_read_b64_tr_b16 a[158:159], v2 offset:29648
    v_mfma_f32_16x16x32_bf16 v[112:115], v[200:203], a[200:203], v[112:115]
    v_exp_f32 v224, v224
    v_mfma_f32_16x16x32_bf16 v[112:115], v[196:199], a[204:207], v[112:115]
    s_add_u32 m0, s25, 16640
    ds_read_b128 a[96:99], v1 offset:512
    v_mfma_f32_16x16x32_bf16 v[108:111], v[196:199], a[196:199], v[108:111]
    v_exp_f32 v225, v225
    v_mfma_f32_16x16x32_bf16 v[108:111], v[200:203], a[192:195], v[108:111]
    buffer_load_dwordx4 v4, s[8:11], 0 offen nt lds
    v_mfma_f32_16x16x32_bf16 v[104:107], v[200:203], a[184:187], v[104:107]
    v_exp_f32 v226, v226
    v_mfma_f32_16x16x32_bf16 v[104:107], v[196:199], a[188:191], v[104:107]
    ds_read_b64_tr_b16 a[160:161], v2 offset:24992
    v_mfma_f32_16x16x32_bf16 v[100:103], v[196:199], a[180:183], v[100:103]
    v_exp_f32 v227, v227
    v_mfma_f32_16x16x32_bf16 v[100:103], v[200:203], a[176:179], v[100:103]
    ds_read_b128 a[100:103], v1 offset:576
    v_mfma_f32_16x16x32_bf16 v[228:231], a[112:115], a[32:35], v[244:247]
    v_cvt_pk_bf16_f32 v194, v224, v225
    v_cvt_pk_bf16_f32 v195, v226, v227
    v_mfma_f32_16x16x32_bf16 v[228:231], a[116:119], a[36:39], v[228:231]
    v_exp_f32 v220, v220
    v_mfma_f32_16x16x32_bf16 v[228:231], a[120:123], a[40:43], v[228:231]
    v_exp_f32 v221, v221
    v_mfma_f32_16x16x32_bf16 v[228:231], a[124:127], a[44:47], v[228:231]
    ds_read_b64_tr_b16 a[162:163], v2 offset:25504
    v_mfma_f32_16x16x32_bf16 v[232:235], a[140:143], a[44:47], v[244:247]
    v_exp_f32 v222, v222
    v_mfma_f32_16x16x32_bf16 v[232:235], a[136:139], a[40:43], v[232:235]
    v_exp_f32 v223, v223
    v_mfma_f32_16x16x32_bf16 v[232:235], a[132:135], a[36:39], v[232:235]
    v_cvt_pk_bf16_f32 v192, v220, v221
    v_cvt_pk_bf16_f32 v193, v222, v223
    v_mfma_f32_16x16x32_bf16 v[232:235], a[128:131], a[32:35], v[232:235]
    ds_read_b64_tr_b16 a[164:165], v2 offset:29152
    ds_read_b64_tr_b16 a[166:167], v2 offset:29664
    v_mfma_f32_16x16x32_bf16 v[224:227], a[128:131], a[48:51], v[248:251]
    v_exp_f32 v228, v228
    v_mfma_f32_16x16x32_bf16 v[224:227], a[132:135], a[52:55], v[224:227]
    s_add_u32 m0, s25, 16656
    v_exp_f32 v229, v229
    v_mfma_f32_16x16x32_bf16 v[224:227], a[136:139], a[56:59], v[224:227]
    v_exp_f32 v230, v230
    v_mfma_f32_16x16x32_bf16 v[224:227], a[140:143], a[60:63], v[224:227]
    buffer_load_dwordx4 v4, s[8:11], 0 offen offset:1024 nt lds
    v_mfma_f32_16x16x32_bf16 v[220:223], a[124:127], a[60:63], v[248:251]
    s_add_u32 s8, s8, 8064
    v_exp_f32 v231, v231
    v_mfma_f32_16x16x32_bf16 v[220:223], a[120:123], a[56:59], v[220:223]
    s_addc_u32 s9, s9, 0
    v_cvt_pk_bf16_f32 v200, v228, v229
    v_cvt_pk_bf16_f32 v201, v230, v231
    v_mfma_f32_16x16x32_bf16 v[220:223], a[116:119], a[52:55], v[220:223]
    s_sub_u32 s21, s21, 8064
    v_exp_f32 v232, v232
    v_mfma_f32_16x16x32_bf16 v[220:223], a[112:115], a[48:51], v[220:223]
    s_max_i32 s10, s21, 0
    ds_read_b128 a[104:107], v1 offset:640
    v_mfma_f32_16x16x32_bf16 v[132:135], v[208:211], a[176:179], v[132:135]
    v_exp_f32 v233, v233
    v_mfma_f32_16x16x32_bf16 v[132:135], v[204:207], a[180:183], v[132:135]
    ds_read_b64_tr_b16 a[168:169], v2 offset:25008
    v_mfma_f32_16x16x32_bf16 v[136:139], v[204:207], a[188:191], v[136:139]
    v_exp_f32 v234, v234
    v_mfma_f32_16x16x32_bf16 v[136:139], v[208:211], a[184:187], v[136:139]
    ds_read_b128 a[108:111], v1 offset:704
    v_mfma_f32_16x16x32_bf16 v[140:143], v[208:211], a[192:195], v[140:143]
    v_exp_f32 v235, v235
    v_mfma_f32_16x16x32_bf16 v[140:143], v[204:207], a[196:199], v[140:143]
    ds_read_b64_tr_b16 a[170:171], v2 offset:25520
    v_mfma_f32_16x16x32_bf16 v[144:147], v[204:207], a[204:207], v[144:147]
    v_cvt_pk_bf16_f32 v202, v232, v233
    v_cvt_pk_bf16_f32 v203, v234, v235
    v_mfma_f32_16x16x32_bf16 v[144:147], v[208:211], a[200:203], v[144:147]
    ds_read_b64_tr_b16 a[172:173], v2 offset:29168
    ds_read_b64_tr_b16 a[174:175], v2 offset:29680
    v_mfma_f32_16x16x32_bf16 v[176:179], v[216:219], a[200:203], v[176:179]
    v_exp_f32 v224, v224
    v_mfma_f32_16x16x32_bf16 v[176:179], v[212:215], a[204:207], v[176:179]
    v_mfma_f32_16x16x32_bf16 v[172:175], v[212:215], a[196:199], v[172:175]
    v_exp_f32 v225, v225
    v_mfma_f32_16x16x32_bf16 v[172:175], v[216:219], a[192:195], v[172:175]
    buffer_store_dwordx4 a[236:239], v3, s[16:19], s32 offen offset:0 sc1 nt
    v_mfma_f32_16x16x32_bf16 v[168:171], v[216:219], a[184:187], v[168:171]
    v_exp_f32 v226, v226
    v_mfma_f32_16x16x32_bf16 v[168:171], v[212:215], a[188:191], v[168:171]
    v_mfma_f32_16x16x32_bf16 v[164:167], v[212:215], a[180:183], v[164:167]
    v_exp_f32 v227, v227
    v_mfma_f32_16x16x32_bf16 v[164:167], v[216:219], a[176:179], v[164:167]
    buffer_store_dwordx4 a[240:243], v3, s[16:19], s32 offen offset:1024 sc1 nt
    v_mfma_f32_16x16x32_bf16 v[228:231], a[112:115], a[64:67], v[252:255]
    v_cvt_pk_bf16_f32 v210, v224, v225
    v_cvt_pk_bf16_f32 v211, v226, v227
    v_mfma_f32_16x16x32_bf16 v[228:231], a[116:119], a[68:71], v[228:231]
    v_exp_f32 v220, v220
    v_mfma_f32_16x16x32_bf16 v[228:231], a[120:123], a[72:75], v[228:231]
    s_waitcnt vmcnt(10) lgkmcnt(0)
    v_exp_f32 v221, v221
    v_mfma_f32_16x16x32_bf16 v[228:231], a[124:127], a[76:79], v[228:231]
    buffer_store_dwordx4 a[244:247], v3, s[16:19], s32 offen offset:2048 sc1 nt
    s_barrier
    v_mfma_f32_16x16x32_bf16 v[232:235], a[140:143], a[76:79], v[252:255]
    v_exp_f32 v222, v222
    v_mfma_f32_16x16x32_bf16 v[232:235], a[136:139], a[72:75], v[232:235]
    v_exp_f32 v223, v223
    v_mfma_f32_16x16x32_bf16 v[232:235], a[132:135], a[68:71], v[232:235]
    v_cvt_pk_bf16_f32 v208, v220, v221
    v_cvt_pk_bf16_f32 v209, v222, v223
    v_mfma_f32_16x16x32_bf16 v[232:235], a[128:131], a[64:67], v[232:235]
    v_mfma_f32_16x16x32_bf16 v[224:227], a[96:99], a[0:3], v[236:239]
    v_exp_f32 v228, v228
    v_mfma_f32_16x16x32_bf16 v[224:227], a[100:103], a[4:7], v[224:227]
    s_add_u32 m0, s24, 0
    v_exp_f32 v229, v229
    v_mfma_f32_16x16x32_bf16 v[224:227], a[104:107], a[8:11], v[224:227]
    v_exp_f32 v230, v230
    v_mfma_f32_16x16x32_bf16 v[224:227], a[108:111], a[12:15], v[224:227]
    buffer_load_dwordx4 v3, s[4:7], 0 offen nt lds
    v_mfma_f32_16x16x32_bf16 v[220:223], a[92:95], a[12:15], v[236:239]
    v_exp_f32 v231, v231
    v_mfma_f32_16x16x32_bf16 v[220:223], a[88:91], a[8:11], v[220:223]
    v_cvt_pk_bf16_f32 v216, v228, v229
    v_cvt_pk_bf16_f32 v217, v230, v231
    v_mfma_f32_16x16x32_bf16 v[220:223], a[84:87], a[4:7], v[220:223]
    v_exp_f32 v232, v232
    v_mfma_f32_16x16x32_bf16 v[220:223], a[80:83], a[0:3], v[220:223]
    ds_read_b128 a[112:115], v1 offset:8448
    v_smfmac_f32_16x16x64_bf16 a[208:211], a[228:231], v[180:187], v10
    ds_read_b64_tr_b16 a[176:177], v2 offset:0
    v_smfmac_f32_16x16x64_bf16 a[212:215], a[228:231], v[188:195], v10
    ds_read_b128 a[116:119], v1 offset:8512
    v_mfma_f32_16x16x32_bf16 v[20:23], v[180:183], a[144:147], v[20:23]
    v_exp_f32 v233, v233
    v_mfma_f32_16x16x32_bf16 v[20:23], v[184:187], a[148:151], v[20:23]
    ds_read_b64_tr_b16 a[178:179], v2 offset:512
    v_mfma_f32_16x16x32_bf16 v[24:27], v[184:187], a[156:159], v[24:27]
    v_exp_f32 v234, v234
    v_mfma_f32_16x16x32_bf16 v[24:27], v[180:183], a[152:155], v[24:27]
    ds_read_b64_tr_b16 a[180:181], v2 offset:4160
    v_mfma_f32_16x16x32_bf16 v[28:31], v[180:183], a[160:163], v[28:31]
    v_exp_f32 v235, v235
    v_mfma_f32_16x16x32_bf16 v[28:31], v[184:187], a[164:167], v[28:31]
    ds_read_b64_tr_b16 a[182:183], v2 offset:4672
    v_mfma_f32_16x16x32_bf16 v[32:35], v[184:187], a[172:175], v[32:35]
    v_cvt_pk_bf16_f32 v218, v232, v233
    v_cvt_pk_bf16_f32 v219, v234, v235
    v_mfma_f32_16x16x32_bf16 v[32:35], v[180:183], a[168:171], v[32:35]
    ds_read_b128 a[120:123], v1 offset:8576
    v_mfma_f32_16x16x32_bf16 v[64:67], v[188:191], a[168:171], v[64:67]
    v_exp_f32 v224, v224
    v_mfma_f32_16x16x32_bf16 v[64:67], v[192:195], a[172:175], v[64:67]
    s_add_u32 m0, s24, 32
    ds_read_b64_tr_b16 a[184:185], v2 offset:16
    v_mfma_f32_16x16x32_bf16 v[60:63], v[192:195], a[164:167], v[60:63]
    v_exp_f32 v225, v225
    v_mfma_f32_16x16x32_bf16 v[60:63], v[188:191], a[160:163], v[60:63]
    buffer_load_dwordx4 v3, s[4:7], 0 offen offset:1024 nt lds
    v_mfma_f32_16x16x32_bf16 v[56:59], v[188:191], a[152:155], v[56:59]
    s_add_u32 s4, s4, 8192
    v_exp_f32 v226, v226
    v_mfma_f32_16x16x32_bf16 v[56:59], v[192:195], a[156:159], v[56:59]
    s_addc_u32 s5, s5, 0
    ds_read_b128 a[124:127], v1 offset:8640
    v_mfma_f32_16x16x32_bf16 v[52:55], v[192:195], a[148:151], v[52:55]
    s_sub_u32 s20, s20, 8192
    v_exp_f32 v227, v227
    v_mfma_f32_16x16x32_bf16 v[52:55], v[188:191], a[144:147], v[52:55]
    s_max_i32 s6, s20, 0
    ds_read_b64_tr_b16 a[186:187], v2 offset:528
    v_mfma_f32_16x16x32_bf16 v[228:231], a[80:83], a[16:19], v[240:243]
    v_cvt_pk_bf16_f32 v182, v224, v225
    v_cvt_pk_bf16_f32 v183, v226, v227
    v_mfma_f32_16x16x32_bf16 v[228:231], a[84:87], a[20:23], v[228:231]
    v_exp_f32 v220, v220
    v_mfma_f32_16x16x32_bf16 v[228:231], a[88:91], a[24:27], v[228:231]
    v_exp_f32 v221, v221
    v_mfma_f32_16x16x32_bf16 v[228:231], a[92:95], a[28:31], v[228:231]
    ds_read_b64_tr_b16 a[188:189], v2 offset:4176
    v_mfma_f32_16x16x32_bf16 v[232:235], a[108:111], a[28:31], v[240:243]
    v_exp_f32 v222, v222
    v_mfma_f32_16x16x32_bf16 v[232:235], a[104:107], a[24:27], v[232:235]
    v_exp_f32 v223, v223
    v_mfma_f32_16x16x32_bf16 v[232:235], a[100:103], a[20:23], v[232:235]
    v_cvt_pk_bf16_f32 v180, v220, v221
    v_cvt_pk_bf16_f32 v181, v222, v223
    v_mfma_f32_16x16x32_bf16 v[232:235], a[96:99], a[16:19], v[232:235]
    ds_read_b64_tr_b16 a[190:191], v2 offset:4688
    v_mfma_f32_16x16x32_bf16 v[224:227], a[96:99], a[32:35], v[244:247]
    v_exp_f32 v228, v228
    v_mfma_f32_16x16x32_bf16 v[224:227], a[100:103], a[36:39], v[224:227]
    s_add_u32 m0, s25, 24960
    v_exp_f32 v229, v229
    v_mfma_f32_16x16x32_bf16 v[224:227], a[104:107], a[40:43], v[224:227]
    v_exp_f32 v230, v230
    v_mfma_f32_16x16x32_bf16 v[224:227], a[108:111], a[44:47], v[224:227]
    buffer_load_dwordx4 v4, s[8:11], 0 offen nt lds
    v_mfma_f32_16x16x32_bf16 v[220:223], a[92:95], a[44:47], v[244:247]
    v_exp_f32 v231, v231
    v_mfma_f32_16x16x32_bf16 v[220:223], a[88:91], a[40:43], v[220:223]
    v_cvt_pk_bf16_f32 v188, v228, v229
    v_cvt_pk_bf16_f32 v189, v230, v231
    v_mfma_f32_16x16x32_bf16 v[220:223], a[84:87], a[36:39], v[220:223]
    v_exp_f32 v232, v232
    v_mfma_f32_16x16x32_bf16 v[220:223], a[80:83], a[32:35], v[220:223]
    ds_read_b128 a[128:131], v1 offset:8960
    v_smfmac_f32_16x16x64_bf16 a[216:219], a[228:231], v[196:203], v10
    ds_read_b64_tr_b16 a[192:193], v2 offset:32
    v_smfmac_f32_16x16x64_bf16 a[220:223], a[228:231], v[204:211], v10
    ds_read_b128 a[132:135], v1 offset:9024
    v_smfmac_f32_16x16x64_bf16 a[224:227], a[228:231], v[212:219], v10
    ds_read_b64_tr_b16 a[194:195], v2 offset:544
    v_mfma_f32_16x16x32_bf16 v[84:87], v[196:199], a[144:147], v[84:87]
    v_exp_f32 v233, v233
    v_mfma_f32_16x16x32_bf16 v[84:87], v[200:203], a[148:151], v[84:87]
    ds_read_b64_tr_b16 a[196:197], v2 offset:4192
    v_mfma_f32_16x16x32_bf16 v[88:91], v[200:203], a[156:159], v[88:91]
    v_exp_f32 v234, v234
    v_mfma_f32_16x16x32_bf16 v[88:91], v[196:199], a[152:155], v[88:91]
    ds_read_b64_tr_b16 a[198:199], v2 offset:4704
    v_mfma_f32_16x16x32_bf16 v[92:95], v[196:199], a[160:163], v[92:95]
    v_exp_f32 v235, v235
    v_mfma_f32_16x16x32_bf16 v[92:95], v[200:203], a[164:167], v[92:95]
    ds_read_b128 a[136:139], v1 offset:9088
    v_mfma_f32_16x16x32_bf16 v[96:99], v[200:203], a[172:175], v[96:99]
    v_cvt_pk_bf16_f32 v190, v232, v233
    v_cvt_pk_bf16_f32 v191, v234, v235
    v_mfma_f32_16x16x32_bf16 v[96:99], v[196:199], a[168:171], v[96:99]
    ds_read_b64_tr_b16 a[200:201], v2 offset:48
    v_mfma_f32_16x16x32_bf16 v[128:131], v[204:207], a[168:171], v[128:131]
    v_exp_f32 v224, v224
    v_mfma_f32_16x16x32_bf16 v[128:131], v[208:211], a[172:175], v[128:131]
    s_add_u32 m0, s25, 24976
    ds_read_b128 a[140:143], v1 offset:9152
    v_mfma_f32_16x16x32_bf16 v[124:127], v[208:211], a[164:167], v[124:127]
    v_exp_f32 v225, v225
    v_mfma_f32_16x16x32_bf16 v[124:127], v[204:207], a[160:163], v[124:127]
    buffer_load_dwordx4 v4, s[8:11], 0 offen offset:1024 nt lds
    v_mfma_f32_16x16x32_bf16 v[120:123], v[204:207], a[152:155], v[120:123]
    s_add_u32 s8, s8, 8320
    v_exp_f32 v226, v226
    v_mfma_f32_16x16x32_bf16 v[120:123], v[208:211], a[156:159], v[120:123]
    s_addc_u32 s9, s9, 0
    ds_read_b64_tr_b16 a[202:203], v2 offset:560
    v_mfma_f32_16x16x32_bf16 v[116:119], v[208:211], a[148:151], v[116:119]
    s_sub_u32 s21, s21, 8320
    v_exp_f32 v227, v227
    v_mfma_f32_16x16x32_bf16 v[116:119], v[204:207], a[144:147], v[116:119]
    s_max_i32 s10, s21, 0
    ds_read_b64_tr_b16 a[204:205], v2 offset:4208
    v_mfma_f32_16x16x32_bf16 v[228:231], a[80:83], a[48:51], v[248:251]
    v_cvt_pk_bf16_f32 v198, v224, v225
    v_cvt_pk_bf16_f32 v199, v226, v227
    v_mfma_f32_16x16x32_bf16 v[228:231], a[84:87], a[52:55], v[228:231]
    v_exp_f32 v220, v220
    v_mfma_f32_16x16x32_bf16 v[228:231], a[88:91], a[56:59], v[228:231]
    v_exp_f32 v221, v221
    v_mfma_f32_16x16x32_bf16 v[228:231], a[92:95], a[60:63], v[228:231]
    ds_read_b64_tr_b16 a[206:207], v2 offset:4720
    v_mfma_f32_16x16x32_bf16 v[232:235], a[108:111], a[60:63], v[248:251]
    v_exp_f32 v222, v222
    v_mfma_f32_16x16x32_bf16 v[232:235], a[104:107], a[56:59], v[232:235]
    v_exp_f32 v223, v223
    v_mfma_f32_16x16x32_bf16 v[232:235], a[100:103], a[52:55], v[232:235]
    v_cvt_pk_bf16_f32 v196, v220, v221
    v_cvt_pk_bf16_f32 v197, v222, v223
    v_mfma_f32_16x16x32_bf16 v[232:235], a[96:99], a[48:51], v[232:235]
    v_mfma_f32_16x16x32_bf16 v[224:227], a[96:99], a[64:67], v[252:255]
    v_exp_f32 v228, v228
    v_mfma_f32_16x16x32_bf16 v[224:227], a[100:103], a[68:71], v[224:227]
    v_exp_f32 v229, v229
    v_mfma_f32_16x16x32_bf16 v[224:227], a[104:107], a[72:75], v[224:227]
    v_exp_f32 v230, v230
    v_mfma_f32_16x16x32_bf16 v[224:227], a[108:111], a[76:79], v[224:227]
    v_mfma_f32_16x16x32_bf16 v[220:223], a[92:95], a[76:79], v[252:255]
    v_exp_f32 v231, v231
    v_mfma_f32_16x16x32_bf16 v[220:223], a[88:91], a[72:75], v[220:223]
    v_cvt_pk_bf16_f32 v204, v228, v229
    v_cvt_pk_bf16_f32 v205, v230, v231
    v_mfma_f32_16x16x32_bf16 v[220:223], a[84:87], a[68:71], v[220:223]
    v_exp_f32 v232, v232
    v_mfma_f32_16x16x32_bf16 v[220:223], a[80:83], a[64:67], v[220:223]
    ds_read_b64_tr_b16 a[236:237], v0 offset:0
    ds_read_b64_tr_b16 a[238:239], v0 offset:32
    v_mfma_f32_16x16x32_bf16 v[148:151], v[212:215], a[144:147], v[148:151]
    v_exp_f32 v233, v233
    v_mfma_f32_16x16x32_bf16 v[148:151], v[216:219], a[148:151], v[148:151]
    v_mfma_f32_16x16x32_bf16 v[152:155], v[216:219], a[156:159], v[152:155]
    v_exp_f32 v234, v234
    v_mfma_f32_16x16x32_bf16 v[152:155], v[212:215], a[152:155], v[152:155]
    v_mfma_f32_16x16x32_bf16 v[156:159], v[212:215], a[160:163], v[156:159]
    s_waitcnt vmcnt(11) lgkmcnt(0)
    v_exp_f32 v235, v235
    v_mfma_f32_16x16x32_bf16 v[156:159], v[216:219], a[164:167], v[156:159]
    s_barrier
    v_mfma_f32_16x16x32_bf16 v[160:163], v[216:219], a[172:175], v[160:163]
    v_cvt_pk_bf16_f32 v206, v232, v233
    v_cvt_pk_bf16_f32 v207, v234, v235
    v_mfma_f32_16x16x32_bf16 v[160:163], v[212:215], a[168:171], v[160:163]
    v_mfma_f32_16x16x32_bf16 v[48:51], v[184:187], a[200:203], v[48:51]
    v_exp_f32 v224, v224
    v_mfma_f32_16x16x32_bf16 v[48:51], v[180:183], a[204:207], v[48:51]
    s_add_u32 m0, s24, 8448
    ds_read_b128 a[80:83], v1 offset:16896
    v_mfma_f32_16x16x32_bf16 v[44:47], v[180:183], a[196:199], v[44:47]
    v_exp_f32 v225, v225
    v_mfma_f32_16x16x32_bf16 v[44:47], v[184:187], a[192:195], v[44:47]
    buffer_load_dwordx4 v3, s[4:7], 0 offen nt lds
    v_mfma_f32_16x16x32_bf16 v[40:43], v[184:187], a[184:187], v[40:43]
    v_exp_f32 v226, v226
    v_mfma_f32_16x16x32_bf16 v[40:43], v[180:183], a[188:191], v[40:43]
    ds_read_b64_tr_b16 a[144:145], v2 offset:8320
    v_mfma_f32_16x16x32_bf16 v[36:39], v[180:183], a[180:183], v[36:39]
    v_exp_f32 v227, v227
    v_mfma_f32_16x16x32_bf16 v[36:39], v[184:187], a[176:179], v[36:39]
    ds_read_b128 a[84:87], v1 offset:16960
    v_mfma_f32_16x16x32_bf16 v[228:231], a[112:115], a[0:3], v[236:239]
    v_cvt_pk_bf16_f32 v214, v224, v225
    v_cvt_pk_bf16_f32 v215, v226, v227
    v_mfma_f32_16x16x32_bf16 v[228:231], a[116:119], a[4:7], v[228:231]
    v_exp_f32 v220, v220
    v_mfma_f32_16x16x32_bf16 v[228:231], a[120:123], a[8:11], v[228:231]
    v_exp_f32 v221, v221
    v_mfma_f32_16x16x32_bf16 v[228:231], a[124:127], a[12:15], v[228:231]
    ds_read_b64_tr_b16 a[146:147], v2 offset:8832
    v_mfma_f32_16x16x32_bf16 v[232:235], a[140:143], a[12:15], v[236:239]
    v_exp_f32 v222, v222
    v_mfma_f32_16x16x32_bf16 v[232:235], a[136:139], a[8:11], v[232:235]
    v_exp_f32 v223, v223
    v_mfma_f32_16x16x32_bf16 v[232:235], a[132:135], a[4:7], v[232:235]
    v_cvt_pk_bf16_f32 v212, v220, v221
    v_cvt_pk_bf16_f32 v213, v222, v223
    v_mfma_f32_16x16x32_bf16 v[232:235], a[128:131], a[0:3], v[232:235]
    ds_read_b64_tr_b16 a[148:149], v2 offset:12480
    ds_read_b64_tr_b16 a[150:151], v2 offset:12992
    v_mfma_f32_16x16x32_bf16 v[224:227], a[128:131], a[16:19], v[240:243]
    v_exp_f32 v228, v228
    v_mfma_f32_16x16x32_bf16 v[224:227], a[132:135], a[20:23], v[224:227]
    s_add_u32 m0, s24, 8480
    v_exp_f32 v229, v229
    v_mfma_f32_16x16x32_bf16 v[224:227], a[136:139], a[24:27], v[224:227]
    v_exp_f32 v230, v230
    v_mfma_f32_16x16x32_bf16 v[224:227], a[140:143], a[28:31], v[224:227]
    buffer_load_dwordx4 v3, s[4:7], 0 offen offset:1024 nt lds
    v_mfma_f32_16x16x32_bf16 v[220:223], a[124:127], a[28:31], v[240:243]
    s_add_u32 s4, s4, 8192
    v_exp_f32 v231, v231
    v_mfma_f32_16x16x32_bf16 v[220:223], a[120:123], a[24:27], v[220:223]
    s_addc_u32 s5, s5, 0
    v_cvt_pk_bf16_f32 v184, v228, v229
    v_cvt_pk_bf16_f32 v185, v230, v231
    v_mfma_f32_16x16x32_bf16 v[220:223], a[116:119], a[20:23], v[220:223]
    s_sub_u32 s20, s20, 8192
    v_exp_f32 v232, v232
    v_mfma_f32_16x16x32_bf16 v[220:223], a[112:115], a[16:19], v[220:223]
    s_max_i32 s6, s20, 0
    ds_read_b128 a[88:91], v1 offset:17024
    v_mfma_f32_16x16x32_bf16 v[68:71], v[192:195], a[176:179], v[68:71]
    v_exp_f32 v233, v233
    v_mfma_f32_16x16x32_bf16 v[68:71], v[188:191], a[180:183], v[68:71]
    ds_read_b64_tr_b16 a[152:153], v2 offset:8336
    v_mfma_f32_16x16x32_bf16 v[72:75], v[188:191], a[188:191], v[72:75]
    v_exp_f32 v234, v234
    v_mfma_f32_16x16x32_bf16 v[72:75], v[192:195], a[184:187], v[72:75]
    ds_read_b128 a[92:95], v1 offset:17088
    v_mfma_f32_16x16x32_bf16 v[76:79], v[192:195], a[192:195], v[76:79]
    v_exp_f32 v235, v235
    v_mfma_f32_16x16x32_bf16 v[76:79], v[188:191], a[196:199], v[76:79]
    ds_read_b64_tr_b16 a[154:155], v2 offset:8848
    v_mfma_f32_16x16x32_bf16 v[80:83], v[188:191], a[204:207], v[80:83]
    v_cvt_pk_bf16_f32 v186, v232, v233
    v_cvt_pk_bf16_f32 v187, v234, v235
    v_mfma_f32_16x16x32_bf16 v[80:83], v[192:195], a[200:203], v[80:83]
    ds_read_b64_tr_b16 a[156:157], v2 offset:12496
    ds_read_b64_tr_b16 a[158:159], v2 offset:13008
    v_mfma_f32_16x16x32_bf16 v[112:115], v[200:203], a[200:203], v[112:115]
    v_exp_f32 v224, v224
    v_mfma_f32_16x16x32_bf16 v[112:115], v[196:199], a[204:207], v[112:115]
    s_add_u32 m0, s25, 0
    ds_read_b128 a[96:99], v1 offset:17408
    v_mfma_f32_16x16x32_bf16 v[108:111], v[196:199], a[196:199], v[108:111]
    v_exp_f32 v225, v225
    v_mfma_f32_16x16x32_bf16 v[108:111], v[200:203], a[192:195], v[108:111]
    buffer_load_dwordx4 v4, s[8:11], 0 offen nt lds
    v_mfma_f32_16x16x32_bf16 v[104:107], v[200:203], a[184:187], v[104:107]
    v_exp_f32 v226, v226
    v_mfma_f32_16x16x32_bf16 v[104:107], v[196:199], a[188:191], v[104:107]
    ds_read_b64_tr_b16 a[160:161], v2 offset:8352
    v_mfma_f32_16x16x32_bf16 v[100:103], v[196:199], a[180:183], v[100:103]
    v_exp_f32 v227, v227
    v_mfma_f32_16x16x32_bf16 v[100:103], v[200:203], a[176:179], v[100:103]
    ds_read_b128 a[100:103], v1 offset:17472
    v_mfma_f32_16x16x32_bf16 v[228:231], a[112:115], a[32:35], v[244:247]
    v_cvt_pk_bf16_f32 v194, v224, v225
    v_cvt_pk_bf16_f32 v195, v226, v227
    v_mfma_f32_16x16x32_bf16 v[228:231], a[116:119], a[36:39], v[228:231]
    v_exp_f32 v220, v220
    v_mfma_f32_16x16x32_bf16 v[228:231], a[120:123], a[40:43], v[228:231]
    v_exp_f32 v221, v221
    v_mfma_f32_16x16x32_bf16 v[228:231], a[124:127], a[44:47], v[228:231]
    ds_read_b64_tr_b16 a[162:163], v2 offset:8864
    v_mfma_f32_16x16x32_bf16 v[232:235], a[140:143], a[44:47], v[244:247]
    v_exp_f32 v222, v222
    v_mfma_f32_16x16x32_bf16 v[232:235], a[136:139], a[40:43], v[232:235]
    v_exp_f32 v223, v223
    v_mfma_f32_16x16x32_bf16 v[232:235], a[132:135], a[36:39], v[232:235]
    v_cvt_pk_bf16_f32 v192, v220, v221
    v_cvt_pk_bf16_f32 v193, v222, v223
    v_mfma_f32_16x16x32_bf16 v[232:235], a[128:131], a[32:35], v[232:235]
    ds_read_b64_tr_b16 a[164:165], v2 offset:12512
    ds_read_b64_tr_b16 a[166:167], v2 offset:13024
    v_mfma_f32_16x16x32_bf16 v[224:227], a[128:131], a[48:51], v[248:251]
    v_exp_f32 v228, v228
    v_mfma_f32_16x16x32_bf16 v[224:227], a[132:135], a[52:55], v[224:227]
    s_add_u32 m0, s25, 16
    v_exp_f32 v229, v229
    v_mfma_f32_16x16x32_bf16 v[224:227], a[136:139], a[56:59], v[224:227]
    v_exp_f32 v230, v230
    v_mfma_f32_16x16x32_bf16 v[224:227], a[140:143], a[60:63], v[224:227]
    buffer_load_dwordx4 v4, s[8:11], 0 offen offset:1024 nt lds
    v_mfma_f32_16x16x32_bf16 v[220:223], a[124:127], a[60:63], v[248:251]
    s_add_u32 s8, s8, 8064
    v_exp_f32 v231, v231
    v_mfma_f32_16x16x32_bf16 v[220:223], a[120:123], a[56:59], v[220:223]
    s_addc_u32 s9, s9, 0
    v_cvt_pk_bf16_f32 v200, v228, v229
    v_cvt_pk_bf16_f32 v201, v230, v231
    v_mfma_f32_16x16x32_bf16 v[220:223], a[116:119], a[52:55], v[220:223]
    s_sub_u32 s21, s21, 8064
    v_exp_f32 v232, v232
    v_mfma_f32_16x16x32_bf16 v[220:223], a[112:115], a[48:51], v[220:223]
    s_max_i32 s10, s21, 0
    ds_read_b128 a[104:107], v1 offset:17536
    v_mfma_f32_16x16x32_bf16 v[132:135], v[208:211], a[176:179], v[132:135]
    v_exp_f32 v233, v233
    v_mfma_f32_16x16x32_bf16 v[132:135], v[204:207], a[180:183], v[132:135]
    ds_read_b64_tr_b16 a[168:169], v2 offset:8368
    v_mfma_f32_16x16x32_bf16 v[136:139], v[204:207], a[188:191], v[136:139]
L_pad6:
    s_cbranch_execz L_warmed
    v_exp_f32 v234, v234
    v_mfma_f32_16x16x32_bf16 v[136:139], v[208:211], a[184:187], v[136:139]
    ds_read_b128 a[108:111], v1 offset:17600
    v_mfma_f32_16x16x32_bf16 v[140:143], v[208:211], a[192:195], v[140:143]
    v_exp_f32 v235, v235
    v_mfma_f32_16x16x32_bf16 v[140:143], v[204:207], a[196:199], v[140:143]
    ds_read_b64_tr_b16 a[170:171], v2 offset:8880
    v_mfma_f32_16x16x32_bf16 v[144:147], v[204:207], a[204:207], v[144:147]
    v_cvt_pk_bf16_f32 v202, v232, v233
    v_cvt_pk_bf16_f32 v203, v234, v235
    v_mfma_f32_16x16x32_bf16 v[144:147], v[208:211], a[200:203], v[144:147]
    ds_read_b64_tr_b16 a[172:173], v2 offset:12528
    ds_read_b64_tr_b16 a[174:175], v2 offset:13040
    v_mfma_f32_16x16x32_bf16 v[176:179], v[216:219], a[200:203], v[176:179]
    v_exp_f32 v224, v224
    v_mfma_f32_16x16x32_bf16 v[176:179], v[212:215], a[204:207], v[176:179]
    ds_read_b64_tr_b16 a[240:241], v0 offset:1088
    ds_read_b64_tr_b16 a[242:243], v0 offset:1120
    v_mfma_f32_16x16x32_bf16 v[172:175], v[212:215], a[196:199], v[172:175]
    v_exp_f32 v225, v225
    v_mfma_f32_16x16x32_bf16 v[172:175], v[216:219], a[192:195], v[172:175]
    v_mfma_f32_16x16x32_bf16 v[168:171], v[216:219], a[184:187], v[168:171]
    v_exp_f32 v226, v226
    v_mfma_f32_16x16x32_bf16 v[168:171], v[212:215], a[188:191], v[168:171]
    v_mfma_f32_16x16x32_bf16 v[164:167], v[212:215], a[180:183], v[164:167]
    v_exp_f32 v227, v227
    v_mfma_f32_16x16x32_bf16 v[164:167], v[216:219], a[176:179], v[164:167]
    v_mfma_f32_16x16x32_bf16 v[228:231], a[112:115], a[64:67], v[252:255]
    v_cvt_pk_bf16_f32 v210, v224, v225
    v_cvt_pk_bf16_f32 v211, v226, v227
    v_mfma_f32_16x16x32_bf16 v[228:231], a[116:119], a[68:71], v[228:231]
    v_exp_f32 v220, v220
    v_mfma_f32_16x16x32_bf16 v[228:231], a[120:123], a[72:75], v[228:231]
    s_waitcnt vmcnt(11) lgkmcnt(0)
    v_exp_f32 v221, v221
    v_mfma_f32_16x16x32_bf16 v[228:231], a[124:127], a[76:79], v[228:231]
    s_barrier
    v_mfma_f32_16x16x32_bf16 v[232:235], a[140:143], a[76:79], v[252:255]
    v_exp_f32 v222, v222
    v_mfma_f32_16x16x32_bf16 v[232:235], a[136:139], a[72:75], v[232:235]
    v_exp_f32 v223, v223
    v_mfma_f32_16x16x32_bf16 v[232:235], a[132:135], a[68:71], v[232:235]
    v_cvt_pk_bf16_f32 v208, v220, v221
    v_cvt_pk_bf16_f32 v209, v222, v223
    v_mfma_f32_16x16x32_bf16 v[232:235], a[128:131], a[64:67], v[232:235]
    v_mfma_f32_16x16x32_bf16 v[224:227], a[96:99], a[0:3], v[236:239]
    v_exp_f32 v228, v228
    v_mfma_f32_16x16x32_bf16 v[224:227], a[100:103], a[4:7], v[224:227]
    s_add_u32 m0, s24, 16896
    v_exp_f32 v229, v229
    v_mfma_f32_16x16x32_bf16 v[224:227], a[104:107], a[8:11], v[224:227]
    v_exp_f32 v230, v230
    v_mfma_f32_16x16x32_bf16 v[224:227], a[108:111], a[12:15], v[224:227]
    buffer_load_dwordx4 v3, s[4:7], 0 offen nt lds
    v_mfma_f32_16x16x32_bf16 v[220:223], a[92:95], a[12:15], v[236:239]
    v_exp_f32 v231, v231
    v_mfma_f32_16x16x32_bf16 v[220:223], a[88:91], a[8:11], v[220:223]
    v_cvt_pk_bf16_f32 v216, v228, v229
    v_cvt_pk_bf16_f32 v217, v230, v231
    v_mfma_f32_16x16x32_bf16 v[220:223], a[84:87], a[4:7], v[220:223]
    v_exp_f32 v232, v232
    v_mfma_f32_16x16x32_bf16 v[220:223], a[80:83], a[0:3], v[220:223]
    ds_read_b128 a[112:115], v1 offset:25344
    v_smfmac_f32_16x16x64_bf16 a[208:211], a[228:231], v[180:187], v10
    ds_read_b64_tr_b16 a[176:177], v2 offset:16640
    v_smfmac_f32_16x16x64_bf16 a[212:215], a[228:231], v[188:195], v10
    ds_read_b128 a[116:119], v1 offset:25408
    v_mfma_f32_16x16x32_bf16 v[20:23], v[180:183], a[144:147], v[20:23]
    v_exp_f32 v233, v233
    v_mfma_f32_16x16x32_bf16 v[20:23], v[184:187], a[148:151], v[20:23]
    ds_read_b64_tr_b16 a[178:179], v2 offset:17152
    v_mfma_f32_16x16x32_bf16 v[24:27], v[184:187], a[156:159], v[24:27]
    v_exp_f32 v234, v234
    v_mfma_f32_16x16x32_bf16 v[24:27], v[180:183], a[152:155], v[24:27]
    ds_read_b64_tr_b16 a[180:181], v2 offset:20800
    v_mfma_f32_16x16x32_bf16 v[28:31], v[180:183], a[160:163], v[28:31]
    v_exp_f32 v235, v235
    v_mfma_f32_16x16x32_bf16 v[28:31], v[184:187], a[164:167], v[28:31]
    ds_read_b64_tr_b16 a[182:183], v2 offset:21312
    v_mfma_f32_16x16x32_bf16 v[32:35], v[184:187], a[172:175], v[32:35]
    v_cvt_pk_bf16_f32 v218, v232, v233
    v_cvt_pk_bf16_f32 v219, v234, v235
    v_mfma_f32_16x16x32_bf16 v[32:35], v[180:183], a[168:171], v[32:35]
    ds_read_b128 a[120:123], v1 offset:25472
    v_mfma_f32_16x16x32_bf16 v[64:67], v[188:191], a[168:171], v[64:67]
    v_exp_f32 v224, v224
    v_mfma_f32_16x16x32_bf16 v[64:67], v[192:195], a[172:175], v[64:67]
    s_add_u32 m0, s24, 16928
    ds_read_b64_tr_b16 a[184:185], v2 offset:16656
    v_mfma_f32_16x16x32_bf16 v[60:63], v[192:195], a[164:167], v[60:63]
    v_exp_f32 v225, v225
    v_mfma_f32_16x16x32_bf16 v[60:63], v[188:191], a[160:163], v[60:63]
    buffer_load_dwordx4 v3, s[4:7], 0 offen offset:1024 nt lds
    v_mfma_f32_16x16x32_bf16 v[56:59], v[188:191], a[152:155], v[56:59]
    s_add_u32 s4, s4, 8192
    v_exp_f32 v226, v226
    v_mfma_f32_16x16x32_bf16 v[56:59], v[192:195], a[156:159], v[56:59]
    s_addc_u32 s5, s5, 0
    ds_read_b128 a[124:127], v1 offset:25536
    v_mfma_f32_16x16x32_bf16 v[52:55], v[192:195], a[148:151], v[52:55]
    s_sub_u32 s20, s20, 8192
    v_exp_f32 v227, v227
    v_mfma_f32_16x16x32_bf16 v[52:55], v[188:191], a[144:147], v[52:55]
    s_max_i32 s6, s20, 0
    ds_read_b64_tr_b16 a[186:187], v2 offset:17168
    v_mfma_f32_16x16x32_bf16 v[228:231], a[80:83], a[16:19], v[240:243]
    v_cvt_pk_bf16_f32 v182, v224, v225
    v_cvt_pk_bf16_f32 v183, v226, v227
    v_mfma_f32_16x16x32_bf16 v[228:231], a[84:87], a[20:23], v[228:231]
    v_exp_f32 v220, v220
    v_mfma_f32_16x16x32_bf16 v[228:231], a[88:91], a[24:27], v[228:231]
    v_exp_f32 v221, v221
    v_mfma_f32_16x16x32_bf16 v[228:231], a[92:95], a[28:31], v[228:231]
    ds_read_b64_tr_b16 a[188:189], v2 offset:20816
    v_mfma_f32_16x16x32_bf16 v[232:235], a[108:111], a[28:31], v[240:243]
    v_exp_f32 v222, v222
    v_mfma_f32_16x16x32_bf16 v[232:235], a[104:107], a[24:27], v[232:235]
    v_exp_f32 v223, v223
    v_mfma_f32_16x16x32_bf16 v[232:235], a[100:103], a[20:23], v[232:235]
    v_cvt_pk_bf16_f32 v180, v220, v221
    v_cvt_pk_bf16_f32 v181, v222, v223
    v_mfma_f32_16x16x32_bf16 v[232:235], a[96:99], a[16:19], v[232:235]
    ds_read_b64_tr_b16 a[190:191], v2 offset:21328
    v_mfma_f32_16x16x32_bf16 v[224:227], a[96:99], a[32:35], v[244:247]
    v_exp_f32 v228, v228
    v_mfma_f32_16x16x32_bf16 v[224:227], a[100:103], a[36:39], v[224:227]
    s_add_u32 m0, s25, 8320
    v_exp_f32 v229, v229
    v_mfma_f32_16x16x32_bf16 v[224:227], a[104:107], a[40:43], v[224:227]
    v_exp_f32 v230, v230
    v_mfma_f32_16x16x32_bf16 v[224:227], a[108:111], a[44:47], v[224:227]
    buffer_load_dwordx4 v4, s[8:11], 0 offen nt lds
    v_mfma_f32_16x16x32_bf16 v[220:223], a[92:95], a[44:47], v[244:247]
    v_exp_f32 v231, v231
    v_mfma_f32_16x16x32_bf16 v[220:223], a[88:91], a[40:43], v[220:223]
    v_cvt_pk_bf16_f32 v188, v228, v229
    v_cvt_pk_bf16_f32 v189, v230, v231
    v_mfma_f32_16x16x32_bf16 v[220:223], a[84:87], a[36:39], v[220:223]
    v_exp_f32 v232, v232
    v_mfma_f32_16x16x32_bf16 v[220:223], a[80:83], a[32:35], v[220:223]
    ds_read_b128 a[128:131], v1 offset:25856
    v_smfmac_f32_16x16x64_bf16 a[216:219], a[228:231], v[196:203], v10
    ds_read_b64_tr_b16 a[192:193], v2 offset:16672
    v_smfmac_f32_16x16x64_bf16 a[220:223], a[228:231], v[204:211], v10
    ds_read_b128 a[132:135], v1 offset:25920
    v_smfmac_f32_16x16x64_bf16 a[224:227], a[228:231], v[212:219], v10
    ds_read_b64_tr_b16 a[194:195], v2 offset:17184
    v_mfma_f32_16x16x32_bf16 v[84:87], v[196:199], a[144:147], v[84:87]
    v_exp_f32 v233, v233
    v_mfma_f32_16x16x32_bf16 v[84:87], v[200:203], a[148:151], v[84:87]
    ds_read_b64_tr_b16 a[196:197], v2 offset:20832
    v_mfma_f32_16x16x32_bf16 v[88:91], v[200:203], a[156:159], v[88:91]
    v_exp_f32 v234, v234
    v_mfma_f32_16x16x32_bf16 v[88:91], v[196:199], a[152:155], v[88:91]
    ds_read_b64_tr_b16 a[198:199], v2 offset:21344
    v_mfma_f32_16x16x32_bf16 v[92:95], v[196:199], a[160:163], v[92:95]
    v_exp_f32 v235, v235
    v_mfma_f32_16x16x32_bf16 v[92:95], v[200:203], a[164:167], v[92:95]
    ds_read_b128 a[136:139], v1 offset:25984
    v_mfma_f32_16x16x32_bf16 v[96:99], v[200:203], a[172:175], v[96:99]
    v_cvt_pk_bf16_f32 v190, v232, v233
    v_cvt_pk_bf16_f32 v191, v234, v235
    v_mfma_f32_16x16x32_bf16 v[96:99], v[196:199], a[168:171], v[96:99]
    ds_read_b64_tr_b16 a[200:201], v2 offset:16688
    v_mfma_f32_16x16x32_bf16 v[128:131], v[204:207], a[168:171], v[128:131]
    v_exp_f32 v224, v224
    v_mfma_f32_16x16x32_bf16 v[128:131], v[208:211], a[172:175], v[128:131]
    s_add_u32 m0, s25, 8336
    ds_read_b128 a[140:143], v1 offset:26048
    v_mfma_f32_16x16x32_bf16 v[124:127], v[208:211], a[164:167], v[124:127]
    v_exp_f32 v225, v225
    v_mfma_f32_16x16x32_bf16 v[124:127], v[204:207], a[160:163], v[124:127]
    buffer_load_dwordx4 v4, s[8:11], 0 offen offset:1024 nt lds
    v_mfma_f32_16x16x32_bf16 v[120:123], v[204:207], a[152:155], v[120:123]
    s_add_u32 s8, s8, 8320
    v_exp_f32 v226, v226
    v_mfma_f32_16x16x32_bf16 v[120:123], v[208:211], a[156:159], v[120:123]
    s_addc_u32 s9, s9, 0
    ds_read_b64_tr_b16 a[202:203], v2 offset:17200
    v_mfma_f32_16x16x32_bf16 v[116:119], v[208:211], a[148:151], v[116:119]
    s_sub_u32 s21, s21, 8320
    v_exp_f32 v227, v227
    v_mfma_f32_16x16x32_bf16 v[116:119], v[204:207], a[144:147], v[116:119]
    s_max_i32 s10, s21, 0
    ds_read_b64_tr_b16 a[204:205], v2 offset:20848
    v_mfma_f32_16x16x32_bf16 v[228:231], a[80:83], a[48:51], v[248:251]
    v_cvt_pk_bf16_f32 v198, v224, v225
    v_cvt_pk_bf16_f32 v199, v226, v227
    v_mfma_f32_16x16x32_bf16 v[228:231], a[84:87], a[52:55], v[228:231]
    v_exp_f32 v220, v220
    v_mfma_f32_16x16x32_bf16 v[228:231], a[88:91], a[56:59], v[228:231]
    v_exp_f32 v221, v221
    v_mfma_f32_16x16x32_bf16 v[228:231], a[92:95], a[60:63], v[228:231]
    ds_read_b64_tr_b16 a[206:207], v2 offset:21360
    v_mfma_f32_16x16x32_bf16 v[232:235], a[108:111], a[60:63], v[248:251]
    v_exp_f32 v222, v222
    v_mfma_f32_16x16x32_bf16 v[232:235], a[104:107], a[56:59], v[232:235]
    v_exp_f32 v223, v223
    v_mfma_f32_16x16x32_bf16 v[232:235], a[100:103], a[52:55], v[232:235]
    v_cvt_pk_bf16_f32 v196, v220, v221
    v_cvt_pk_bf16_f32 v197, v222, v223
    v_mfma_f32_16x16x32_bf16 v[232:235], a[96:99], a[48:51], v[232:235]
    v_mfma_f32_16x16x32_bf16 v[224:227], a[96:99], a[64:67], v[252:255]
    s_lshr_b64 vcc, vcc, 1
    v_exp_f32 v228, v228
    v_mfma_f32_16x16x32_bf16 v[224:227], a[100:103], a[68:71], v[224:227]
    v_exp_f32 v229, v229
    v_mfma_f32_16x16x32_bf16 v[224:227], a[104:107], a[72:75], v[224:227]
    v_exp_f32 v230, v230
    v_mfma_f32_16x16x32_bf16 v[224:227], a[108:111], a[76:79], v[224:227]
    v_mfma_f32_16x16x32_bf16 v[220:223], a[92:95], a[76:79], v[252:255]
    v_exp_f32 v231, v231
    v_mfma_f32_16x16x32_bf16 v[220:223], a[88:91], a[72:75], v[220:223]
    v_cvt_pk_bf16_f32 v204, v228, v229
    v_cvt_pk_bf16_f32 v205, v230, v231
    v_mfma_f32_16x16x32_bf16 v[220:223], a[84:87], a[68:71], v[220:223]
    v_exp_f32 v232, v232
    v_mfma_f32_16x16x32_bf16 v[220:223], a[80:83], a[64:67], v[220:223]
    ds_read_b64_tr_b16 a[244:245], v0 offset:2176
    ds_read_b64_tr_b16 a[246:247], v0 offset:2208
    v_mfma_f32_16x16x32_bf16 v[148:151], v[212:215], a[144:147], v[148:151]
    v_exp_f32 v233, v233
    v_mfma_f32_16x16x32_bf16 v[148:151], v[216:219], a[148:151], v[148:151]
    v_mfma_f32_16x16x32_bf16 v[152:155], v[216:219], a[156:159], v[152:155]
    v_exp_f32 v234, v234
    v_mfma_f32_16x16x32_bf16 v[152:155], v[212:215], a[152:155], v[152:155]
    v_mfma_f32_16x16x32_bf16 v[156:159], v[212:215], a[160:163], v[156:159]
    s_waitcnt vmcnt(8) lgkmcnt(0)
    v_exp_f32 v235, v235
    v_mfma_f32_16x16x32_bf16 v[156:159], v[216:219], a[164:167], v[156:159]
    s_barrier
    v_mfma_f32_16x16x32_bf16 v[160:163], v[216:219], a[172:175], v[160:163]
    v_cvt_pk_bf16_f32 v206, v232, v233
    v_cvt_pk_bf16_f32 v207, v234, v235
    v_mfma_f32_16x16x32_bf16 v[160:163], v[212:215], a[168:171], v[160:163]
    s_cbranch_vccnz L_loop1_0
L_final:
    v_exp_f32 v226, v226
    v_mfma_f32_16x16x32_bf16 v[232:235], a[140:143], a[12:15], v[236:239]
    v_exp_f32 v224, v224
    v_mfma_f32_16x16x32_bf16 v[232:235], a[136:139], a[8:11], v[232:235]
    s_mov_b32 s32, s38
    ds_read_b64_tr_b16 a[174:175], v2 offset:29680
    ds_read_b64_tr_b16 a[152:153], v2 offset:24976
    v_mfma_f32_16x16x32_bf16 v[232:235], a[132:135], a[4:7], v[232:235]
    v_exp_f32 v221, v221
    v_mfma_f32_16x16x32_bf16 v[232:235], a[128:131], a[0:3], v[232:235]
    ds_read_b64_tr_b16 a[144:145], v2 offset:24960
    ds_read_b64_tr_b16 a[150:151], v2 offset:29632
    v_mfma_f32_16x16x32_bf16 v[40:43], v[180:183], a[188:191], v[40:43]
    ds_read_b64_tr_b16 a[160:161], v2 offset:24992
    ds_read_b64_tr_b16 a[154:155], v2 offset:25488
    v_mfma_f32_16x16x32_bf16 v[40:43], v[184:187], a[184:187], v[40:43]
    v_exp_f32 v227, v227
    v_mfma_f32_16x16x32_bf16 v[36:39], v[184:187], a[176:179], v[36:39]
    v_exp_f32 v225, v225
    v_mfma_f32_16x16x32_bf16 v[36:39], v[180:183], a[180:183], v[36:39]
    v_exp_f32 v235, v235
    v_mfma_f32_16x16x32_bf16 v[72:75], v[188:191], a[188:191], v[72:75]
    ds_read_b64_tr_b16 a[148:149], v2 offset:29120
    v_exp_f32 v232, v232
    v_mfma_f32_16x16x32_bf16 v[228:231], a[112:115], a[0:3], v[236:239]
    v_exp_f32 v222, v222
    v_mfma_f32_16x16x32_bf16 v[228:231], a[116:119], a[4:7], v[228:231]
    s_add_u32 s16, s16, 159744
    v_exp_f32 v223, v223
    v_mfma_f32_16x16x32_bf16 v[228:231], a[120:123], a[8:11], v[228:231]
    ds_read_b64_tr_b16 a[158:159], v2 offset:29648
    ds_read_b64_tr_b16 a[170:171], v2 offset:25520
    v_mfma_f32_16x16x32_bf16 v[228:231], a[124:127], a[12:15], v[228:231]
    s_waitcnt vmcnt(4)
    v_exp_f32 v220, v220
    v_mfma_f32_16x16x32_bf16 v[48:51], v[180:183], a[204:207], v[48:51]
    s_barrier
    ds_read_b64_tr_b16 a[156:157], v2 offset:29136
    v_cvt_pk_bf16_f32 v212, v220, v221
    v_mfma_f32_16x16x32_bf16 v[48:51], v[184:187], a[200:203], v[48:51]
    s_nop 0
    v_exp_f32 v228, v228
    v_cvt_pk_bf16_f32 v213, v222, v223
    v_mfma_f32_16x16x32_bf16 v[44:47], v[184:187], a[192:195], v[44:47]
    v_cvt_pk_bf16_f32 v215, v226, v227
    v_exp_f32 v229, v229
    v_exp_f32 v233, v233
    v_mfma_f32_16x16x32_bf16 v[220:223], a[112:115], a[16:19], v[240:243]
    ds_read_b64_tr_b16 a[146:147], v2 offset:25472
    ds_read_b64_tr_b16 a[236:237], v2 offset:0
    v_mfma_f32_16x16x32_bf16 v[220:223], a[116:119], a[20:23], v[220:223]
    ds_read_b64_tr_b16 a[162:163], v2 offset:25504
    v_cvt_pk_bf16_f32 v214, v224, v225
    v_mfma_f32_16x16x32_bf16 v[220:223], a[120:123], a[24:27], v[220:223]
    v_exp_f32 v231, v231
    v_mfma_f32_16x16x32_bf16 v[224:227], a[140:143], a[28:31], v[240:243]
    v_exp_f32 v230, v230
    v_mfma_f32_16x16x32_bf16 v[224:227], a[136:139], a[24:27], v[224:227]
    v_exp_f32 v234, v234
    v_mfma_f32_16x16x32_bf16 v[224:227], a[132:135], a[20:23], v[224:227]
    ds_read_b64_tr_b16 a[244:245], v2 offset:32
    v_cvt_pk_bf16_f32 v184, v228, v229
    v_mfma_f32_16x16x32_bf16 v[224:227], a[128:131], a[16:19], v[224:227]
    ds_read_b64_tr_b16 a[242:243], v2 offset:528
    v_cvt_pk_bf16_f32 v186, v232, v233
    s_waitcnt lgkmcnt(2)
    v_mfma_f32_16x16x32_bf16 v[28:31], v[180:183], a[160:163], v[28:31]
    v_cvt_pk_bf16_f32 v187, v234, v235
    v_cvt_pk_bf16_f32 v185, v230, v231
    v_mfma_f32_16x16x32_bf16 v[220:223], a[124:127], a[28:31], v[220:223]
    ds_read_b64_tr_b16 a[172:173], v2 offset:29168
    ds_read_b64_tr_b16 a[246:247], v2 offset:544
    v_smfmac_f32_16x16x64_bf16 a[208:211], a[228:231], v[180:187], v10
    ds_read_b64_tr_b16 a[238:239], v2 offset:512
    ds_read_b64_tr_b16 a[166:167], v2 offset:29664
    v_mfma_f32_16x16x32_bf16 v[20:23], v[180:183], a[144:147], v[20:23]
    v_exp_f32 v227, v227
    v_mfma_f32_16x16x32_bf16 v[20:23], v[184:187], a[148:151], v[20:23]
    ds_read_b64_tr_b16 a[164:165], v2 offset:29152
    ds_read_b64_tr_b16 a[248:249], v2 offset:48
    v_mfma_f32_16x16x32_bf16 v[24:27], v[184:187], a[156:159], v[24:27]
    ds_read_b64_tr_b16 a[240:241], v2 offset:16
    ds_read_b64_tr_b16 a[168:169], v2 offset:25008
    v_mfma_f32_16x16x32_bf16 v[80:83], v[188:191], a[204:207], v[80:83]
    s_nop 0
    v_accvgpr_read_b32 v5, a209
    v_accvgpr_read_b32 v0, a208
    v_mfma_f32_16x16x32_bf16 v[44:47], v[180:183], a[196:199], v[44:47]
    v_exp_f32 v220, v220
    s_waitcnt lgkmcnt(5)
    v_mfma_f32_16x16x32_bf16 v[36:39], v[184:187], a[236:239], v[36:39]
    v_add_f32 v0, v0, v5
    v_rcp_f32 v5, v0
    v_mfma_f32_16x16x32_bf16 v[44:47], v[184:187], a[244:247], v[44:47]
    ds_write_b32 v8, v5
    v_mfma_f32_16x16x32_bf16 v[68:71], v[192:195], a[176:179], v[68:71]
    ds_read_b64_tr_b16 a[250:251], v2 offset:560
    ds_read_b128 v[236:239], v9
    v_mfma_f32_16x16x32_bf16 v[68:71], v[188:191], a[180:183], v[68:71]
    v_exp_f32 v222, v222
    v_mfma_f32_16x16x32_bf16 v[32:35], v[184:187], a[172:175], v[32:35]
    v_accvgpr_read_b32 v12, a232
    s_waitcnt lgkmcnt(3)
    v_mfma_f32_16x16x32_bf16 v[32:35], v[180:183], a[168:171], v[32:35]
    v_exp_f32 v223, v223
    v_mfma_f32_16x16x32_bf16 v[40:43], v[184:187], a[240:243], v[40:43]
    v_exp_f32 v224, v224
    v_mfma_f32_16x16x32_bf16 v[24:27], v[180:183], a[152:155], v[24:27]
    s_addc_u32 s17, s17, 0
    v_exp_f32 v226, v226
    v_mfma_f32_16x16x32_bf16 v[28:31], v[184:187], a[164:167], v[28:31]
    s_waitcnt lgkmcnt(0)
    v_mul_f32 v19, v12, v239
    v_mul_f32 v18, v12, v238
    v_exp_f32 v225, v225
    v_mul_f32 v16, v12, v236
    v_pk_fma_f32 v[46:47], v[46:47], v[238:239], v[18:19] neg_lo:[0,0,1] neg_hi:[0,0,1]
    v_pk_fma_f32 v[22:23], v[22:23], v[238:239], v[18:19] neg_lo:[0,0,1] neg_hi:[0,0,1]
    v_pk_fma_f32 v[42:43], v[42:43], v[238:239], v[18:19] neg_lo:[0,0,1] neg_hi:[0,0,1]
    v_mul_f32 v17, v12, v237
    v_pk_fma_f32 v[44:45], v[44:45], v[236:237], v[16:17] neg_lo:[0,0,1] neg_hi:[0,0,1]
    v_pk_fma_f32 v[34:35], v[34:35], v[238:239], v[18:19] neg_lo:[0,0,1] neg_hi:[0,0,1]
    v_pk_fma_f32 v[24:25], v[24:25], v[236:237], v[16:17] neg_lo:[0,0,1] neg_hi:[0,0,1]
    v_pk_fma_f32 v[20:21], v[20:21], v[236:237], v[16:17] neg_lo:[0,0,1] neg_hi:[0,0,1]
    v_pk_fma_f32 v[26:27], v[26:27], v[238:239], v[18:19] neg_lo:[0,0,1] neg_hi:[0,0,1]
    v_cvt_pk_bf16_f32 v180, v20, v24
    v_pk_fma_f32 v[40:41], v[40:41], v[236:237], v[16:17] neg_lo:[0,0,1] neg_hi:[0,0,1]
    v_pk_fma_f32 v[32:33], v[32:33], v[236:237], v[16:17] neg_lo:[0,0,1] neg_hi:[0,0,1]
    v_pk_fma_f32 v[30:31], v[30:31], v[238:239], v[18:19] neg_lo:[0,0,1] neg_hi:[0,0,1]
    v_pk_fma_f32 v[38:39], v[38:39], v[238:239], v[18:19] neg_lo:[0,0,1] neg_hi:[0,0,1]
    v_pk_fma_f32 v[36:37], v[36:37], v[236:237], v[16:17] neg_lo:[0,0,1] neg_hi:[0,0,1]
    v_pk_fma_f32 v[28:29], v[28:29], v[236:237], v[16:17] neg_lo:[0,0,1] neg_hi:[0,0,1]
    v_mfma_f32_16x16x32_bf16 v[48:51], v[184:187], a[248:251], v[48:51]
    v_cvt_pk_bf16_f32 v184, v21, v25
    v_cvt_pk_bf16_f32 v181, v28, v32
    v_mfma_f32_16x16x32_bf16 v[76:79], v[192:195], a[192:195], v[76:79]
    v_cmp_ngt_f32 s[46:47], s39, v0
    v_cvt_pk_bf16_f32 v185, v29, v33
    v_mfma_f32_16x16x32_bf16 v[76:79], v[188:191], a[196:199], v[76:79]
    ds_write_b64 v6, v[180:181] offset:0
    v_exp_f32 v221, v221
    v_pk_fma_f32 v[48:49], v[48:49], v[236:237], v[16:17] neg_lo:[0,0,1] neg_hi:[0,0,1]
    v_pk_fma_f32 v[50:51], v[50:51], v[238:239], v[18:19] neg_lo:[0,0,1] neg_hi:[0,0,1]
    v_mfma_f32_16x16x32_bf16 v[104:107], v[196:199], a[188:191], v[104:107]
    s_mov_b32 s18, 159744
    v_cvt_pk_bf16_f32 v183, v44, v48
    v_cvt_pk_bf16_f32 v182, v36, v40
    v_mfma_f32_16x16x32_bf16 v[80:83], v[192:195], a[200:203], v[80:83]
    ds_write_b64 v6, v[182:183] offset:128
    v_mfma_f32_16x16x32_bf16 v[72:75], v[192:195], a[184:187], v[72:75]
    v_cvt_pk_bf16_f32 v194, v224, v225
    v_cvt_pk_bf16_f32 v192, v220, v221
    v_mfma_f32_16x16x32_bf16 v[228:231], a[112:115], a[32:35], v[244:247]
    ds_read_b64_tr_b16 a[0:1], v7 offset:0
    v_cvt_pk_bf16_f32 v187, v45, v49
    v_mfma_f32_16x16x32_bf16 v[228:231], a[116:119], a[36:39], v[228:231]
    s_mov_b64 s[44:45], 0
    ds_read_b64_tr_b16 a[2:3], v7 offset:32
    v_cvt_pk_bf16_f32 v195, v226, v227
    v_mfma_f32_16x16x32_bf16 v[228:231], a[120:123], a[40:43], v[228:231]
    ds_write_b64 v6, v[184:185] offset:1088
    v_mfma_f32_16x16x32_bf16 v[232:235], a[140:143], a[44:47], v[244:247]
    v_cvt_pk_bf16_f32 v186, v37, v41
    v_cvt_pk_bf16_f32 v193, v222, v223
    v_mfma_f32_16x16x32_bf16 v[232:235], a[136:139], a[40:43], v[232:235]
    s_or_b64 s[44:45], s[44:45], s[46:47]
    ds_write_b64 v6, v[186:187] offset:1216
    v_mfma_f32_16x16x32_bf16 v[228:231], a[124:127], a[44:47], v[228:231]
    v_cvt_pk_bf16_f32 v186, v39, v43
    v_cvt_pk_bf16_f32 v187, v47, v51
    v_smfmac_f32_16x16x64_bf16 a[212:215], a[228:231], v[188:195], v10
    ds_read_b64_tr_b16 a[6:7], v7 offset:1120
    ds_read_b64_tr_b16 a[4:5], v7 offset:1088
    v_cvt_pk_bf16_f32 v180, v22, v26
    v_mfma_f32_16x16x32_bf16 v[232:235], a[132:135], a[36:39], v[232:235]
    s_waitcnt lgkmcnt(4)
    buffer_store_dwordx4 a[0:3], v3, s[16:19], s32 offen offset:0 sc1 nt
    v_cvt_pk_bf16_f32 v181, v30, v34
    v_cvt_pk_bf16_f32 v185, v31, v35
    v_cvt_pk_bf16_f32 v184, v23, v27
    v_cvt_pk_bf16_f32 v183, v46, v50
    v_cvt_pk_bf16_f32 v182, v38, v42
    v_mfma_f32_16x16x32_bf16 v[60:63], v[188:191], a[160:163], v[60:63]
    ds_write_b64 v6, v[180:181] offset:2176
    v_mfma_f32_16x16x32_bf16 v[52:55], v[188:191], a[144:147], v[52:55]
    v_accvgpr_read_b32 v0, a212
    v_accvgpr_read_b32 v5, a213
    v_mfma_f32_16x16x32_bf16 v[52:55], v[192:195], a[148:151], v[52:55]
    s_waitcnt lgkmcnt(1)
    buffer_store_dwordx4 a[4:7], v3, s[16:19], s32 offen offset:1024 sc1 nt
    ds_write_b64 v6, v[182:183] offset:2304
    v_add_f32 v0, v0, v5
    v_cmp_ngt_f32 s[46:47], s39, v0
    v_mfma_f32_16x16x32_bf16 v[56:59], v[192:195], a[156:159], v[56:59]
    ds_write_b64 v6, v[184:185] offset:3264
    v_mfma_f32_16x16x32_bf16 v[60:63], v[192:195], a[164:167], v[60:63]
    v_rcp_f32 v5, v0
    v_mfma_f32_16x16x32_bf16 v[232:235], a[128:131], a[32:35], v[232:235]
    ds_write_b32 v8, v5
    ds_read_b128 v[240:243], v9
    v_mfma_f32_16x16x32_bf16 v[76:79], v[192:195], a[244:247], v[76:79]
    v_exp_f32 v228, v228
    v_mfma_f32_16x16x32_bf16 v[64:67], v[192:195], a[172:175], v[64:67]
    s_or_b64 s[44:45], s[44:45], s[46:47]
    ds_write_b64 v6, v[186:187] offset:3392
    v_mfma_f32_16x16x32_bf16 v[64:67], v[188:191], a[168:171], v[64:67]
    v_exp_f32 v231, v231
    v_mfma_f32_16x16x32_bf16 v[80:83], v[192:195], a[248:251], v[80:83]
    ds_read_b64_tr_b16 a[8:9], v7 offset:2176
    ds_read_b64_tr_b16 a[12:13], v7 offset:3264
    v_mfma_f32_16x16x32_bf16 v[56:59], v[188:191], a[152:155], v[56:59]
    v_exp_f32 v235, v235
    v_mfma_f32_16x16x32_bf16 v[108:111], v[200:203], a[192:195], v[108:111]
    ds_read_b64_tr_b16 a[14:15], v7 offset:3296
    ds_read_b64_tr_b16 a[10:11], v7 offset:2208
    v_mfma_f32_16x16x32_bf16 v[108:111], v[196:199], a[196:199], v[108:111]
    v_exp_f32 v230, v230
    v_mfma_f32_16x16x32_bf16 v[100:103], v[200:203], a[176:179], v[100:103]
    v_exp_f32 v233, v233
    v_mfma_f32_16x16x32_bf16 v[72:75], v[192:195], a[240:243], v[72:75]
    v_exp_f32 v232, v232
    v_mfma_f32_16x16x32_bf16 v[112:115], v[196:199], a[204:207], v[112:115]
    v_exp_f32 v234, v234
    v_mfma_f32_16x16x32_bf16 v[68:71], v[192:195], a[236:239], v[68:71]
    v_exp_f32 v229, v229
    v_mfma_f32_16x16x32_bf16 v[104:107], v[200:203], a[184:187], v[104:107]
    s_waitcnt lgkmcnt(0)
    buffer_store_dwordx4 a[8:11], v3, s[16:19], s32 offen offset:2048 sc1 nt
    buffer_store_dwordx4 a[12:15], v3, s[16:19], s32 offen offset:3072 sc1 nt
    v_mul_f32 v19, v12, v243
    v_mul_f32 v17, v12, v241
    v_mul_f32 v18, v12, v242
    v_pk_fma_f32 v[54:55], v[54:55], v[242:243], v[18:19] neg_lo:[0,0,1] neg_hi:[0,0,1]
    v_pk_fma_f32 v[66:67], v[66:67], v[242:243], v[18:19] neg_lo:[0,0,1] neg_hi:[0,0,1]
    v_pk_fma_f32 v[82:83], v[82:83], v[242:243], v[18:19] neg_lo:[0,0,1] neg_hi:[0,0,1]
    v_mul_f32 v16, v12, v240
    v_pk_fma_f32 v[60:61], v[60:61], v[240:241], v[16:17] neg_lo:[0,0,1] neg_hi:[0,0,1]
    v_pk_fma_f32 v[56:57], v[56:57], v[240:241], v[16:17] neg_lo:[0,0,1] neg_hi:[0,0,1]
    v_pk_fma_f32 v[64:65], v[64:65], v[240:241], v[16:17] neg_lo:[0,0,1] neg_hi:[0,0,1]
    v_pk_fma_f32 v[58:59], v[58:59], v[242:243], v[18:19] neg_lo:[0,0,1] neg_hi:[0,0,1]
    v_cvt_pk_bf16_f32 v189, v60, v64
    v_pk_fma_f32 v[72:73], v[72:73], v[240:241], v[16:17] neg_lo:[0,0,1] neg_hi:[0,0,1]
    v_pk_fma_f32 v[62:63], v[62:63], v[242:243], v[18:19] neg_lo:[0,0,1] neg_hi:[0,0,1]
    v_pk_fma_f32 v[68:69], v[68:69], v[240:241], v[16:17] neg_lo:[0,0,1] neg_hi:[0,0,1]
    v_pk_fma_f32 v[80:81], v[80:81], v[240:241], v[16:17] neg_lo:[0,0,1] neg_hi:[0,0,1]
    v_cvt_pk_bf16_f32 v190, v68, v72
    v_pk_fma_f32 v[74:75], v[74:75], v[242:243], v[18:19] neg_lo:[0,0,1] neg_hi:[0,0,1]
    v_pk_fma_f32 v[78:79], v[78:79], v[242:243], v[18:19] neg_lo:[0,0,1] neg_hi:[0,0,1]
    v_pk_fma_f32 v[52:53], v[52:53], v[240:241], v[16:17] neg_lo:[0,0,1] neg_hi:[0,0,1]
    v_pk_fma_f32 v[76:77], v[76:77], v[240:241], v[16:17] neg_lo:[0,0,1] neg_hi:[0,0,1]
    v_cvt_pk_bf16_f32 v192, v53, v57
    v_mfma_f32_16x16x32_bf16 v[112:115], v[200:203], a[200:203], v[112:115]
    v_cvt_pk_bf16_f32 v200, v228, v229
    v_cvt_pk_bf16_f32 v188, v52, v56
    v_mfma_f32_16x16x32_bf16 v[100:103], v[196:199], a[180:183], v[100:103]
    ds_write_b64 v6, v[188:189] offset:4352
    v_mfma_f32_16x16x32_bf16 v[224:227], a[140:143], a[60:63], v[248:251]
    s_add_u32 s32, s32, 4096
    v_cvt_pk_bf16_f32 v191, v76, v80
    v_cvt_pk_bf16_f32 v201, v230, v231
    v_mfma_f32_16x16x32_bf16 v[224:227], a[136:139], a[56:59], v[224:227]
    ds_write_b64 v6, v[190:191] offset:4480
    v_cvt_pk_bf16_f32 v193, v61, v65
    v_mfma_f32_16x16x32_bf16 v[220:223], a[112:115], a[48:51], v[248:251]
    ds_read_b64_tr_b16 a[16:17], v7 offset:4352
    v_cvt_pk_bf16_f32 v203, v234, v235
    v_mfma_f32_16x16x32_bf16 v[220:223], a[116:119], a[52:55], v[220:223]
    ds_read_b64_tr_b16 a[18:19], v7 offset:4384
    ds_write_b64 v6, v[192:193] offset:5440
    v_mfma_f32_16x16x32_bf16 v[224:227], a[132:135], a[52:55], v[224:227]
    v_cvt_pk_bf16_f32 v193, v63, v67
    v_cvt_pk_bf16_f32 v188, v54, v58
    v_mfma_f32_16x16x32_bf16 v[224:227], a[128:131], a[48:51], v[224:227]
    v_cvt_pk_bf16_f32 v194, v69, v73
    v_cvt_pk_bf16_f32 v195, v77, v81
    v_mfma_f32_16x16x32_bf16 v[92:95], v[196:199], a[160:163], v[92:95]
    ds_write_b64 v6, v[194:195] offset:5568
    v_mfma_f32_16x16x32_bf16 v[220:223], a[120:123], a[56:59], v[220:223]
    v_cvt_pk_bf16_f32 v195, v79, v83
    v_cvt_pk_bf16_f32 v202, v232, v233
    v_mfma_f32_16x16x32_bf16 v[220:223], a[124:127], a[60:63], v[220:223]
    ds_read_b64_tr_b16 a[22:23], v7 offset:5472
    v_cvt_pk_bf16_f32 v189, v62, v66
    v_smfmac_f32_16x16x64_bf16 a[216:219], a[228:231], v[196:203], v10
    s_waitcnt lgkmcnt(3)
    buffer_store_dwordx4 a[16:19], v3, s[16:19], s32 offen offset:0 sc1 nt
    ds_read_b64_tr_b16 a[20:21], v7 offset:5440
    ds_write_b64 v6, v[188:189] offset:6528
    v_pk_fma_f32 v[70:71], v[70:71], v[242:243], v[18:19] neg_lo:[0,0,1] neg_hi:[0,0,1]
    v_mfma_f32_16x16x32_bf16 v[136:139], v[204:207], a[188:191], v[136:139]
    v_cvt_pk_bf16_f32 v191, v78, v82
    v_cvt_pk_bf16_f32 v192, v55, v59
    v_mfma_f32_16x16x32_bf16 v[232:235], a[140:143], a[76:79], v[252:255]
    v_cvt_pk_bf16_f32 v190, v70, v74
    v_cvt_pk_bf16_f32 v194, v71, v75
    v_mfma_f32_16x16x32_bf16 v[132:135], v[208:211], a[176:179], v[132:135]
    ds_write_b64 v6, v[190:191] offset:6656
    v_mfma_f32_16x16x32_bf16 v[140:143], v[208:211], a[192:195], v[140:143]
    s_waitcnt lgkmcnt(2)
    buffer_store_dwordx4 a[20:23], v3, s[16:19], s32 offen offset:1024 sc1 nt
    ds_write_b64 v6, v[192:193] offset:7616
    v_accvgpr_read_b32 v0, a216
    v_accvgpr_read_b32 v5, a217
    v_mfma_f32_16x16x32_bf16 v[100:103], v[200:203], a[236:239], v[100:103]
    v_add_f32 v0, v0, v5
    v_cmp_ngt_f32 s[46:47], s39, v0
    v_mfma_f32_16x16x32_bf16 v[92:95], v[200:203], a[164:167], v[92:95]
    ds_write_b64 v6, v[194:195] offset:7744
    v_rcp_f32 v5, v0
    v_mfma_f32_16x16x32_bf16 v[88:91], v[200:203], a[156:159], v[88:91]
    ds_read_b64_tr_b16 a[28:29], v7 offset:7616
    ds_read_b64_tr_b16 a[26:27], v7 offset:6560
    v_mfma_f32_16x16x32_bf16 v[88:91], v[196:199], a[152:155], v[88:91]
    ds_write_b32 v8, v5
    v_mfma_f32_16x16x32_bf16 v[108:111], v[200:203], a[244:247], v[108:111]
    ds_read_b128 v[244:247], v9
    v_exp_f32 v220, v220
    v_mfma_f32_16x16x32_bf16 v[104:107], v[200:203], a[240:243], v[104:107]
    s_or_b64 s[44:45], s[44:45], s[46:47]
    ds_read_b64_tr_b16 a[30:31], v7 offset:7648
    ds_read_b64_tr_b16 a[24:25], v7 offset:6528
    v_mfma_f32_16x16x32_bf16 v[84:87], v[196:199], a[144:147], v[84:87]
    v_exp_f32 v223, v223
    v_mfma_f32_16x16x32_bf16 v[84:87], v[200:203], a[148:151], v[84:87]
    v_exp_f32 v227, v227
    v_mfma_f32_16x16x32_bf16 v[112:115], v[200:203], a[248:251], v[112:115]
    v_exp_f32 v226, v226
    v_exp_f32 v225, v225
    v_mfma_f32_16x16x32_bf16 v[96:99], v[200:203], a[172:175], v[96:99]
    v_exp_f32 v221, v221
    v_mfma_f32_16x16x32_bf16 v[96:99], v[196:199], a[168:171], v[96:99]
    s_waitcnt lgkmcnt(0)
    buffer_store_dwordx4 a[24:27], v3, s[16:19], s32 offen offset:2048 sc1 nt
    buffer_store_dwordx4 a[28:31], v3, s[16:19], s32 offen offset:3072 sc1 nt
    v_mul_f32 v17, v12, v245
    v_mul_f32 v19, v12, v247
    v_mul_f32 v16, v12, v244
    v_pk_fma_f32 v[92:93], v[92:93], v[244:245], v[16:17] neg_lo:[0,0,1] neg_hi:[0,0,1]
    v_pk_fma_f32 v[100:101], v[100:101], v[244:245], v[16:17] neg_lo:[0,0,1] neg_hi:[0,0,1]
    v_mul_f32 v18, v12, v246
    v_pk_fma_f32 v[104:105], v[104:105], v[244:245], v[16:17] neg_lo:[0,0,1] neg_hi:[0,0,1]
    v_pk_fma_f32 v[110:111], v[110:111], v[246:247], v[18:19] neg_lo:[0,0,1] neg_hi:[0,0,1]
    v_pk_fma_f32 v[90:91], v[90:91], v[246:247], v[18:19] neg_lo:[0,0,1] neg_hi:[0,0,1]
    v_pk_fma_f32 v[94:95], v[94:95], v[246:247], v[18:19] neg_lo:[0,0,1] neg_hi:[0,0,1]
L_pad7:
    s_cbranch_execz L_warmed
    v_pk_fma_f32 v[102:103], v[102:103], v[246:247], v[18:19] neg_lo:[0,0,1] neg_hi:[0,0,1]
    v_pk_fma_f32 v[108:109], v[108:109], v[244:245], v[16:17] neg_lo:[0,0,1] neg_hi:[0,0,1]
    v_pk_fma_f32 v[112:113], v[112:113], v[244:245], v[16:17] neg_lo:[0,0,1] neg_hi:[0,0,1]
    v_pk_fma_f32 v[84:85], v[84:85], v[244:245], v[16:17] neg_lo:[0,0,1] neg_hi:[0,0,1]
    v_cvt_pk_bf16_f32 v198, v100, v104
    v_pk_fma_f32 v[88:89], v[88:89], v[244:245], v[16:17] neg_lo:[0,0,1] neg_hi:[0,0,1]
    v_pk_fma_f32 v[96:97], v[96:97], v[244:245], v[16:17] neg_lo:[0,0,1] neg_hi:[0,0,1]
    v_pk_fma_f32 v[106:107], v[106:107], v[246:247], v[18:19] neg_lo:[0,0,1] neg_hi:[0,0,1]
    v_pk_fma_f32 v[98:99], v[98:99], v[246:247], v[18:19] neg_lo:[0,0,1] neg_hi:[0,0,1]
    v_cvt_pk_bf16_f32 v200, v85, v89
    v_pk_fma_f32 v[114:115], v[114:115], v[246:247], v[18:19] neg_lo:[0,0,1] neg_hi:[0,0,1]
    v_pk_fma_f32 v[86:87], v[86:87], v[246:247], v[18:19] neg_lo:[0,0,1] neg_hi:[0,0,1]
    v_cvt_pk_bf16_f32 v197, v92, v96
    v_mfma_f32_16x16x32_bf16 v[228:231], a[112:115], a[64:67], v[252:255]
    v_exp_f32 v224, v224
    v_mfma_f32_16x16x32_bf16 v[228:231], a[116:119], a[68:71], v[228:231]
    v_cvt_pk_bf16_f32 v196, v84, v88
    v_cvt_pk_bf16_f32 v201, v93, v97
    v_mfma_f32_16x16x32_bf16 v[228:231], a[120:123], a[72:75], v[228:231]
    ds_write_b64 v6, v[196:197] offset:8704
    v_cvt_pk_bf16_f32 v199, v108, v112
    v_mfma_f32_16x16x32_bf16 v[144:147], v[204:207], a[204:207], v[144:147]
    v_cvt_pk_bf16_f32 v196, v86, v90
    v_cvt_pk_bf16_f32 v203, v109, v113
    v_mfma_f32_16x16x32_bf16 v[144:147], v[208:211], a[200:203], v[144:147]
    ds_write_b64 v6, v[198:199] offset:8832
    v_cvt_pk_bf16_f32 v197, v94, v98
    v_mfma_f32_16x16x32_bf16 v[136:139], v[208:211], a[184:187], v[136:139]
    ds_write_b64 v6, v[200:201] offset:9792
    v_mfma_f32_16x16x32_bf16 v[228:231], a[124:127], a[76:79], v[228:231]
    v_cvt_pk_bf16_f32 v211, v226, v227
    v_cvt_pk_bf16_f32 v208, v220, v221
    v_mfma_f32_16x16x32_bf16 v[232:235], a[136:139], a[72:75], v[232:235]
    v_exp_f32 v222, v222
    v_mfma_f32_16x16x32_bf16 v[232:235], a[132:135], a[68:71], v[232:235]
    s_add_u32 s32, s32, 4096
    v_cvt_pk_bf16_f32 v209, v222, v223
    v_cvt_pk_bf16_f32 v202, v101, v105
    v_mfma_f32_16x16x32_bf16 v[232:235], a[128:131], a[64:67], v[232:235]
    v_cvt_pk_bf16_f32 v210, v224, v225
    v_cvt_pk_bf16_f32 v200, v87, v91
    v_cvt_pk_bf16_f32 v198, v102, v106
    v_mfma_f32_16x16x32_bf16 v[116:119], v[204:207], a[144:147], v[116:119]
    ds_read_b64_tr_b16 a[32:33], v7 offset:8704
    ds_read_b64_tr_b16 a[34:35], v7 offset:8736
    v_smfmac_f32_16x16x64_bf16 a[220:223], a[228:231], v[204:211], v10
    ds_write_b64 v6, v[202:203] offset:9920
    v_mfma_f32_16x16x32_bf16 v[124:127], v[204:207], a[160:163], v[124:127]
    v_cvt_pk_bf16_f32 v202, v103, v107
    v_cvt_pk_bf16_f32 v203, v111, v115
    v_mfma_f32_16x16x32_bf16 v[124:127], v[208:211], a[164:167], v[124:127]
    ds_write_b64 v6, v[196:197] offset:10880
    v_exp_f32 v230, v230
    v_mfma_f32_16x16x32_bf16 v[172:175], v[216:219], a[192:195], v[172:175]
    ds_read_b64_tr_b16 a[36:37], v7 offset:9792
    ds_read_b64_tr_b16 a[38:39], v7 offset:9824
    v_mfma_f32_16x16x32_bf16 v[132:135], v[204:207], a[180:183], v[132:135]
    s_waitcnt lgkmcnt(4)
    buffer_store_dwordx4 a[32:35], v3, s[16:19], s32 offen offset:0 sc1 nt
    v_exp_f32 v231, v231
    v_accvgpr_read_b32 v5, a221
    v_cvt_pk_bf16_f32 v199, v110, v114
    v_accvgpr_read_b32 v0, a220
    v_mfma_f32_16x16x32_bf16 v[136:139], v[208:211], a[240:243], v[136:139]
    ds_write_b64 v6, v[198:199] offset:11008
    v_add_f32 v0, v0, v5
    v_mfma_f32_16x16x32_bf16 v[168:171], v[212:215], a[188:191], v[168:171]
    ds_read_b64_tr_b16 a[42:43], v7 offset:10912
    v_cvt_pk_bf16_f32 v201, v95, v99
    v_cmp_ngt_f32 s[46:47], s39, v0
    v_rcp_f32 v5, v0
    v_mfma_f32_16x16x32_bf16 v[128:131], v[208:211], a[172:175], v[128:131]
    ds_write_b32 v8, v5
    v_mfma_f32_16x16x32_bf16 v[128:131], v[204:207], a[168:171], v[128:131]
    ds_read_b64_tr_b16 a[40:41], v7 offset:10880
    ds_read_b128 v[248:251], v9
    v_mfma_f32_16x16x32_bf16 v[132:135], v[208:211], a[236:239], v[132:135]
    v_exp_f32 v232, v232
    v_mfma_f32_16x16x32_bf16 v[144:147], v[208:211], a[248:251], v[144:147]
    s_waitcnt lgkmcnt(5)
    buffer_store_dwordx4 a[36:39], v3, s[16:19], s32 offen offset:1024 sc1 nt
    ds_write_b64 v6, v[200:201] offset:11968
    v_exp_f32 v235, v235
    v_mfma_f32_16x16x32_bf16 v[164:167], v[216:219], a[176:179], v[164:167]
    ds_write_b64 v6, v[202:203] offset:12096
    v_mfma_f32_16x16x32_bf16 v[120:123], v[208:211], a[156:159], v[120:123]
    v_exp_f32 v228, v228
    v_mfma_f32_16x16x32_bf16 v[120:123], v[204:207], a[152:155], v[120:123]
    v_exp_f32 v229, v229
    v_mfma_f32_16x16x32_bf16 v[140:143], v[204:207], a[196:199], v[140:143]
    s_or_b64 s[44:45], s[44:45], s[46:47]
    v_exp_f32 v234, v234
    v_mfma_f32_16x16x32_bf16 v[116:119], v[208:211], a[148:151], v[116:119]
    s_waitcnt lgkmcnt(2)
    v_mul_f32 v18, v12, v250
    v_mul_f32 v17, v12, v249
    v_mfma_f32_16x16x32_bf16 v[140:143], v[208:211], a[244:247], v[140:143]
    buffer_store_dwordx4 a[40:43], v3, s[16:19], s32 offen offset:2048 sc1 nt
    ds_read_b64_tr_b16 a[44:45], v7 offset:11968
    ds_read_b64_tr_b16 a[46:47], v7 offset:12000
    v_mul_f32 v19, v12, v251
    v_mul_f32 v16, v12, v248
    v_pk_fma_f32 v[132:133], v[132:133], v[248:249], v[16:17] neg_lo:[0,0,1] neg_hi:[0,0,1]
    v_pk_fma_f32 v[136:137], v[136:137], v[248:249], v[16:17] neg_lo:[0,0,1] neg_hi:[0,0,1]
    v_pk_fma_f32 v[144:145], v[144:145], v[248:249], v[16:17] neg_lo:[0,0,1] neg_hi:[0,0,1]
    v_pk_fma_f32 v[120:121], v[120:121], v[248:249], v[16:17] neg_lo:[0,0,1] neg_hi:[0,0,1]
    v_pk_fma_f32 v[116:117], v[116:117], v[248:249], v[16:17] neg_lo:[0,0,1] neg_hi:[0,0,1]
    v_cvt_pk_bf16_f32 v204, v116, v120
    v_cvt_pk_bf16_f32 v208, v117, v121
    v_pk_fma_f32 v[140:141], v[140:141], v[248:249], v[16:17] neg_lo:[0,0,1] neg_hi:[0,0,1]
    v_pk_fma_f32 v[146:147], v[146:147], v[250:251], v[18:19] neg_lo:[0,0,1] neg_hi:[0,0,1]
    v_pk_fma_f32 v[128:129], v[128:129], v[248:249], v[16:17] neg_lo:[0,0,1] neg_hi:[0,0,1]
    v_pk_fma_f32 v[124:125], v[124:125], v[248:249], v[16:17] neg_lo:[0,0,1] neg_hi:[0,0,1]
    v_cvt_pk_bf16_f32 v205, v124, v128
    v_mfma_f32_16x16x32_bf16 v[176:179], v[212:215], a[204:207], v[176:179]
    ds_write_b64 v6, v[204:205] offset:13056
    v_cvt_pk_bf16_f32 v207, v140, v144
    v_cvt_pk_bf16_f32 v206, v132, v136
    v_pk_fma_f32 v[142:143], v[142:143], v[250:251], v[18:19] neg_lo:[0,0,1] neg_hi:[0,0,1]
    v_pk_fma_f32 v[126:127], v[126:127], v[250:251], v[18:19] neg_lo:[0,0,1] neg_hi:[0,0,1]
    v_mfma_f32_16x16x32_bf16 v[148:151], v[212:215], a[144:147], v[148:151]
    s_waitcnt lgkmcnt(1)
    buffer_store_dwordx4 a[44:47], v3, s[16:19], s32 offen offset:3072 sc1 nt
    ds_write_b64 v6, v[206:207] offset:13184
    v_exp_f32 v233, v233
    v_mfma_f32_16x16x32_bf16 v[168:171], v[216:219], a[184:187], v[168:171]
    ds_read_b64_tr_b16 a[50:51], v7 offset:13088
    ds_read_b64_tr_b16 a[48:49], v7 offset:13056
    v_mfma_f32_16x16x32_bf16 v[176:179], v[216:219], a[200:203], v[176:179]
    s_add_u32 s32, s32, 4096
    v_cvt_pk_bf16_f32 v209, v125, v129
    v_cvt_pk_bf16_f32 v219, v234, v235
    v_cvt_pk_bf16_f32 v218, v232, v233
    v_cvt_pk_bf16_f32 v217, v230, v231
    v_cvt_pk_bf16_f32 v216, v228, v229
    v_mfma_f32_16x16x32_bf16 v[172:175], v[212:215], a[196:199], v[172:175]
    ds_write_b64 v6, v[208:209] offset:14144
    v_smfmac_f32_16x16x64_bf16 a[224:227], a[228:231], v[212:219], v10
    v_cvt_pk_bf16_f32 v211, v141, v145
    v_cvt_pk_bf16_f32 v210, v133, v137
    v_mfma_f32_16x16x32_bf16 v[148:151], v[216:219], a[148:151], v[148:151]
    ds_write_b64 v6, v[210:211] offset:14272
    v_mfma_f32_16x16x32_bf16 v[160:163], v[216:219], a[172:175], v[160:163]
    s_waitcnt lgkmcnt(2)
    buffer_store_dwordx4 a[48:51], v3, s[16:19], s32 offen offset:0 sc1 nt
    ds_read_b64_tr_b16 a[54:55], v7 offset:14176
    ds_read_b64_tr_b16 a[52:53], v7 offset:14144
    v_cvt_pk_bf16_f32 v207, v142, v146
    v_pk_fma_f32 v[122:123], v[122:123], v[250:251], v[18:19] neg_lo:[0,0,1] neg_hi:[0,0,1]
    v_pk_fma_f32 v[118:119], v[118:119], v[250:251], v[18:19] neg_lo:[0,0,1] neg_hi:[0,0,1]
    v_cvt_pk_bf16_f32 v204, v118, v122
    v_pk_fma_f32 v[134:135], v[134:135], v[250:251], v[18:19] neg_lo:[0,0,1] neg_hi:[0,0,1]
    v_pk_fma_f32 v[138:139], v[138:139], v[250:251], v[18:19] neg_lo:[0,0,1] neg_hi:[0,0,1]
    v_cvt_pk_bf16_f32 v208, v119, v123
    v_pk_fma_f32 v[130:131], v[130:131], v[250:251], v[18:19] neg_lo:[0,0,1] neg_hi:[0,0,1]
    v_cvt_pk_bf16_f32 v205, v126, v130
    v_mfma_f32_16x16x32_bf16 v[176:179], v[216:219], a[248:251], v[176:179]
    ds_write_b64 v6, v[204:205] offset:15232
    v_cvt_pk_bf16_f32 v206, v134, v138
    v_mfma_f32_16x16x32_bf16 v[164:167], v[212:215], a[180:183], v[164:167]
    ds_write_b64 v6, v[206:207] offset:15360
    v_mfma_f32_16x16x32_bf16 v[156:159], v[212:215], a[160:163], v[156:159]
    s_waitcnt lgkmcnt(2)
    buffer_store_dwordx4 a[52:55], v3, s[16:19], s32 offen offset:1024 sc1 nt
    v_accvgpr_read_b32 v5, a225
    v_accvgpr_read_b32 v0, a224
    v_add_f32 v0, v0, v5
    v_rcp_f32 v5, v0
    v_mfma_f32_16x16x32_bf16 v[160:163], v[212:215], a[168:171], v[160:163]
    ds_read_b64_tr_b16 a[56:57], v7 offset:15232
    ds_read_b64_tr_b16 a[58:59], v7 offset:15264
    v_mfma_f32_16x16x32_bf16 v[152:155], v[216:219], a[156:159], v[152:155]
    ds_write_b32 v8, v5
    v_mfma_f32_16x16x32_bf16 v[156:159], v[216:219], a[164:167], v[156:159]
    ds_read_b128 v[252:255], v9
    v_cvt_pk_bf16_f32 v209, v127, v131
    v_mfma_f32_16x16x32_bf16 v[164:167], v[216:219], a[236:239], v[164:167]
    ds_write_b64 v6, v[208:209] offset:16320
    v_mfma_f32_16x16x32_bf16 v[152:155], v[212:215], a[152:155], v[152:155]
    v_cvt_pk_bf16_f32 v210, v135, v139
    v_cvt_pk_bf16_f32 v211, v143, v147
    v_mfma_f32_16x16x32_bf16 v[172:175], v[216:219], a[244:247], v[172:175]
    ds_write_b64 v6, v[210:211] offset:16448
    v_mfma_f32_16x16x32_bf16 v[168:171], v[216:219], a[240:243], v[168:171]
    s_waitcnt lgkmcnt(4)
    buffer_store_dwordx4 a[56:59], v3, s[16:19], s32 offen offset:2048 sc1 nt
    ds_read_b64_tr_b16 a[62:63], v7 offset:16352
    ds_read_b64_tr_b16 a[60:61], v7 offset:16320
    s_waitcnt lgkmcnt(4)
    v_mul_f32 v16, v12, v252
    v_mul_f32 v17, v12, v253
    v_pk_fma_f32 v[160:161], v[160:161], v[252:253], v[16:17] neg_lo:[0,0,1] neg_hi:[0,0,1]
    v_pk_fma_f32 v[176:177], v[176:177], v[252:253], v[16:17] neg_lo:[0,0,1] neg_hi:[0,0,1]
    v_pk_fma_f32 v[148:149], v[148:149], v[252:253], v[16:17] neg_lo:[0,0,1] neg_hi:[0,0,1]
    v_pk_fma_f32 v[156:157], v[156:157], v[252:253], v[16:17] neg_lo:[0,0,1] neg_hi:[0,0,1]
    v_pk_fma_f32 v[172:173], v[172:173], v[252:253], v[16:17] neg_lo:[0,0,1] neg_hi:[0,0,1]
    v_pk_fma_f32 v[152:153], v[152:153], v[252:253], v[16:17] neg_lo:[0,0,1] neg_hi:[0,0,1]
    v_cvt_pk_bf16_f32 v212, v148, v152
    v_cvt_pk_bf16_f32 v213, v156, v160
    ds_write_b64 v6, v[212:213] offset:17408
    v_cvt_pk_bf16_f32 v215, v172, v176
    v_pk_fma_f32 v[164:165], v[164:165], v[252:253], v[16:17] neg_lo:[0,0,1] neg_hi:[0,0,1]
    v_pk_fma_f32 v[168:169], v[168:169], v[252:253], v[16:17] neg_lo:[0,0,1] neg_hi:[0,0,1]
    v_cvt_pk_bf16_f32 v218, v165, v169
    v_cvt_pk_bf16_f32 v214, v164, v168
    s_waitcnt lgkmcnt(1)
    buffer_store_dwordx4 a[60:63], v3, s[16:19], s32 offen offset:3072 sc1 nt
    ds_write_b64 v6, v[214:215] offset:17536
    v_cvt_pk_bf16_f32 v216, v149, v153
    v_mul_f32 v18, v12, v254
    v_cvt_pk_bf16_f32 v217, v157, v161
    ds_read_b64_tr_b16 a[66:67], v7 offset:17440
    ds_read_b64_tr_b16 a[64:65], v7 offset:17408
    ds_write_b64 v6, v[216:217] offset:18496
    v_mul_f32 v19, v12, v255
    v_pk_fma_f32 v[154:155], v[154:155], v[254:255], v[18:19] neg_lo:[0,0,1] neg_hi:[0,0,1]
    v_pk_fma_f32 v[178:179], v[178:179], v[254:255], v[18:19] neg_lo:[0,0,1] neg_hi:[0,0,1]
    v_pk_fma_f32 v[150:151], v[150:151], v[254:255], v[18:19] neg_lo:[0,0,1] neg_hi:[0,0,1]
    v_cvt_pk_bf16_f32 v212, v150, v154
    v_cmp_ngt_f32 s[46:47], s39, v0
    v_pk_fma_f32 v[162:163], v[162:163], v[254:255], v[18:19] neg_lo:[0,0,1] neg_hi:[0,0,1]
    v_cvt_pk_bf16_f32 v219, v173, v177
    s_or_b64 s[44:45], s[44:45], s[46:47]
    s_add_u32 s32, s32, 4096
    ds_write_b64 v6, v[218:219] offset:18624
    v_pk_fma_f32 v[158:159], v[158:159], v[254:255], v[18:19] neg_lo:[0,0,1] neg_hi:[0,0,1]
    v_cvt_pk_bf16_f32 v213, v158, v162
    s_waitcnt lgkmcnt(2)
    buffer_store_dwordx4 a[64:67], v3, s[16:19], s32 offen offset:0 sc1 nt
    ds_read_b64_tr_b16 a[68:69], v7 offset:18496
    ds_read_b64_tr_b16 a[70:71], v7 offset:18528
    ds_write_b64 v6, v[212:213] offset:19584
    v_pk_fma_f32 v[170:171], v[170:171], v[254:255], v[18:19] neg_lo:[0,0,1] neg_hi:[0,0,1]
    v_pk_fma_f32 v[174:175], v[174:175], v[254:255], v[18:19] neg_lo:[0,0,1] neg_hi:[0,0,1]
    v_cvt_pk_bf16_f32 v215, v174, v178
    v_pk_fma_f32 v[166:167], v[166:167], v[254:255], v[18:19] neg_lo:[0,0,1] neg_hi:[0,0,1]
    v_cvt_pk_bf16_f32 v214, v166, v170
    ds_write_b64 v6, v[214:215] offset:19712
    v_cvt_pk_bf16_f32 v216, v151, v155
    v_cvt_pk_bf16_f32 v217, v159, v163
    ds_read_b64_tr_b16 a[72:73], v7 offset:19584
    ds_write_b64 v6, v[216:217] offset:20672
    s_waitcnt lgkmcnt(4)
    buffer_store_dwordx4 a[68:71], v3, s[16:19], s32 offen offset:1024 sc1 nt
    v_cvt_pk_bf16_f32 v218, v167, v171
    ds_read_b64_tr_b16 a[74:75], v7 offset:19616
    v_cvt_pk_bf16_f32 v219, v175, v179
    ds_write_b64 v6, v[218:219] offset:20800
    ds_read_b64_tr_b16 a[78:79], v7 offset:20704
    ds_read_b64_tr_b16 a[76:77], v7 offset:20672
    s_waitcnt lgkmcnt(3)
    buffer_store_dwordx4 a[72:75], v3, s[16:19], s32 offen offset:2048 sc1 nt
    s_waitcnt lgkmcnt(0)
    buffer_store_dwordx4 a[76:79], v3, s[16:19], s32 offen offset:3072 sc1 nt
    s_add_u32 s32, s32, 4096
    s_cmp_lg_u64 s[44:45], 0
    s_cselect_b32 s34, 2, 0
    s_or_b32 s28, s28, s34
L_done:
    s_cmp_lg_u32 s28, 0
    s_cbranch_scc1 L_slow
L_exit:
    s_endpgm
.p2align 6
L_start_b:
    s_add_u32 m0, s24, 0
    s_nop 0
    buffer_load_dwordx4 v3, s[4:7], 0 offen nt lds
    s_add_u32 m0, s24, 32
    s_nop 0
    buffer_load_dwordx4 v3, s[4:7], 0 offen offset:1024 nt lds
    s_add_u32 s4, s4, 8192
    s_addc_u32 s5, s5, 0
    s_sub_u32 s20, s20, 8192
    s_max_i32 s6, s20, 0
    s_add_u32 m0, s36, 0
    s_nop 0
    buffer_load_dwordx4 v3, s[12:15], s22 offen offset:0 nt lds
    s_add_u32 m0, s36, 64
    s_nop 0
    buffer_load_dwordx4 v3, s[12:15], s22 offen offset:1024 nt lds
    s_add_u32 m0, s36, 128
    s_nop 0
    buffer_load_dwordx4 v3, s[12:15], s22 offen offset:2048 nt lds
    s_add_u32 m0, s36, 192
    s_nop 0
    buffer_load_dwordx4 v3, s[12:15], s22 offen offset:3072 nt lds
    s_add_u32 s22, s22, 4096
    s_mov_b64 exec, 0
    s_cmp_eq_u32 s33, 1
    s_cbranch_scc1 L_pad2
    s_cmp_eq_u32 s33, 2
    s_cbranch_scc1 L_pad3
    s_cmp_eq_u32 s33, 3
    s_cbranch_scc1 L_pad4
    s_branch L_pad8
L_warmed_b:
    s_waitcnt vmcnt(0)
    ds_read_b128 a[0:3], v5 offset:0
    s_add_u32 m0, s24, 8448
    ds_read_b128 a[4:7], v5 offset:64
    s_barrier
    ds_read_b128 a[8:11], v5 offset:128
    ds_read_b128 v[160:163], v1 offset:192
    buffer_load_dwordx4 v3, s[4:7], 0 offen nt lds
    s_add_u32 m0, s24, 8480
    ds_read_b128 v[176:179], v1 offset:704
    buffer_load_dwordx4 v3, s[4:7], 0 offen offset:1024 nt lds
    s_waitcnt lgkmcnt(4)
    v_mfma_f32_4x4x4_16b_bf16 v[184:187], a[232:233], a[2:3], 0
    ds_read_b128 a[12:15], v5 offset:192
    s_nop 0
    v_mfma_f32_4x4x4_16b_bf16 v[184:187], a[234:235], a[2:3], v[184:187]
    s_waitcnt lgkmcnt(4)
    v_mfma_f32_4x4x4_16b_bf16 v[236:239], a[232:233], a[4:5], 0
    s_nop 1
    v_mfma_f32_4x4x4_16b_bf16 v[236:239], a[234:235], a[4:5], v[236:239]
    v_cvt_pk_bf16_f32 v184, v184, v185
    v_cvt_pk_bf16_f32 v185, v186, v187
    v_accvgpr_write_b32 a3, v185
    v_mfma_f32_4x4x4_16b_bf16 v[180:183], a[232:233], a[0:1], 0
    s_nop 1
    v_mfma_f32_4x4x4_16b_bf16 v[180:183], a[234:235], a[0:1], v[180:183]
    v_cvt_pk_bf16_f32 v236, v236, v237
    s_add_u32 s4, s4, 8192
    s_addc_u32 s5, s5, 0
    s_sub_u32 s20, s20, 8192
    v_accvgpr_write_b32 a4, v236
    s_max_i32 s6, s20, 0
    v_cvt_pk_bf16_f32 v237, v238, v239
    v_accvgpr_write_b32 a5, v237
    v_cvt_pk_bf16_f32 v180, v180, v181
    s_waitcnt lgkmcnt(3)
    v_mfma_f32_4x4x4_16b_bf16 v[236:239], a[232:233], a[10:11], 0
    s_add_u32 m0, s25, 0
    s_nop 0
    buffer_load_dwordx4 v4, s[8:11], 0 offen nt lds
    s_add_u32 m0, s25, 16
    v_mfma_f32_4x4x4_16b_bf16 v[236:239], a[234:235], a[10:11], v[236:239]
    s_lshr_b32 s34, s33, 1
    v_accvgpr_write_b32 a2, v184
    s_lshl_b32 s34, s34, 13
    v_mfma_f32_4x4x4_16b_bf16 v[184:187], a[232:233], a[8:9], 0
    s_sub_u32 s34, s34, 128
    s_ashr_i32 s35, s34, 31
    ds_read_b128 v[156:159], v1 offset:128
    buffer_load_dwordx4 v4, s[8:11], 0 offen offset:1024 nt lds
    ds_read_b128 v[168:171], v1 offset:576
    s_add_u32 s8, s8, s34
    v_accvgpr_write_b32 a0, v180
    v_cvt_pk_bf16_f32 v181, v182, v183
    v_mfma_f32_4x4x4_16b_bf16 v[184:187], a[234:235], a[8:9], v[184:187]
    v_accvgpr_write_b32 a1, v181
    v_mfma_f32_4x4x4_16b_bf16 v[180:183], a[232:233], a[6:7], 0
    s_nop 1
    v_mfma_f32_4x4x4_16b_bf16 v[180:183], a[234:235], a[6:7], v[180:183]
    ds_read_b128 v[152:155], v1 offset:64
    v_cvt_pk_bf16_f32 v236, v236, v237
    v_cvt_pk_bf16_f32 v237, v238, v239
    v_cvt_pk_bf16_f32 v184, v184, v185
    v_accvgpr_write_b32 a8, v184
    v_cvt_pk_bf16_f32 v180, v180, v181
    v_accvgpr_write_b32 a6, v180
    s_addc_u32 s9, s9, s35
    v_cvt_pk_bf16_f32 v185, v186, v187
    s_sub_u32 s21, s21, s34
    s_add_u32 m0, s24, 16896
    v_accvgpr_write_b32 a9, v185
    buffer_load_dwordx4 v3, s[4:7], 0 offen nt lds
    v_accvgpr_write_b32 a11, v237
    s_waitcnt lgkmcnt(3)
    v_mfma_f32_4x4x4_16b_bf16 v[184:187], a[232:233], a[14:15], 0
    ds_read_b128 v[172:175], v1 offset:640
    v_cvt_pk_bf16_f32 v181, v182, v183
    s_add_u32 m0, s24, 16928
    v_mfma_f32_4x4x4_16b_bf16 v[184:187], a[234:235], a[14:15], v[184:187]
    buffer_load_dwordx4 v3, s[4:7], 0 offen offset:1024 nt lds
    v_accvgpr_write_b32 a7, v181
    s_add_u32 s4, s4, 8192
    s_addc_u32 s5, s5, 0
    v_mfma_f32_4x4x4_16b_bf16 v[180:183], a[232:233], a[12:13], 0
    ds_read_b128 v[164:167], v1 offset:512
    s_nop 0
    v_mfma_f32_4x4x4_16b_bf16 v[180:183], a[234:235], a[12:13], v[180:183]
    s_mov_b32 s10, s21
    s_sub_u32 s20, s20, 8192
    s_max_i32 s6, s20, 0
    s_add_u32 m0, s25, 8320
    v_cvt_pk_bf16_f32 v184, v184, v185
    buffer_load_dwordx4 v4, s[8:11], 0 offen nt lds
    s_add_u32 m0, s25, 8336
    v_cvt_pk_bf16_f32 v180, v180, v181
    v_accvgpr_write_b32 a12, v180
    buffer_load_dwordx4 v4, s[8:11], 0 offen offset:1024 nt lds
    s_add_u32 s8, s8, 8320
    ds_read_b128 v[148:151], v1 offset:0
    s_addc_u32 s9, s9, 0
    s_sub_u32 s21, s21, 8320
    s_max_i32 s10, s21, 0
    s_add_u32 m0, s36, 4352
    v_cvt_pk_bf16_f32 v185, v186, v187
    v_accvgpr_write_b32 a10, v236
    v_accvgpr_write_b32 a15, v185
    v_cvt_pk_bf16_f32 v181, v182, v183
    v_accvgpr_write_b32 a14, v184
    v_accvgpr_write_b32 a13, v181
    buffer_load_dwordx4 v3, s[12:15], s22 offen offset:0 nt lds
    s_waitcnt vmcnt(5)
    s_barrier
    ds_read_b64_tr_b16 a[196:197], v2 offset:4192
    v_mfma_f32_16x16x32_bf16 v[16:19], v[176:179], a[12:15], 0
    ds_read_b128 a[128:131], v1 offset:8960
    s_waitcnt lgkmcnt(4)
    v_mfma_f32_16x16x32_bf16 v[16:19], v[172:175], a[8:11], v[16:19]
    ds_read_b128 a[116:119], v1 offset:8512
    v_mfma_f32_16x16x32_bf16 v[16:19], v[168:171], a[4:7], v[16:19]
    ds_read_b128 a[112:115], v1 offset:8448
    s_waitcnt lgkmcnt(4)
    v_mfma_f32_16x16x32_bf16 v[12:15], v[148:151], a[0:3], 0
    ds_read_b64_tr_b16 a[182:183], v2 offset:4672
    ds_read_b64_tr_b16 a[190:191], v2 offset:4688
    v_mfma_f32_16x16x32_bf16 v[12:15], v[152:155], a[4:7], v[12:15]
    ds_read_b128 a[120:123], v1 offset:8576
    v_mfma_f32_16x16x32_bf16 v[12:15], v[156:159], a[8:11], v[12:15]
    ds_read_b64_tr_b16 a[204:205], v2 offset:4208
    ds_read_b64_tr_b16 v[214:215], v2 offset:4176
    v_mfma_f32_16x16x32_bf16 v[12:15], v[160:163], a[12:15], v[12:15]
    ds_read_b64_tr_b16 a[206:207], v2 offset:4720
    ds_read_b64_tr_b16 v[216:217], v2 offset:4192
    v_mfma_f32_16x16x32_bf16 v[16:19], v[164:167], a[0:3], v[16:19]
    s_add_u32 m0, s36, 4416
    ds_read_b64_tr_b16 v[218:219], v2 offset:4208
    ds_read_b128 a[124:127], v1 offset:8640
    buffer_load_dwordx4 v3, s[12:15], s22 offen offset:1024 nt lds
    s_add_u32 m0, s36, 4480
    ds_read_b128 a[136:139], v1 offset:9088
    buffer_load_dwordx4 v3, s[12:15], s22 offen offset:2048 nt lds
    v_max3_f32 v11, v12, v13, v14
    v_max3_f32 v11, v11, v18, v19
    v_max3_f32 v0, v15, v16, v17
    v_max_f32 v11, v11, v0
    v_mov_b32 v0, v11
    s_add_u32 m0, s36, 4544
    ds_read_b128 a[132:135], v1 offset:9024
    buffer_load_dwordx4 v3, s[12:15], s22 offen offset:3072 nt lds
    ds_read_b128 a[140:143], v1 offset:9152
    v_permlane32_swap_b32 v11, v0
    v_max_f32 v11, v11, v0
    v_mov_b32 v0, v11
    s_add_u32 s22, s22, 4096
    s_add_u32 m0, s36, 8704
    v_permlane16_swap_b32 v11, v0
    v_max_f32 v11, v11, v0
    v_sub_f32 v237, s3, v11
    v_sub_f32 v236, s3, v11
    v_pk_add_f32 v[14:15], v[14:15], v[236:237]
    v_exp_f32 v14, v14
    v_pk_add_f32 v[16:17], v[16:17], v[236:237]
    v_exp_f32 v17, v17
    v_pk_add_f32 v[12:13], v[12:13], v[236:237]
    v_exp_f32 v12, v12
    v_sub_f32 v239, s3, v11
    v_sub_f32 v238, s3, v11
    v_pk_add_f32 v[18:19], v[18:19], v[236:237]
    v_exp_f32 v18, v18
    v_exp_f32 v15, v15
    s_waitcnt lgkmcnt(0)
    v_mfma_f32_16x16x32_bf16 v[232:235], a[140:143], a[12:15], v[236:239]
    v_exp_f32 v13, v13
    v_mfma_f32_16x16x32_bf16 v[232:235], a[136:139], a[8:11], v[232:235]
    v_exp_f32 v16, v16
    v_mfma_f32_16x16x32_bf16 v[232:235], a[132:135], a[4:7], v[232:235]
    ds_read_b64_tr_b16 a[198:199], v2 offset:4704
    ds_read_b64_tr_b16 v[212:213], v2 offset:4160
    v_mfma_f32_16x16x32_bf16 v[232:235], a[128:131], a[0:3], v[232:235]
    buffer_load_dwordx4 v3, s[12:15], s22 offen offset:0 nt lds
    v_cvt_pk_bf16_f32 v181, v14, v15
    v_cvt_pk_bf16_f32 v180, v12, v13
    v_mfma_f32_16x16x32_bf16 v[228:231], a[112:115], a[0:3], v[236:239]
    v_exp_f32 v19, v19
    v_mfma_f32_16x16x32_bf16 v[228:231], a[116:119], a[4:7], v[228:231]
    ds_read_b64_tr_b16 a[180:181], v2 offset:4160
    v_cvt_pk_bf16_f32 v182, v16, v17
    v_mfma_f32_16x16x32_bf16 v[228:231], a[120:123], a[8:11], v[228:231]
    ds_read_b64_tr_b16 a[188:189], v2 offset:4176
    v_cvt_pk_bf16_f32 v183, v18, v19
    v_mfma_f32_16x16x32_bf16 v[228:231], a[124:127], a[12:15], v[228:231]
    s_waitcnt vmcnt(5)
    s_barrier
    ds_read_b64_tr_b16 v[208:209], v2 offset:8352
    s_add_u32 m0, s36, 8768
    ds_read_b64_tr_b16 v[204:205], v2 offset:8320
    ds_read_b64_tr_b16 v[210:211], v2 offset:8368
    buffer_load_dwordx4 v3, s[12:15], s22 offen offset:1024 nt lds
    ds_read_b64_tr_b16 v[206:207], v2 offset:8336
    ds_read_b128 a[104:107], v1 offset:17536
    v_max_f32 v214, abs(v214), abs(v215)
    s_waitcnt lgkmcnt(7)
    v_max_f32 v212, abs(v212), abs(v213)
    s_add_u32 m0, s36, 8832
    ds_read_b64_tr_b16 a[144:145], v2 offset:8320
    buffer_load_dwordx4 v3, s[12:15], s22 offen offset:2048 nt lds
    ds_read_b128 a[108:111], v1 offset:17600
    s_add_u32 m0, s36, 8896
    ds_read_b64_tr_b16 a[152:153], v2 offset:8336
    buffer_load_dwordx4 v3, s[12:15], s22 offen offset:3072 nt lds
    ds_read_b128 a[88:91], v1 offset:17024
    v_max_f32 v216, abs(v216), abs(v217)
    v_max_f32 v218, abs(v218), abs(v219)
    ds_read_b64_tr_b16 a[162:163], v2 offset:8864
    ds_read_b128 a[84:87], v1 offset:16960
    s_waitcnt lgkmcnt(7)
    v_max_f32 v206, abs(v206), abs(v207)
    v_max_f32 v204, abs(v204), abs(v205)
    v_max_f32 v210, abs(v210), abs(v211)
    v_max_f32 v208, abs(v208), abs(v209)
    v_min3_f32 v204, v204, v206, v208
    v_min3_f32 v204, v204, v216, v218
    v_min3_f32 v210, v210, v212, v214
    ds_read_b64_tr_b16 a[156:157], v2 offset:12496
    ds_read_b128 a[92:95], v1 offset:17088
    v_min_f32 v204, v204, v210
    v_and_b32 v204, s58, v204
    v_mov_b32 v205, v204
    s_add_u32 s22, s22, 4096
    s_add_u32 m0, s36, 13056
    ds_read_b64_tr_b16 a[166:167], v2 offset:13024
    ds_read_b64_tr_b16 a[168:169], v2 offset:8368
    ds_read_b128 a[80:83], v1 offset:16896
    v_permlane32_swap_b32 v204, v205
    v_max_f32 v204, v204, v205
    v_mov_b32 v205, v204
    ds_read_b64_tr_b16 a[158:159], v2 offset:13008
    ds_read_b64_tr_b16 a[164:165], v2 offset:12512
    ds_read_b128 a[100:103], v1 offset:17472
    v_permlane16_swap_b32 v204, v205
    v_max_f32 v204, v204, v205
    v_mul_f32 v6, s59, v204
    v_mul_f32 v7, s59, v204
    v_mul_f32 v9, s59, v204
    v_mul_f32 v8, s59, v204
    ds_read_b64_tr_b16 a[170:171], v2 offset:8880
    ds_read_b64_tr_b16 a[154:155], v2 offset:8848
    v_mfma_f32_16x16x32_bf16 v[40:43], v[180:183], a[188:191], v[6:9]
    ds_read_b64_tr_b16 a[150:151], v2 offset:12992
    ds_read_b64_tr_b16 a[148:149], v2 offset:12480
    v_mfma_f32_16x16x32_bf16 v[48:51], v[180:183], a[204:207], v[6:9]
    ds_read_b64_tr_b16 a[146:147], v2 offset:8832
    ds_read_b64_tr_b16 a[160:161], v2 offset:8352
    ds_read_b64_tr_b16 a[174:175], v2 offset:13040
    v_mfma_f32_16x16x32_bf16 v[44:47], v[180:183], a[196:199], v[6:9]
    buffer_load_dwordx4 v3, s[12:15], s22 offen offset:0 nt lds
    ds_read_b64_tr_b16 a[172:173], v2 offset:12528
    ds_read_b128 a[96:99], v1 offset:17408
    v_mfma_f32_16x16x32_bf16 v[36:39], v[180:183], a[180:183], v[6:9]
    s_waitcnt vmcnt(5)
    ds_read_b128 a[16:19], v5 offset:4352
    s_waitcnt lgkmcnt(13)
    v_mfma_f32_16x16x32_bf16 v[220:223], a[80:83], a[0:3], v[236:239]
    v_exp_f32 v233, v233
    v_mfma_f32_16x16x32_bf16 v[220:223], a[84:87], a[4:7], v[220:223]
    v_exp_f32 v231, v231
    v_mfma_f32_16x16x32_bf16 v[220:223], a[88:91], a[8:11], v[220:223]
    ds_read_b128 a[20:23], v5 offset:4416
    v_exp_f32 v230, v230
    v_mfma_f32_16x16x32_bf16 v[224:227], a[108:111], a[12:15], v[236:239]
    s_add_u32 m0, s36, 13120
    v_exp_f32 v232, v232
    v_mfma_f32_16x16x32_bf16 v[224:227], a[104:107], a[8:11], v[224:227]
    ds_read_b128 a[28:31], v5 offset:4544
    s_waitcnt lgkmcnt(6)
    v_mfma_f32_16x16x32_bf16 v[28:31], v[180:183], a[160:163], v[6:9]
    buffer_load_dwordx4 v3, s[12:15], s22 offen offset:1024 nt lds
    v_cvt_pk_bf16_f32 v186, v232, v233
    s_waitcnt lgkmcnt(2)
    v_mfma_f32_4x4x4_16b_bf16 v[192:195], a[232:233], a[18:19], 0
    ds_read_b128 a[24:27], v5 offset:4480
    v_mfma_f32_4x4x4_16b_bf16 v[188:191], a[232:233], a[16:17], 0
L_pad8:
    s_cbranch_execz L_pad9
    s_add_u32 m0, s36, 13184
    v_mfma_f32_4x4x4_16b_bf16 v[192:195], a[234:235], a[18:19], v[192:195]
    buffer_load_dwordx4 v3, s[12:15], s22 offen offset:2048 nt lds
    v_exp_f32 v228, v228
    v_mfma_f32_4x4x4_16b_bf16 v[188:191], a[234:235], a[16:17], v[188:191]
    s_waitcnt lgkmcnt(2)
    v_mfma_f32_4x4x4_16b_bf16 v[240:243], a[232:233], a[20:21], 0
    v_cvt_pk_bf16_f32 v192, v192, v193
    v_cvt_pk_bf16_f32 v193, v194, v195
    v_mfma_f32_4x4x4_16b_bf16 v[240:243], a[234:235], a[20:21], v[240:243]
    v_exp_f32 v235, v235
    v_cvt_pk_bf16_f32 v188, v188, v189
    v_mfma_f32_16x16x32_bf16 v[220:223], a[92:95], a[12:15], v[220:223]
    s_add_u32 m0, s36, 13248
    v_cvt_pk_bf16_f32 v189, v190, v191
    v_accvgpr_write_b32 a17, v189
    v_accvgpr_write_b32 a16, v188
    v_mfma_f32_4x4x4_16b_bf16 v[188:191], a[232:233], a[22:23], 0
    v_cvt_pk_bf16_f32 v240, v240, v241
    v_accvgpr_write_b32 a20, v240
    v_mfma_f32_4x4x4_16b_bf16 v[188:191], a[234:235], a[22:23], v[188:191]
    v_accvgpr_write_b32 a19, v193
    v_accvgpr_write_b32 a18, v192
    s_waitcnt lgkmcnt(0)
    v_mfma_f32_4x4x4_16b_bf16 v[192:195], a[232:233], a[24:25], 0
    buffer_load_dwordx4 v3, s[12:15], s22 offen offset:3072 nt lds
    v_cvt_pk_bf16_f32 v241, v242, v243
    v_cvt_pk_bf16_f32 v188, v188, v189
    v_accvgpr_write_b32 a21, v241
    v_mfma_f32_4x4x4_16b_bf16 v[192:195], a[234:235], a[24:25], v[192:195]
    v_cvt_pk_bf16_f32 v189, v190, v191
    v_mfma_f32_4x4x4_16b_bf16 v[240:243], a[232:233], a[26:27], 0
    v_accvgpr_write_b32 a23, v189
    v_accvgpr_write_b32 a22, v188
    v_mfma_f32_4x4x4_16b_bf16 v[188:191], a[232:233], a[28:29], 0
    v_cvt_pk_bf16_f32 v192, v192, v193
    v_mfma_f32_4x4x4_16b_bf16 v[240:243], a[234:235], a[26:27], v[240:243]
    v_cvt_pk_bf16_f32 v193, v194, v195
    v_mfma_f32_4x4x4_16b_bf16 v[188:191], a[234:235], a[28:29], v[188:191]
    v_accvgpr_write_b32 a25, v193
    v_accvgpr_write_b32 a24, v192
    v_mfma_f32_4x4x4_16b_bf16 v[192:195], a[232:233], a[30:31], 0
    v_cvt_pk_bf16_f32 v240, v240, v241
    v_accvgpr_write_b32 a26, v240
    v_mfma_f32_4x4x4_16b_bf16 v[192:195], a[234:235], a[30:31], v[192:195]
    v_cvt_pk_bf16_f32 v241, v242, v243
    v_cvt_pk_bf16_f32 v188, v188, v189
    v_accvgpr_write_b32 a27, v241
    v_mfma_f32_16x16x32_bf16 v[224:227], a[100:103], a[4:7], v[224:227]
    v_cvt_pk_bf16_f32 v189, v190, v191
    v_cvt_pk_bf16_f32 v192, v192, v193
    v_mfma_f32_16x16x32_bf16 v[224:227], a[96:99], a[0:3], v[224:227]
    v_cvt_pk_bf16_f32 v185, v230, v231
    v_accvgpr_write_b32 a30, v192
    v_mfma_f32_16x16x32_bf16 v[12:15], v[148:151], a[16:19], 0
    v_accvgpr_write_b32 a28, v188
    v_cvt_pk_bf16_f32 v193, v194, v195
    v_mfma_f32_16x16x32_bf16 v[12:15], v[152:155], a[20:23], v[12:15]
    v_accvgpr_write_b32 a31, v193
    v_accvgpr_write_b32 a29, v189
    v_mfma_f32_16x16x32_bf16 v[12:15], v[156:159], a[24:27], v[12:15]
    v_exp_f32 v229, v229
    v_mfma_f32_16x16x32_bf16 v[12:15], v[160:163], a[28:31], v[12:15]
    v_exp_f32 v226, v226
    v_mfma_f32_16x16x32_bf16 v[16:19], v[176:179], a[28:31], 0
    s_add_u32 s22, s22, 4096
    v_exp_f32 v220, v220
    v_mfma_f32_16x16x32_bf16 v[16:19], v[172:175], a[24:27], v[16:19]
    v_exp_f32 v234, v234
    v_mfma_f32_16x16x32_bf16 v[16:19], v[168:171], a[20:23], v[16:19]
    v_exp_f32 v227, v227
    v_mfma_f32_16x16x32_bf16 v[16:19], v[164:167], a[16:19], v[16:19]
    v_exp_f32 v223, v223
    v_exp_f32 v224, v224
    v_cvt_pk_bf16_f32 v184, v228, v229
    v_cvt_pk_bf16_f32 v187, v234, v235
    v_mfma_f32_16x16x32_bf16 v[20:23], v[180:183], a[144:147], v[6:9]
    v_exp_f32 v225, v225
    v_mfma_f32_16x16x32_bf16 v[28:31], v[184:187], a[164:167], v[28:31]
    s_add_u32 m0, s36, 17408
    v_max3_f32 v0, v15, v16, v17
    v_max3_f32 v11, v12, v13, v14
    v_max3_f32 v11, v11, v18, v19
    v_smfmac_f32_16x16x64_bf16 a[208:211], a[228:231], v[180:187], v10
    v_max_f32 v11, v11, v0
    v_mov_b32 v0, v11
    v_mfma_f32_16x16x32_bf16 v[20:23], v[184:187], a[148:151], v[20:23]
    s_nop 0
    v_permlane32_swap_b32 v11, v0
    v_mfma_f32_16x16x32_bf16 v[32:35], v[184:187], a[172:175], v[6:9]
    v_max_f32 v11, v11, v0
    v_mov_b32 v0, v11
    v_mfma_f32_16x16x32_bf16 v[32:35], v[180:183], a[168:171], v[32:35]
    buffer_load_dwordx4 v3, s[12:15], s22 offen offset:0 nt lds
    v_permlane16_swap_b32 v11, v0
    v_max_f32 v11, v11, v0
    v_sub_f32 v243, s3, v11
    v_sub_f32 v241, s3, v11
    v_sub_f32 v240, s3, v11
    v_pk_add_f32 v[16:17], v[16:17], v[240:241]
    v_sub_f32 v242, s3, v11
    v_exp_f32 v17, v17
    v_pk_add_f32 v[18:19], v[18:19], v[240:241]
    v_pk_add_f32 v[12:13], v[12:13], v[240:241]
    v_pk_add_f32 v[14:15], v[14:15], v[240:241]
    v_mfma_f32_16x16x32_bf16 v[24:27], v[184:187], a[156:159], v[6:9]
    v_exp_f32 v19, v19
    v_mfma_f32_16x16x32_bf16 v[232:235], a[140:143], a[28:31], v[240:243]
    v_exp_f32 v14, v14
    v_mfma_f32_16x16x32_bf16 v[232:235], a[136:139], a[24:27], v[232:235]
    v_exp_f32 v16, v16
    v_mfma_f32_16x16x32_bf16 v[232:235], a[132:135], a[20:23], v[232:235]
    v_exp_f32 v15, v15
    v_mfma_f32_16x16x32_bf16 v[232:235], a[128:131], a[16:19], v[232:235]
    v_exp_f32 v12, v12
    v_mfma_f32_16x16x32_bf16 v[228:231], a[112:115], a[16:19], v[240:243]
    v_exp_f32 v13, v13
    v_mfma_f32_16x16x32_bf16 v[228:231], a[116:119], a[20:23], v[228:231]
    v_exp_f32 v18, v18
    v_mfma_f32_16x16x32_bf16 v[228:231], a[120:123], a[24:27], v[228:231]
    v_cvt_pk_bf16_f32 v191, v18, v19
    v_cvt_pk_bf16_f32 v189, v14, v15
    v_mfma_f32_16x16x32_bf16 v[228:231], a[124:127], a[28:31], v[228:231]
    v_cvt_pk_bf16_f32 v190, v16, v17
    v_cvt_pk_bf16_f32 v188, v12, v13
    v_mfma_f32_16x16x32_bf16 v[24:27], v[180:183], a[152:155], v[24:27]
    v_cvt_pk_bf16_f32 v183, v226, v227
    v_cvt_pk_bf16_f32 v182, v224, v225
    v_mfma_f32_16x16x32_bf16 v[80:83], v[188:191], a[204:207], v[6:9]
    v_exp_f32 v222, v222
    v_mfma_f32_16x16x32_bf16 v[68:71], v[188:191], a[180:183], v[6:9]
    v_exp_f32 v221, v221
    v_mfma_f32_16x16x32_bf16 v[76:79], v[188:191], a[196:199], v[6:9]
    v_cvt_pk_bf16_f32 v180, v220, v221
    v_cvt_pk_bf16_f32 v181, v222, v223
    v_mfma_f32_16x16x32_bf16 v[72:75], v[188:191], a[188:191], v[6:9]
    s_waitcnt vmcnt(5)
    s_barrier
    ds_read_b128 a[32:35], v5 offset:8704
    v_mfma_f32_16x16x32_bf16 v[224:227], a[108:111], a[28:31], v[240:243]
    v_exp_f32 v232, v232
    v_mfma_f32_16x16x32_bf16 v[224:227], a[104:107], a[24:27], v[224:227]
    v_exp_f32 v229, v229
    v_mfma_f32_16x16x32_bf16 v[224:227], a[100:103], a[20:23], v[224:227]
    s_add_u32 m0, s36, 17472
    ds_read_b128 a[36:39], v5 offset:8768
    v_exp_f32 v231, v231
    v_mfma_f32_16x16x32_bf16 v[220:223], a[80:83], a[16:19], v[240:243]
    v_exp_f32 v235, v235
    v_mfma_f32_16x16x32_bf16 v[220:223], a[84:87], a[20:23], v[220:223]
    ds_read_b128 a[44:47], v5 offset:8896
    v_exp_f32 v230, v230
    v_mfma_f32_16x16x32_bf16 v[60:63], v[188:191], a[160:163], v[6:9]
    v_exp_f32 v228, v228
    s_waitcnt lgkmcnt(2)
    v_mfma_f32_4x4x4_16b_bf16 v[196:199], a[232:233], a[32:33], 0
    ds_read_b128 a[40:43], v5 offset:8832
    v_mfma_f32_4x4x4_16b_bf16 v[200:203], a[232:233], a[34:35], 0
    buffer_load_dwordx4 v3, s[12:15], s22 offen offset:1024 nt lds
    v_exp_f32 v233, v233
    v_mfma_f32_4x4x4_16b_bf16 v[200:203], a[234:235], a[34:35], v[200:203]
    s_add_u32 m0, s36, 17536
    v_mfma_f32_4x4x4_16b_bf16 v[196:199], a[234:235], a[32:33], v[196:199]
    s_waitcnt lgkmcnt(2)
    v_mfma_f32_4x4x4_16b_bf16 v[244:247], a[232:233], a[36:37], 0
    v_cvt_pk_bf16_f32 v194, v232, v233
    v_cvt_pk_bf16_f32 v200, v200, v201
    v_mfma_f32_16x16x32_bf16 v[224:227], a[96:99], a[16:19], v[224:227]
    v_accvgpr_write_b32 a34, v200
    v_cvt_pk_bf16_f32 v196, v196, v197
    v_cvt_pk_bf16_f32 v201, v202, v203
    v_cvt_pk_bf16_f32 v193, v230, v231
    v_mfma_f32_16x16x32_bf16 v[220:223], a[88:91], a[24:27], v[220:223]
    buffer_load_dwordx4 v3, s[12:15], s22 offen offset:2048 nt lds
    v_cvt_pk_bf16_f32 v197, v198, v199
    v_accvgpr_write_b32 a32, v196
    v_mfma_f32_4x4x4_16b_bf16 v[244:247], a[234:235], a[36:37], v[244:247]
    v_accvgpr_write_b32 a35, v201
    v_accvgpr_write_b32 a33, v197
    v_mfma_f32_4x4x4_16b_bf16 v[196:199], a[232:233], a[38:39], 0
    s_waitcnt lgkmcnt(0)
    v_mfma_f32_4x4x4_16b_bf16 v[200:203], a[232:233], a[40:41], 0
    v_cvt_pk_bf16_f32 v244, v244, v245
    v_accvgpr_write_b32 a36, v244
    v_mfma_f32_4x4x4_16b_bf16 v[200:203], a[234:235], a[40:41], v[200:203]
    v_cvt_pk_bf16_f32 v245, v246, v247
    v_mfma_f32_4x4x4_16b_bf16 v[196:199], a[234:235], a[38:39], v[196:199]
    v_exp_f32 v225, v225
    v_accvgpr_write_b32 a37, v245
    v_mfma_f32_4x4x4_16b_bf16 v[244:247], a[232:233], a[42:43], 0
    v_cvt_pk_bf16_f32 v200, v200, v201
    v_cvt_pk_bf16_f32 v201, v202, v203
    v_accvgpr_write_b32 a40, v200
    v_mfma_f32_4x4x4_16b_bf16 v[244:247], a[234:235], a[42:43], v[244:247]
    v_accvgpr_write_b32 a41, v201
    v_mfma_f32_4x4x4_16b_bf16 v[200:203], a[232:233], a[46:47], 0
    v_cvt_pk_bf16_f32 v196, v196, v197
    v_cvt_pk_bf16_f32 v197, v198, v199
    v_accvgpr_write_b32 a39, v197
    v_mfma_f32_4x4x4_16b_bf16 v[200:203], a[234:235], a[46:47], v[200:203]
    v_accvgpr_write_b32 a38, v196
    v_mfma_f32_4x4x4_16b_bf16 v[196:199], a[232:233], a[44:45], 0
    v_cvt_pk_bf16_f32 v244, v244, v245
    v_accvgpr_write_b32 a42, v244
    v_mfma_f32_16x16x32_bf16 v[220:223], a[92:95], a[28:31], v[220:223]
    v_cvt_pk_bf16_f32 v200, v200, v201
    v_accvgpr_write_b32 a46, v200
    v_cvt_pk_bf16_f32 v201, v202, v203
    v_mfma_f32_4x4x4_16b_bf16 v[196:199], a[234:235], a[44:45], v[196:199]
    v_cvt_pk_bf16_f32 v245, v246, v247
    v_accvgpr_write_b32 a43, v245
    v_accvgpr_write_b32 a47, v201
    v_mfma_f32_16x16x32_bf16 v[12:15], v[148:151], a[32:35], 0
    s_add_u32 m0, s36, 17600
    v_cvt_pk_bf16_f32 v196, v196, v197
    v_accvgpr_write_b32 a44, v196
    v_mfma_f32_16x16x32_bf16 v[12:15], v[152:155], a[36:39], v[12:15]
    v_cvt_pk_bf16_f32 v197, v198, v199
    v_accvgpr_write_b32 a45, v197
    v_mfma_f32_16x16x32_bf16 v[12:15], v[156:159], a[40:43], v[12:15]
    v_exp_f32 v224, v224
    v_mfma_f32_16x16x32_bf16 v[12:15], v[160:163], a[44:47], v[12:15]
    buffer_load_dwordx4 v3, s[12:15], s22 offen offset:3072 nt lds
    v_exp_f32 v223, v223
    v_mfma_f32_16x16x32_bf16 v[16:19], v[176:179], a[44:47], 0
    v_exp_f32 v234, v234
    v_mfma_f32_16x16x32_bf16 v[16:19], v[172:175], a[40:43], v[16:19]
    v_exp_f32 v227, v227
    v_mfma_f32_16x16x32_bf16 v[16:19], v[168:171], a[36:39], v[16:19]
    v_exp_f32 v222, v222
    v_mfma_f32_16x16x32_bf16 v[16:19], v[164:167], a[32:35], v[16:19]
    s_add_u32 s22, s22, 4096
    v_cvt_pk_bf16_f32 v192, v228, v229
    v_max3_f32 v11, v12, v13, v14
    v_cvt_pk_bf16_f32 v195, v234, v235
    v_mfma_f32_16x16x32_bf16 v[52:55], v[188:191], a[144:147], v[6:9]
    v_exp_f32 v221, v221
    v_mfma_f32_16x16x32_bf16 v[60:63], v[192:195], a[164:167], v[60:63]
    s_nop 0
    v_max3_f32 v0, v15, v16, v17
    v_max3_f32 v11, v11, v18, v19
    v_max_f32 v11, v11, v0
    v_mov_b32 v0, v11
    v_mfma_f32_16x16x32_bf16 v[52:55], v[192:195], a[148:151], v[52:55]
    s_nop 0
    v_permlane32_swap_b32 v11, v0
    v_mfma_f32_16x16x32_bf16 v[64:67], v[192:195], a[172:175], v[6:9]
    v_max_f32 v11, v11, v0
    v_mov_b32 v0, v11
    v_mfma_f32_16x16x32_bf16 v[64:67], v[188:191], a[168:171], v[64:67]
    s_nop 0
    v_permlane16_swap_b32 v11, v0
    v_max_f32 v11, v11, v0
    v_sub_f32 v245, s3, v11
    v_sub_f32 v244, s3, v11
    v_pk_add_f32 v[12:13], v[12:13], v[244:245]
    v_pk_add_f32 v[14:15], v[14:15], v[244:245]
    v_pk_add_f32 v[18:19], v[18:19], v[244:245]
    v_pk_add_f32 v[16:17], v[16:17], v[244:245]
    v_sub_f32 v247, s3, v11
    v_sub_f32 v246, s3, v11
    v_smfmac_f32_16x16x64_bf16 a[212:215], a[228:231], v[188:195], v10
    v_exp_f32 v13, v13
    v_mfma_f32_16x16x32_bf16 v[228:231], a[112:115], a[32:35], v[244:247]
    s_add_u32 s12, s12, 159744
    v_exp_f32 v14, v14
    v_mfma_f32_16x16x32_bf16 v[228:231], a[116:119], a[36:39], v[228:231]
    v_exp_f32 v17, v17
    v_mfma_f32_16x16x32_bf16 v[228:231], a[120:123], a[40:43], v[228:231]
    v_exp_f32 v15, v15
    v_mfma_f32_16x16x32_bf16 v[228:231], a[124:127], a[44:47], v[228:231]
    s_addc_u32 s13, s13, 0
    v_exp_f32 v19, v19
    v_mfma_f32_16x16x32_bf16 v[56:59], v[192:195], a[156:159], v[6:9]
    v_exp_f32 v18, v18
    v_mfma_f32_16x16x32_bf16 v[56:59], v[188:191], a[152:155], v[56:59]
    v_exp_f32 v12, v12
    v_mfma_f32_16x16x32_bf16 v[232:235], a[140:143], a[44:47], v[244:247]
    s_sub_u32 s22, s38, 1024
    v_exp_f32 v16, v16
    v_mfma_f32_16x16x32_bf16 v[232:235], a[136:139], a[40:43], v[232:235]
    s_add_u32 s34, s38, 20480
    v_cvt_pk_bf16_f32 v196, v12, v13
    v_cvt_pk_bf16_f32 v197, v14, v15
    v_mfma_f32_16x16x32_bf16 v[232:235], a[132:135], a[36:39], v[232:235]
    s_min_u32 s14, s34, 159744
    v_cvt_pk_bf16_f32 v198, v16, v17
    v_cvt_pk_bf16_f32 v199, v18, v19
    v_mfma_f32_16x16x32_bf16 v[232:235], a[128:131], a[32:35], v[232:235]
    v_exp_f32 v226, v226
    v_mfma_f32_16x16x32_bf16 v[104:107], v[196:199], a[188:191], v[6:9]
    v_exp_f32 v220, v220
    v_mfma_f32_16x16x32_bf16 v[112:115], v[196:199], a[204:207], v[6:9]
    s_add_u32 m0, s24, 25344
    v_cvt_pk_bf16_f32 v188, v220, v221
    v_cvt_pk_bf16_f32 v190, v224, v225
    v_mfma_f32_16x16x32_bf16 v[100:103], v[196:199], a[180:183], v[6:9]
    buffer_load_dwordx4 v3, s[4:7], 0 offen nt lds
    v_cvt_pk_bf16_f32 v191, v226, v227
    v_cvt_pk_bf16_f32 v189, v222, v223
    v_mfma_f32_16x16x32_bf16 v[108:111], v[196:199], a[196:199], v[6:9]
    s_waitcnt vmcnt(5)
    ds_read_b128 a[48:51], v5 offset:13056
    v_exp_f32 v230, v230
    v_mfma_f32_16x16x32_bf16 v[220:223], a[80:83], a[32:35], v[244:247]
    v_exp_f32 v233, v233
    v_mfma_f32_16x16x32_bf16 v[220:223], a[84:87], a[36:39], v[220:223]
    v_exp_f32 v235, v235
    v_mfma_f32_16x16x32_bf16 v[220:223], a[88:91], a[40:43], v[220:223]
    ds_read_b128 a[52:55], v5 offset:13120
    v_mfma_f32_16x16x32_bf16 v[220:223], a[92:95], a[44:47], v[220:223]
    v_exp_f32 v234, v234
    v_mfma_f32_16x16x32_bf16 v[224:227], a[108:111], a[44:47], v[244:247]
    v_exp_f32 v231, v231
    v_mfma_f32_16x16x32_bf16 v[224:227], a[104:107], a[40:43], v[224:227]
    s_add_u32 m0, s24, 25376
    ds_read_b128 a[60:63], v5 offset:13248
    v_cvt_pk_bf16_f32 v203, v234, v235
    v_mfma_f32_16x16x32_bf16 v[224:227], a[100:103], a[36:39], v[224:227]
    v_exp_f32 v220, v220
    s_waitcnt lgkmcnt(2)
    v_mfma_f32_4x4x4_16b_bf16 v[204:207], a[232:233], a[48:49], 0
    ds_read_b128 a[56:59], v5 offset:13184
    v_mfma_f32_4x4x4_16b_bf16 v[208:211], a[232:233], a[50:51], 0
    v_exp_f32 v228, v228
    v_mfma_f32_4x4x4_16b_bf16 v[204:207], a[234:235], a[48:49], v[204:207]
    s_waitcnt lgkmcnt(2)
    v_mfma_f32_4x4x4_16b_bf16 v[248:251], a[232:233], a[52:53], 0
    buffer_load_dwordx4 v3, s[4:7], 0 offen offset:1024 nt lds
    v_exp_f32 v229, v229
    v_mfma_f32_4x4x4_16b_bf16 v[208:211], a[234:235], a[50:51], v[208:211]
    v_cvt_pk_bf16_f32 v204, v204, v205
    v_cvt_pk_bf16_f32 v205, v206, v207
    v_accvgpr_write_b32 a48, v204
    v_mfma_f32_4x4x4_16b_bf16 v[248:251], a[234:235], a[52:53], v[248:251]
    v_accvgpr_write_b32 a49, v205
    v_mfma_f32_4x4x4_16b_bf16 v[204:207], a[232:233], a[54:55], 0
    v_cvt_pk_bf16_f32 v208, v208, v209
    v_cvt_pk_bf16_f32 v209, v210, v211
    v_accvgpr_write_b32 a50, v208
    v_mfma_f32_4x4x4_16b_bf16 v[204:207], a[234:235], a[54:55], v[204:207]
    v_cvt_pk_bf16_f32 v248, v248, v249
    v_cvt_pk_bf16_f32 v249, v250, v251
    v_accvgpr_write_b32 a53, v249
    v_accvgpr_write_b32 a51, v209
    s_waitcnt lgkmcnt(0)
    v_mfma_f32_4x4x4_16b_bf16 v[208:211], a[232:233], a[56:57], 0
    v_accvgpr_write_b32 a52, v248
    v_mfma_f32_4x4x4_16b_bf16 v[248:251], a[232:233], a[58:59], 0
    v_cvt_pk_bf16_f32 v204, v204, v205
    v_mfma_f32_4x4x4_16b_bf16 v[208:211], a[234:235], a[56:57], v[208:211]
    v_accvgpr_write_b32 a54, v204
    v_mfma_f32_4x4x4_16b_bf16 v[248:251], a[234:235], a[58:59], v[248:251]
    v_cvt_pk_bf16_f32 v205, v206, v207
    v_accvgpr_write_b32 a55, v205
    v_mfma_f32_4x4x4_16b_bf16 v[204:207], a[232:233], a[60:61], 0
    v_cvt_pk_bf16_f32 v208, v208, v209
    v_cvt_pk_bf16_f32 v209, v210, v211
    v_accvgpr_write_b32 a57, v209
    v_mfma_f32_4x4x4_16b_bf16 v[204:207], a[234:235], a[60:61], v[204:207]
    v_accvgpr_write_b32 a56, v208
    v_mfma_f32_4x4x4_16b_bf16 v[208:211], a[232:233], a[62:63], 0
    v_cvt_pk_bf16_f32 v248, v248, v249
    v_cvt_pk_bf16_f32 v249, v250, v251
    v_mfma_f32_4x4x4_16b_bf16 v[208:211], a[234:235], a[62:63], v[208:211]
    v_exp_f32 v232, v232
    v_accvgpr_write_b32 a58, v248
    v_cvt_pk_bf16_f32 v204, v204, v205
    v_mfma_f32_16x16x32_bf16 v[224:227], a[96:99], a[32:35], v[224:227]
    s_nop 0
    v_cvt_pk_bf16_f32 v208, v208, v209
    v_accvgpr_write_b32 a59, v249
    v_accvgpr_write_b32 a62, v208
    v_cvt_pk_bf16_f32 v209, v210, v211
    v_mfma_f32_16x16x32_bf16 v[12:15], v[148:151], a[48:51], 0
    v_cvt_pk_bf16_f32 v205, v206, v207
    v_accvgpr_write_b32 a61, v205
    v_mfma_f32_16x16x32_bf16 v[12:15], v[152:155], a[52:55], v[12:15]
    v_accvgpr_write_b32 a63, v209
    v_accvgpr_write_b32 a60, v204
    v_mfma_f32_16x16x32_bf16 v[12:15], v[156:159], a[56:59], v[12:15]
    v_exp_f32 v222, v222
    v_mfma_f32_16x16x32_bf16 v[12:15], v[160:163], a[60:63], v[12:15]
    v_cvt_pk_bf16_f32 v202, v232, v233
    v_cvt_pk_bf16_f32 v200, v228, v229
    v_mfma_f32_16x16x32_bf16 v[16:19], v[176:179], a[60:63], 0
    s_add_u32 s4, s4, 8192
    v_exp_f32 v224, v224
    v_mfma_f32_16x16x32_bf16 v[16:19], v[172:175], a[56:59], v[16:19]
    v_exp_f32 v225, v225
    v_mfma_f32_16x16x32_bf16 v[16:19], v[168:171], a[52:55], v[16:19]
    s_addc_u32 s5, s5, 0
    v_exp_f32 v227, v227
    v_mfma_f32_16x16x32_bf16 v[16:19], v[164:167], a[48:51], v[16:19]
    s_sub_u32 s20, s20, 8192
    v_max3_f32 v11, v12, v13, v14
    v_cvt_pk_bf16_f32 v201, v230, v231
    v_mfma_f32_16x16x32_bf16 v[84:87], v[196:199], a[144:147], v[6:9]
    s_max_i32 s6, s20, 0
    v_exp_f32 v223, v223
    v_mfma_f32_16x16x32_bf16 v[92:95], v[196:199], a[160:163], v[6:9]
    s_nop 0
    v_max3_f32 v0, v15, v16, v17
    v_max3_f32 v11, v11, v18, v19
    v_mfma_f32_16x16x32_bf16 v[88:91], v[200:203], a[156:159], v[6:9]
    s_add_u32 m0, s25, 16640
    v_max_f32 v11, v11, v0
    v_mov_b32 v0, v11
    v_mfma_f32_16x16x32_bf16 v[88:91], v[196:199], a[152:155], v[88:91]
    s_nop 0
    v_permlane32_swap_b32 v11, v0
    v_mfma_f32_16x16x32_bf16 v[96:99], v[200:203], a[172:175], v[6:9]
    buffer_load_dwordx4 v4, s[8:11], 0 offen nt lds
    v_max_f32 v11, v11, v0
    v_mov_b32 v0, v11
    v_mfma_f32_16x16x32_bf16 v[92:95], v[200:203], a[164:167], v[92:95]
    s_add_u32 m0, s25, 16656
    v_permlane16_swap_b32 v11, v0
    v_max_f32 v11, v11, v0
    v_sub_f32 v248, s3, v11
    v_sub_f32 v249, s3, v11
    v_pk_add_f32 v[16:17], v[16:17], v[248:249]
    v_pk_add_f32 v[18:19], v[18:19], v[248:249]
    v_pk_add_f32 v[12:13], v[12:13], v[248:249]
    v_exp_f32 v17, v17
    v_pk_add_f32 v[14:15], v[14:15], v[248:249]
    v_smfmac_f32_16x16x64_bf16 a[216:219], a[228:231], v[196:203], v10
    buffer_load_dwordx4 v4, s[8:11], 0 offen offset:1024 nt lds
    v_sub_f32 v250, s3, v11
    v_sub_f32 v251, s3, v11
    v_mfma_f32_16x16x32_bf16 v[84:87], v[200:203], a[148:151], v[84:87]
    v_exp_f32 v15, v15
    v_mfma_f32_16x16x32_bf16 v[232:235], a[140:143], a[60:63], v[248:251]
    s_add_u32 s8, s8, 8064
    v_exp_f32 v14, v14
    v_mfma_f32_16x16x32_bf16 v[232:235], a[136:139], a[56:59], v[232:235]
    v_exp_f32 v13, v13
    v_mfma_f32_16x16x32_bf16 v[232:235], a[132:135], a[52:55], v[232:235]
    v_exp_f32 v18, v18
    v_mfma_f32_16x16x32_bf16 v[232:235], a[128:131], a[48:51], v[232:235]
    v_exp_f32 v12, v12
    v_mfma_f32_16x16x32_bf16 v[96:99], v[196:199], a[168:171], v[96:99]
    v_exp_f32 v19, v19
    v_mfma_f32_16x16x32_bf16 v[228:231], a[112:115], a[48:51], v[248:251]
    s_addc_u32 s9, s9, 0
    v_cvt_pk_bf16_f32 v207, v18, v19
    v_cvt_pk_bf16_f32 v204, v12, v13
    v_mfma_f32_16x16x32_bf16 v[228:231], a[116:119], a[52:55], v[228:231]
    s_sub_u32 s21, s21, 8064
    v_exp_f32 v16, v16
    v_mfma_f32_16x16x32_bf16 v[228:231], a[120:123], a[56:59], v[228:231]
    s_max_i32 s10, s21, 0
    v_cvt_pk_bf16_f32 v206, v16, v17
    v_cvt_pk_bf16_f32 v205, v14, v15
    v_mfma_f32_16x16x32_bf16 v[228:231], a[124:127], a[60:63], v[228:231]
    s_add_u32 m0, s24, 0
    v_exp_f32 v221, v221
    v_mfma_f32_16x16x32_bf16 v[144:147], v[204:207], a[204:207], v[6:9]
    v_cvt_pk_bf16_f32 v196, v220, v221
    v_cvt_pk_bf16_f32 v198, v224, v225
    v_mfma_f32_16x16x32_bf16 v[140:143], v[204:207], a[196:199], v[6:9]
    buffer_load_dwordx4 v3, s[4:7], 0 offen nt lds
    v_exp_f32 v226, v226
    v_mfma_f32_16x16x32_bf16 v[132:135], v[204:207], a[180:183], v[6:9]
    v_cvt_pk_bf16_f32 v199, v226, v227
    v_cvt_pk_bf16_f32 v197, v222, v223
    v_mfma_f32_16x16x32_bf16 v[136:139], v[204:207], a[188:191], v[6:9]
    s_waitcnt vmcnt(5)
    v_exp_f32 v230, v230
    v_mfma_f32_16x16x32_bf16 v[220:223], a[80:83], a[48:51], v[248:251]
    s_add_u32 m0, s24, 32
    ds_read_b128 a[64:67], v5 offset:17408
    buffer_load_dwordx4 v3, s[4:7], 0 offen offset:1024 nt lds
    v_exp_f32 v233, v233
    v_mfma_f32_16x16x32_bf16 v[224:227], a[108:111], a[60:63], v[248:251]
    v_exp_f32 v228, v228
    v_mfma_f32_16x16x32_bf16 v[224:227], a[104:107], a[56:59], v[224:227]
    s_add_u32 s4, s4, 8192
    v_exp_f32 v234, v234
    v_mfma_f32_16x16x32_bf16 v[224:227], a[100:103], a[52:55], v[224:227]
    s_addc_u32 s5, s5, 0
    s_sub_u32 s20, s20, 8192
    ds_read_b128 a[68:71], v5 offset:17472
    v_mfma_f32_16x16x32_bf16 v[224:227], a[96:99], a[48:51], v[224:227]
    s_max_i32 s6, s20, 0
    v_exp_f32 v235, v235
    v_mfma_f32_16x16x32_bf16 v[220:223], a[84:87], a[52:55], v[220:223]
    s_add_u32 m0, s25, 24960
    ds_read_b128 a[76:79], v5 offset:17600
    buffer_load_dwordx4 v4, s[8:11], 0 offen nt lds
    v_exp_f32 v232, v232
    s_waitcnt lgkmcnt(2)
    v_mfma_f32_4x4x4_16b_bf16 v[216:219], a[232:233], a[66:67], 0
    v_cvt_pk_bf16_f32 v210, v232, v233
    v_mfma_f32_4x4x4_16b_bf16 v[212:215], a[232:233], a[64:65], 0
    s_add_u32 m0, s25, 24976
    v_mfma_f32_4x4x4_16b_bf16 v[216:219], a[234:235], a[66:67], v[216:219]
    ds_read_b128 a[72:75], v5 offset:17536
    v_mfma_f32_4x4x4_16b_bf16 v[212:215], a[234:235], a[64:65], v[212:215]
    v_exp_f32 v224, v224
    v_mfma_f32_16x16x32_bf16 v[116:119], v[204:207], a[144:147], v[6:9]
    buffer_load_dwordx4 v4, s[8:11], 0 offen offset:1024 nt lds
    v_cvt_pk_bf16_f32 v216, v216, v217
    s_waitcnt lgkmcnt(2)
    v_mfma_f32_4x4x4_16b_bf16 v[252:255], a[232:233], a[68:69], 0
    v_cvt_pk_bf16_f32 v212, v212, v213
    v_cvt_pk_bf16_f32 v213, v214, v215
    v_accvgpr_write_b32 a65, v213
    v_mfma_f32_4x4x4_16b_bf16 v[252:255], a[234:235], a[68:69], v[252:255]
    v_accvgpr_write_b32 a64, v212
    v_mfma_f32_4x4x4_16b_bf16 v[212:215], a[232:233], a[70:71], 0
    v_cvt_pk_bf16_f32 v217, v218, v219
    v_accvgpr_write_b32 a66, v216
    v_exp_f32 v229, v229
    v_mfma_f32_4x4x4_16b_bf16 v[212:215], a[234:235], a[70:71], v[212:215]
    v_cvt_pk_bf16_f32 v252, v252, v253
    v_accvgpr_write_b32 a67, v217
    v_accvgpr_write_b32 a68, v252
    v_mfma_f32_16x16x32_bf16 v[220:223], a[88:91], a[56:59], v[220:223]
    v_cvt_pk_bf16_f32 v211, v234, v235
    v_cvt_pk_bf16_f32 v212, v212, v213
    s_waitcnt lgkmcnt(0)
    v_mfma_f32_4x4x4_16b_bf16 v[216:219], a[232:233], a[72:73], 0
    v_cvt_pk_bf16_f32 v213, v214, v215
    v_cvt_pk_bf16_f32 v253, v254, v255
    v_mfma_f32_4x4x4_16b_bf16 v[216:219], a[234:235], a[72:73], v[216:219]
    v_accvgpr_write_b32 a69, v253
    v_accvgpr_write_b32 a71, v213
    v_mfma_f32_4x4x4_16b_bf16 v[252:255], a[232:233], a[74:75], 0
    v_accvgpr_write_b32 a70, v212
    v_mfma_f32_4x4x4_16b_bf16 v[212:215], a[232:233], a[76:77], 0
    v_cvt_pk_bf16_f32 v216, v216, v217
    v_mfma_f32_4x4x4_16b_bf16 v[252:255], a[234:235], a[74:75], v[252:255]
    v_accvgpr_write_b32 a72, v216
    v_mfma_f32_4x4x4_16b_bf16 v[212:215], a[234:235], a[76:77], v[212:215]
    v_cvt_pk_bf16_f32 v217, v218, v219
    v_accvgpr_write_b32 a73, v217
    v_mfma_f32_4x4x4_16b_bf16 v[216:219], a[232:233], a[78:79], 0
    v_cvt_pk_bf16_f32 v252, v252, v253
    v_accvgpr_write_b32 a74, v252
    v_mfma_f32_4x4x4_16b_bf16 v[216:219], a[234:235], a[78:79], v[216:219]
    v_cvt_pk_bf16_f32 v212, v212, v213
    v_cvt_pk_bf16_f32 v213, v214, v215
    v_accvgpr_write_b32 a76, v212
    v_mfma_f32_16x16x32_bf16 v[220:223], a[92:95], a[60:63], v[220:223]
    s_add_u32 s8, s8, 8320
    v_cvt_pk_bf16_f32 v253, v254, v255
    v_cvt_pk_bf16_f32 v216, v216, v217
    v_accvgpr_write_b32 a75, v253
    v_mfma_f32_16x16x32_bf16 v[12:15], v[148:151], a[64:67], 0
    v_cvt_pk_bf16_f32 v217, v218, v219
    v_accvgpr_write_b32 a78, v216
    v_mfma_f32_16x16x32_bf16 v[12:15], v[152:155], a[68:71], v[12:15]
    v_accvgpr_write_b32 a77, v213
    v_accvgpr_write_b32 a79, v217
    v_mfma_f32_16x16x32_bf16 v[12:15], v[156:159], a[72:75], v[12:15]
    v_exp_f32 v226, v226
    v_mfma_f32_16x16x32_bf16 v[12:15], v[160:163], a[76:79], v[12:15]
    v_exp_f32 v223, v223
    v_exp_f32 v221, v221
    v_mfma_f32_16x16x32_bf16 v[16:19], v[176:179], a[76:79], 0
    v_exp_f32 v220, v220
    v_mfma_f32_16x16x32_bf16 v[16:19], v[172:175], a[72:75], v[16:19]
    v_exp_f32 v225, v225
    v_mfma_f32_16x16x32_bf16 v[16:19], v[168:171], a[68:71], v[16:19]
    s_addc_u32 s9, s9, 0
    v_exp_f32 v231, v231
    v_mfma_f32_16x16x32_bf16 v[16:19], v[164:167], a[64:67], v[16:19]
    s_sub_u32 s21, s21, 8320
    v_cvt_pk_bf16_f32 v209, v230, v231
    v_max3_f32 v11, v12, v13, v14
    v_cvt_pk_bf16_f32 v208, v228, v229
    v_mfma_f32_16x16x32_bf16 v[124:127], v[204:207], a[160:163], v[6:9]
    s_max_i32 s10, s21, 0
    v_exp_f32 v227, v227
    v_mfma_f32_16x16x32_bf16 v[124:127], v[208:211], a[164:167], v[124:127]
    s_add_u32 s22, s22, 1024
    v_max3_f32 v0, v15, v16, v17
    v_max3_f32 v11, v11, v18, v19
    v_mfma_f32_16x16x32_bf16 v[120:123], v[208:211], a[156:159], v[6:9]
    s_add_u32 s23, s23, 1088
    v_max_f32 v11, v11, v0
    v_mov_b32 v0, v11
    v_mfma_f32_16x16x32_bf16 v[120:123], v[204:207], a[152:155], v[120:123]
    s_nop 0
    v_permlane32_swap_b32 v11, v0
    v_max_f32 v11, v11, v0
    v_mov_b32 v0, v11
    v_smfmac_f32_16x16x64_bf16 a[220:223], a[228:231], v[204:211], v10
L_pad9:
    s_cbranch_execz L_pad0
    s_min_u32 m0, s23, s48
    v_permlane16_swap_b32 v11, v0
    v_max3_f32 v11, v11, v0, s54
    v_sub_f32 v253, s3, v11
    v_sub_f32 v252, s3, v11
    v_pk_add_f32 v[18:19], v[18:19], v[252:253]
    v_pk_add_f32 v[14:15], v[14:15], v[252:253]
    v_pk_add_f32 v[16:17], v[16:17], v[252:253]
    v_sub_f32 v255, s3, v11
    v_pk_add_f32 v[12:13], v[12:13], v[252:253]
    v_exp_f32 v12, v12
    v_sub_f32 v254, s3, v11
    v_mfma_f32_16x16x32_bf16 v[116:119], v[208:211], a[148:151], v[116:119]
    buffer_load_dwordx4 v3, s[12:15], s22 offen nt lds
    v_exp_f32 v13, v13
    v_mfma_f32_16x16x32_bf16 v[228:231], a[112:115], a[64:67], v[252:255]
    v_exp_f32 v18, v18
    v_mfma_f32_16x16x32_bf16 v[228:231], a[116:119], a[68:71], v[228:231]
    v_exp_f32 v17, v17
    v_mfma_f32_16x16x32_bf16 v[228:231], a[120:123], a[72:75], v[228:231]
    v_exp_f32 v14, v14
    v_mfma_f32_16x16x32_bf16 v[228:231], a[124:127], a[76:79], v[228:231]
    v_exp_f32 v16, v16
    v_mfma_f32_16x16x32_bf16 v[232:235], a[140:143], a[76:79], v[252:255]
    v_exp_f32 v19, v19
    v_mfma_f32_16x16x32_bf16 v[232:235], a[136:139], a[72:75], v[232:235]
    v_exp_f32 v15, v15
    v_mfma_f32_16x16x32_bf16 v[232:235], a[132:135], a[68:71], v[232:235]
    v_exp_f32 v222, v222
    v_mfma_f32_16x16x32_bf16 v[232:235], a[128:131], a[64:67], v[232:235]
    v_cvt_pk_bf16_f32 v213, v14, v15
    v_cvt_pk_bf16_f32 v214, v16, v17
    v_mfma_f32_16x16x32_bf16 v[128:131], v[208:211], a[172:175], v[6:9]
    v_cvt_pk_bf16_f32 v212, v12, v13
    v_cvt_pk_bf16_f32 v215, v18, v19
    v_mfma_f32_16x16x32_bf16 v[128:131], v[204:207], a[168:171], v[128:131]
    s_waitcnt vmcnt(5)
    s_barrier
    ds_read_b128 a[132:135], v1 offset:25920
    v_mfma_f32_16x16x32_bf16 v[168:171], v[212:215], a[188:191], v[6:9]
    s_add_u32 m0, s24, 8448
    ds_read_b128 a[128:131], v1 offset:25856
    buffer_load_dwordx4 v3, s[4:7], 0 offen nt lds
    v_exp_f32 v234, v234
    v_mfma_f32_16x16x32_bf16 v[164:167], v[212:215], a[180:183], v[6:9]
    s_add_u32 m0, s24, 8480
    ds_read_b64_tr_b16 a[186:187], v2 offset:17168
    buffer_load_dwordx4 v3, s[4:7], 0 offen offset:1024 nt lds
    v_cvt_pk_bf16_f32 v204, v220, v221
    v_cvt_pk_bf16_f32 v205, v222, v223
    v_mfma_f32_16x16x32_bf16 v[220:223], a[80:83], a[64:67], v[252:255]
    s_add_u32 s4, s4, 8192
    v_exp_f32 v228, v228
    v_cvt_pk_bf16_f32 v206, v224, v225
    v_mfma_f32_16x16x32_bf16 v[176:179], v[212:215], a[204:207], v[6:9]
    s_addc_u32 s5, s5, 0
    v_exp_f32 v233, v233
    v_exp_f32 v235, v235
    v_exp_f32 v232, v232
    v_mfma_f32_16x16x32_bf16 v[148:151], v[212:215], a[144:147], v[6:9]
    s_sub_u32 s20, s20, 8192
    v_exp_f32 v230, v230
    v_mfma_f32_16x16x32_bf16 v[172:175], v[212:215], a[196:199], v[6:9]
    s_max_i32 s6, s20, 0
    s_add_u32 m0, s25, 0
    ds_read_b128 a[140:143], v1 offset:26048
    buffer_load_dwordx4 v4, s[8:11], 0 offen nt lds
    v_exp_f32 v229, v229
    v_cvt_pk_bf16_f32 v207, v226, v227
    v_mfma_f32_16x16x32_bf16 v[224:227], a[108:111], a[76:79], v[252:255]
    s_add_u32 m0, s25, 16
    ds_read_b64_tr_b16 a[178:179], v2 offset:17152
    ds_read_b128 a[116:119], v1 offset:25408
    v_mfma_f32_16x16x32_bf16 v[224:227], a[104:107], a[72:75], v[224:227]
    s_mov_b64 vcc, 64
    buffer_load_dwordx4 v4, s[8:11], 0 offen offset:1024 nt lds
    v_exp_f32 v231, v231
    v_mfma_f32_16x16x32_bf16 v[220:223], a[84:87], a[68:71], v[220:223]
    s_add_u32 s8, s8, 8064
    s_addc_u32 s9, s9, 0
    v_cvt_pk_bf16_f32 v216, v228, v229
    v_mfma_f32_16x16x32_bf16 v[220:223], a[88:91], a[72:75], v[220:223]
    s_sub_u32 s21, s21, 8064
    ds_read_b128 a[124:127], v1 offset:25536
    v_cvt_pk_bf16_f32 v218, v232, v233
    v_mfma_f32_16x16x32_bf16 v[220:223], a[92:95], a[76:79], v[220:223]
    s_max_i32 s10, s21, 0
    s_add_u32 s22, s22, 1024
    ds_read_b64_tr_b16 a[176:177], v2 offset:16640
    v_mfma_f32_16x16x32_bf16 v[224:227], a[100:103], a[68:71], v[224:227]
    s_add_u32 s23, s23, 1088
    ds_read_b128 a[112:115], v1 offset:25344
    v_cvt_pk_bf16_f32 v219, v234, v235
    v_cvt_pk_bf16_f32 v217, v230, v231
    v_mfma_f32_16x16x32_bf16 v[156:159], v[212:215], a[160:163], v[6:9]
    s_min_u32 m0, s23, s48
    ds_read_b64_tr_b16 a[200:201], v2 offset:16688
    buffer_load_dwordx4 v3, s[12:15], s22 offen nt lds
    ds_read_b64_tr_b16 a[204:205], v2 offset:20848
    ds_read_b64_tr_b16 a[196:197], v2 offset:20832
    ds_read_b64_tr_b16 a[180:181], v2 offset:20800
    v_mfma_f32_16x16x32_bf16 v[160:163], v[216:219], a[172:175], v[6:9]
    s_add_u32 m0, s24, 16896
    ds_read_b64_tr_b16 a[198:199], v2 offset:21344
    ds_read_b128 a[120:123], v1 offset:25472
    buffer_load_dwordx4 v3, s[4:7], 0 offen nt lds
    v_accvgpr_write_b32 a232, v6
    v_lshrrev_b32 v0, 0, v3
    v_mfma_f32_16x16x32_bf16 v[160:163], v[212:215], a[168:171], v[160:163]
    s_add_u32 m0, s24, 16928
    ds_read_b64_tr_b16 a[206:207], v2 offset:21360
    buffer_load_dwordx4 v3, s[4:7], 0 offen offset:1024 nt lds
    ds_read_b64_tr_b16 a[192:193], v2 offset:16672
    ds_read_b64_tr_b16 a[182:183], v2 offset:21312
    v_mfma_f32_16x16x32_bf16 v[152:155], v[216:219], a[156:159], v[6:9]
    s_add_u32 s4, s4, 8192
    ds_read_b64_tr_b16 a[194:195], v2 offset:17184
    ds_read_b64_tr_b16 a[188:189], v2 offset:20816
    v_mfma_f32_16x16x32_bf16 v[152:155], v[212:215], a[152:155], v[152:155]
    s_addc_u32 s5, s5, 0
    ds_read_b128 a[136:139], v1 offset:25984
    s_sub_u32 s20, s20, 8192
    ds_read_b64_tr_b16 a[190:191], v2 offset:21328
    v_mfma_f32_16x16x32_bf16 v[224:227], a[96:99], a[64:67], v[224:227]
    s_max_i32 s6, s20, 0
    s_add_u32 m0, s25, 8320
    ds_read_b64_tr_b16 a[184:185], v2 offset:16656
    buffer_load_dwordx4 v4, s[8:11], 0 offen nt lds
    s_add_u32 m0, s25, 8336
    ds_read_b64_tr_b16 a[202:203], v2 offset:17200
    buffer_load_dwordx4 v4, s[8:11], 0 offen offset:1024 nt lds
    v_accvgpr_read_b32 v7, a253
    s_add_u32 s8, s8, 8320
    v_mfma_f32_16x16x32_bf16 v[156:159], v[216:219], a[164:167], v[156:159]
    s_addc_u32 s9, s9, 0
    s_sub_u32 s21, s21, 8320
    s_max_i32 s10, s21, 0
    v_mfma_f32_16x16x32_bf16 v[148:151], v[216:219], a[148:151], v[148:151]
    s_add_u32 s22, s22, 1024
    s_add_u32 s23, s23, 1088
    v_accvgpr_read_b32 v8, a254
    v_accvgpr_read_b32 v9, a255
    v_accvgpr_read_b32 v6, a252
    s_min_u32 m0, s23, s48
    s_add_u32 s34, s36, 19584
    v_smfmac_f32_16x16x64_bf16 a[224:227], a[228:231], v[212:219], v10
    s_mov_b32 s26, -19584
    buffer_load_dwordx4 v3, s[12:15], s22 offen nt lds
    v_add_u32 v0, s34, v0
    s_waitcnt vmcnt(11)
    s_waitcnt lgkmcnt(0)
    s_barrier
    s_branch L_started
.p2align 6
L_loop0_1:
    v_mfma_f32_16x16x32_bf16 v[48:51], v[184:187], a[200:203], v[48:51]
    v_mfma_f32_16x16x32_bf16 v[48:51], v[180:183], a[204:207], v[48:51]
    s_add_u32 m0, s24, 25344
    ds_read_b128 a[80:83], v1 offset:0
    v_lshlrev_b32 v11, 16, v12
    v_mfma_f32_16x16x32_bf16 v[44:47], v[180:183], a[196:199], v[44:47]
    v_mfma_f32_16x16x32_bf16 v[44:47], v[184:187], a[192:195], v[44:47]
    buffer_load_dwordx4 v3, s[4:7], 0 offen nt lds
    v_mfma_f32_16x16x32_bf16 v[40:43], v[184:187], a[184:187], v[40:43]
    v_mfma_f32_16x16x32_bf16 v[40:43], v[180:183], a[188:191], v[40:43]
    ds_read_b64_tr_b16 a[144:145], v2 offset:24960
    v_and_b32 v12, s29, v12
    v_mfma_f32_16x16x32_bf16 v[36:39], v[180:183], a[180:183], v[36:39]
    v_mfma_f32_16x16x32_bf16 v[36:39], v[184:187], a[176:179], v[36:39]
    ds_read_b128 a[84:87], v1 offset:64
    v_mul_f32 v11, s30, v11
    v_mfma_f32_16x16x32_bf16 v[228:231], a[112:115], a[0:3], v[236:239]
    v_mfma_f32_16x16x32_bf16 v[228:231], a[116:119], a[4:7], v[228:231]
    v_mfma_f32_16x16x32_bf16 v[228:231], a[120:123], a[8:11], v[228:231]
    v_mfma_f32_16x16x32_bf16 v[228:231], a[124:127], a[12:15], v[228:231]
    ds_read_b64_tr_b16 a[146:147], v2 offset:25472
    v_mul_f32 v12, s30, v12
    v_mfma_f32_16x16x32_bf16 v[232:235], a[140:143], a[12:15], v[236:239]
    v_mfma_f32_16x16x32_bf16 v[232:235], a[136:139], a[8:11], v[232:235]
    v_mfma_f32_16x16x32_bf16 v[232:235], a[132:135], a[4:7], v[232:235]
    v_mfma_f32_16x16x32_bf16 v[232:235], a[128:131], a[0:3], v[232:235]
    ds_read_b64_tr_b16 a[148:149], v2 offset:29120
    ds_read_b64_tr_b16 a[150:151], v2 offset:29632
    v_mfma_f32_16x16x32_bf16 v[224:227], a[128:131], a[16:19], v[240:243]
    v_exp_f32 v228, v228
    v_mfma_f32_16x16x32_bf16 v[224:227], a[132:135], a[20:23], v[224:227]
    s_add_u32 m0, s24, 25376
    v_exp_f32 v229, v229
    v_mfma_f32_16x16x32_bf16 v[224:227], a[136:139], a[24:27], v[224:227]
    v_exp_f32 v230, v230
    v_mfma_f32_16x16x32_bf16 v[224:227], a[140:143], a[28:31], v[224:227]
    buffer_load_dwordx4 v3, s[4:7], 0 offen offset:1024 nt lds
    v_mfma_f32_16x16x32_bf16 v[220:223], a[124:127], a[28:31], v[240:243]
    s_add_u32 s4, s4, 8192
    v_exp_f32 v231, v231
    v_mfma_f32_16x16x32_bf16 v[220:223], a[120:123], a[24:27], v[220:223]
    s_addc_u32 s5, s5, 0
    v_cvt_pk_bf16_f32 v184, v228, v229
    v_cvt_pk_bf16_f32 v185, v230, v231
    v_mfma_f32_16x16x32_bf16 v[220:223], a[116:119], a[20:23], v[220:223]
    s_sub_u32 s20, s20, 8192
    v_exp_f32 v232, v232
    v_mfma_f32_16x16x32_bf16 v[220:223], a[112:115], a[16:19], v[220:223]
    s_max_i32 s6, s20, 0
    ds_read_b128 a[88:91], v1 offset:128
    v_cvt_pk_bf16_f32 v12, v11, v12
    v_mfma_f32_16x16x32_bf16 v[68:71], v[192:195], a[176:179], v[68:71]
    v_exp_f32 v233, v233
    v_mfma_f32_16x16x32_bf16 v[68:71], v[188:191], a[180:183], v[68:71]
    ds_read_b64_tr_b16 a[152:153], v2 offset:24976
    v_lshlrev_b32 v11, 16, v13
    v_mfma_f32_16x16x32_bf16 v[72:75], v[188:191], a[188:191], v[72:75]
    v_exp_f32 v234, v234
    v_mfma_f32_16x16x32_bf16 v[72:75], v[192:195], a[184:187], v[72:75]
    ds_read_b128 a[92:95], v1 offset:192
    v_and_b32 v13, s29, v13
    v_mfma_f32_16x16x32_bf16 v[76:79], v[192:195], a[192:195], v[76:79]
    v_exp_f32 v235, v235
    v_mfma_f32_16x16x32_bf16 v[76:79], v[188:191], a[196:199], v[76:79]
    ds_read_b64_tr_b16 a[154:155], v2 offset:25488
    v_mul_f32 v11, s30, v11
    v_mfma_f32_16x16x32_bf16 v[80:83], v[188:191], a[204:207], v[80:83]
    v_cvt_pk_bf16_f32 v186, v232, v233
    v_cvt_pk_bf16_f32 v187, v234, v235
    v_mfma_f32_16x16x32_bf16 v[80:83], v[192:195], a[200:203], v[80:83]
    ds_read_b64_tr_b16 a[156:157], v2 offset:29136
    ds_read_b64_tr_b16 a[158:159], v2 offset:29648
    v_mfma_f32_16x16x32_bf16 v[112:115], v[200:203], a[200:203], v[112:115]
    v_exp_f32 v224, v224
    v_mfma_f32_16x16x32_bf16 v[112:115], v[196:199], a[204:207], v[112:115]
    s_add_u32 m0, s25, 16640
    ds_read_b128 a[96:99], v1 offset:512
    v_mul_f32 v13, s30, v13
    v_mfma_f32_16x16x32_bf16 v[108:111], v[196:199], a[196:199], v[108:111]
    v_exp_f32 v225, v225
    v_mfma_f32_16x16x32_bf16 v[108:111], v[200:203], a[192:195], v[108:111]
    buffer_load_dwordx4 v4, s[8:11], 0 offen nt lds
    v_mfma_f32_16x16x32_bf16 v[104:107], v[200:203], a[184:187], v[104:107]
    v_exp_f32 v226, v226
    v_mfma_f32_16x16x32_bf16 v[104:107], v[196:199], a[188:191], v[104:107]
    ds_read_b64_tr_b16 a[160:161], v2 offset:24992
    v_cvt_pk_bf16_f32 v13, v11, v13
    v_mfma_f32_16x16x32_bf16 v[100:103], v[196:199], a[180:183], v[100:103]
    v_exp_f32 v227, v227
    v_mfma_f32_16x16x32_bf16 v[100:103], v[200:203], a[176:179], v[100:103]
    ds_read_b128 a[100:103], v1 offset:576
    v_lshlrev_b32 v11, 16, v14
    v_mfma_f32_16x16x32_bf16 v[228:231], a[112:115], a[32:35], v[244:247]
    v_cvt_pk_bf16_f32 v194, v224, v225
    v_cvt_pk_bf16_f32 v195, v226, v227
    v_mfma_f32_16x16x32_bf16 v[228:231], a[116:119], a[36:39], v[228:231]
    v_exp_f32 v220, v220
    v_mfma_f32_16x16x32_bf16 v[228:231], a[120:123], a[40:43], v[228:231]
    v_exp_f32 v221, v221
    v_mfma_f32_16x16x32_bf16 v[228:231], a[124:127], a[44:47], v[228:231]
    ds_read_b64_tr_b16 a[162:163], v2 offset:25504
    v_and_b32 v14, s29, v14
    v_mfma_f32_16x16x32_bf16 v[232:235], a[140:143], a[44:47], v[244:247]
    v_exp_f32 v222, v222
    v_mfma_f32_16x16x32_bf16 v[232:235], a[136:139], a[40:43], v[232:235]
    v_exp_f32 v223, v223
    v_mfma_f32_16x16x32_bf16 v[232:235], a[132:135], a[36:39], v[232:235]
    v_cvt_pk_bf16_f32 v192, v220, v221
    v_cvt_pk_bf16_f32 v193, v222, v223
    v_mfma_f32_16x16x32_bf16 v[232:235], a[128:131], a[32:35], v[232:235]
    ds_read_b64_tr_b16 a[164:165], v2 offset:29152
    ds_read_b64_tr_b16 a[166:167], v2 offset:29664
    v_mfma_f32_16x16x32_bf16 v[224:227], a[128:131], a[48:51], v[248:251]
    v_exp_f32 v228, v228
    v_mfma_f32_16x16x32_bf16 v[224:227], a[132:135], a[52:55], v[224:227]
    s_add_u32 m0, s25, 16656
    v_exp_f32 v229, v229
    v_mfma_f32_16x16x32_bf16 v[224:227], a[136:139], a[56:59], v[224:227]
    v_exp_f32 v230, v230
    v_mfma_f32_16x16x32_bf16 v[224:227], a[140:143], a[60:63], v[224:227]
    buffer_load_dwordx4 v4, s[8:11], 0 offen offset:1024 nt lds
    v_mfma_f32_16x16x32_bf16 v[220:223], a[124:127], a[60:63], v[248:251]
    s_add_u32 s8, s8, 8064
    v_exp_f32 v231, v231
    v_mfma_f32_16x16x32_bf16 v[220:223], a[120:123], a[56:59], v[220:223]
    s_addc_u32 s9, s9, 0
    v_cvt_pk_bf16_f32 v200, v228, v229
    v_cvt_pk_bf16_f32 v201, v230, v231
    v_mfma_f32_16x16x32_bf16 v[220:223], a[116:119], a[52:55], v[220:223]
    s_sub_u32 s21, s21, 8064
    v_exp_f32 v232, v232
    v_mfma_f32_16x16x32_bf16 v[220:223], a[112:115], a[48:51], v[220:223]
    s_max_i32 s10, s21, 0
    ds_read_b128 a[104:107], v1 offset:640
    v_mul_f32 v11, s30, v11
    v_mfma_f32_16x16x32_bf16 v[132:135], v[208:211], a[176:179], v[132:135]
    v_exp_f32 v233, v233
    v_mfma_f32_16x16x32_bf16 v[132:135], v[204:207], a[180:183], v[132:135]
    ds_read_b64_tr_b16 a[168:169], v2 offset:25008
    v_mul_f32 v14, s30, v14
    v_mfma_f32_16x16x32_bf16 v[136:139], v[204:207], a[188:191], v[136:139]
    v_exp_f32 v234, v234
    v_mfma_f32_16x16x32_bf16 v[136:139], v[208:211], a[184:187], v[136:139]
    ds_read_b128 a[108:111], v1 offset:704
    v_cvt_pk_bf16_f32 v14, v11, v14
    v_mfma_f32_16x16x32_bf16 v[140:143], v[208:211], a[192:195], v[140:143]
    v_exp_f32 v235, v235
    v_mfma_f32_16x16x32_bf16 v[140:143], v[204:207], a[196:199], v[140:143]
    ds_read_b64_tr_b16 a[170:171], v2 offset:25520
    v_lshlrev_b32 v11, 16, v15
    v_mfma_f32_16x16x32_bf16 v[144:147], v[204:207], a[204:207], v[144:147]
    v_cvt_pk_bf16_f32 v202, v232, v233
    v_cvt_pk_bf16_f32 v203, v234, v235
    v_mfma_f32_16x16x32_bf16 v[144:147], v[208:211], a[200:203], v[144:147]
    ds_read_b64_tr_b16 a[172:173], v2 offset:29168
    ds_read_b64_tr_b16 a[174:175], v2 offset:29680
    v_exp_f32 v224, v224
    v_and_b32 v15, s29, v15
    v_mul_f32 v11, s30, v11
    v_exp_f32 v225, v225
    v_mul_f32 v15, s30, v15
    v_cvt_pk_bf16_f32 v15, v11, v15
    v_exp_f32 v226, v226
    v_exp_f32 v227, v227
    ds_write_b64 v0, v[12:13] offset:2176
    v_cvt_pk_bf16_f32 v210, v224, v225
    v_cvt_pk_bf16_f32 v211, v226, v227
    v_exp_f32 v220, v220
    s_waitcnt vmcnt(10) lgkmcnt(1)
    v_exp_f32 v221, v221
    s_barrier
    v_exp_f32 v222, v222
    v_exp_f32 v223, v223
    v_cvt_pk_bf16_f32 v208, v220, v221
    v_cvt_pk_bf16_f32 v209, v222, v223
    ds_write_b64 v0, v[14:15] offset:2184
    v_mfma_f32_16x16x32_bf16 v[224:227], a[96:99], a[0:3], v[236:239]
    s_add_u32 s22, s22, 1024
    v_mfma_f32_16x16x32_bf16 v[224:227], a[100:103], a[4:7], v[224:227]
    s_add_u32 m0, s24, 0
    v_mfma_f32_16x16x32_bf16 v[224:227], a[104:107], a[8:11], v[224:227]
    s_add_u32 s23, s23, 1088
    v_mfma_f32_16x16x32_bf16 v[224:227], a[108:111], a[12:15], v[224:227]
    buffer_load_dwordx4 v3, s[4:7], 0 offen nt lds
    v_mfma_f32_16x16x32_bf16 v[220:223], a[92:95], a[12:15], v[236:239]
    v_mfma_f32_16x16x32_bf16 v[220:223], a[88:91], a[8:11], v[220:223]
    v_mfma_f32_16x16x32_bf16 v[220:223], a[84:87], a[4:7], v[220:223]
    v_mfma_f32_16x16x32_bf16 v[220:223], a[80:83], a[0:3], v[220:223]
    ds_read_b128 a[112:115], v1 offset:8448
    v_add_u32 v0, s26, v0
    v_smfmac_f32_16x16x64_bf16 a[208:211], a[228:231], v[180:187], v10
    ds_read_b64_tr_b16 a[176:177], v2 offset:0
    v_smfmac_f32_16x16x64_bf16 a[212:215], a[228:231], v[188:195], v10
    ds_read_b128 a[116:119], v1 offset:8512
    v_mfma_f32_16x16x32_bf16 v[20:23], v[180:183], a[144:147], v[20:23]
    v_mfma_f32_16x16x32_bf16 v[20:23], v[184:187], a[148:151], v[20:23]
    ds_read_b64_tr_b16 a[178:179], v2 offset:512
    v_mfma_f32_16x16x32_bf16 v[24:27], v[184:187], a[156:159], v[24:27]
    v_mfma_f32_16x16x32_bf16 v[24:27], v[180:183], a[152:155], v[24:27]
    ds_read_b64_tr_b16 a[180:181], v2 offset:4160
    v_mfma_f32_16x16x32_bf16 v[28:31], v[180:183], a[160:163], v[28:31]
    v_mfma_f32_16x16x32_bf16 v[28:31], v[184:187], a[164:167], v[28:31]
    ds_read_b64_tr_b16 a[182:183], v2 offset:4672
    v_mfma_f32_16x16x32_bf16 v[32:35], v[184:187], a[172:175], v[32:35]
    v_mfma_f32_16x16x32_bf16 v[32:35], v[180:183], a[168:171], v[32:35]
    ds_read_b128 a[120:123], v1 offset:8576
    v_mfma_f32_16x16x32_bf16 v[64:67], v[188:191], a[168:171], v[64:67]
    v_exp_f32 v224, v224
    v_mfma_f32_16x16x32_bf16 v[64:67], v[192:195], a[172:175], v[64:67]
    s_add_u32 m0, s24, 32
    ds_read_b64_tr_b16 a[184:185], v2 offset:16
    v_mfma_f32_16x16x32_bf16 v[60:63], v[192:195], a[164:167], v[60:63]
    v_exp_f32 v225, v225
    v_mfma_f32_16x16x32_bf16 v[60:63], v[188:191], a[160:163], v[60:63]
    buffer_load_dwordx4 v3, s[4:7], 0 offen offset:1024 nt lds
    v_mfma_f32_16x16x32_bf16 v[56:59], v[188:191], a[152:155], v[56:59]
    s_add_u32 s4, s4, 8192
    v_exp_f32 v226, v226
    v_mfma_f32_16x16x32_bf16 v[56:59], v[192:195], a[156:159], v[56:59]
    s_addc_u32 s5, s5, 0
    ds_read_b128 a[124:127], v1 offset:8640
    v_mfma_f32_16x16x32_bf16 v[52:55], v[192:195], a[148:151], v[52:55]
    s_sub_u32 s20, s20, 8192
    v_exp_f32 v227, v227
    v_mfma_f32_16x16x32_bf16 v[52:55], v[188:191], a[144:147], v[52:55]
    s_max_i32 s6, s20, 0
    ds_read_b64_tr_b16 a[186:187], v2 offset:528
    v_mfma_f32_16x16x32_bf16 v[228:231], a[80:83], a[16:19], v[240:243]
    v_cvt_pk_bf16_f32 v182, v224, v225
    v_cvt_pk_bf16_f32 v183, v226, v227
    v_mfma_f32_16x16x32_bf16 v[228:231], a[84:87], a[20:23], v[228:231]
    v_exp_f32 v220, v220
    v_mfma_f32_16x16x32_bf16 v[228:231], a[88:91], a[24:27], v[228:231]
    v_exp_f32 v221, v221
    v_mfma_f32_16x16x32_bf16 v[228:231], a[92:95], a[28:31], v[228:231]
    ds_read_b64_tr_b16 a[188:189], v2 offset:4176
    v_mfma_f32_16x16x32_bf16 v[232:235], a[108:111], a[28:31], v[240:243]
    v_exp_f32 v222, v222
    v_mfma_f32_16x16x32_bf16 v[232:235], a[104:107], a[24:27], v[232:235]
    v_exp_f32 v223, v223
    v_mfma_f32_16x16x32_bf16 v[232:235], a[100:103], a[20:23], v[232:235]
    v_cvt_pk_bf16_f32 v180, v220, v221
    v_cvt_pk_bf16_f32 v181, v222, v223
    v_mfma_f32_16x16x32_bf16 v[232:235], a[96:99], a[16:19], v[232:235]
    ds_read_b64_tr_b16 a[190:191], v2 offset:4688
    v_mfma_f32_16x16x32_bf16 v[224:227], a[96:99], a[32:35], v[244:247]
    v_exp_f32 v228, v228
    v_mfma_f32_16x16x32_bf16 v[224:227], a[100:103], a[36:39], v[224:227]
    s_add_u32 m0, s25, 24960
    v_exp_f32 v229, v229
    v_mfma_f32_16x16x32_bf16 v[224:227], a[104:107], a[40:43], v[224:227]
    v_exp_f32 v230, v230
    v_mfma_f32_16x16x32_bf16 v[224:227], a[108:111], a[44:47], v[224:227]
    buffer_load_dwordx4 v4, s[8:11], 0 offen nt lds
    v_mfma_f32_16x16x32_bf16 v[220:223], a[92:95], a[44:47], v[244:247]
    v_exp_f32 v231, v231
    v_mfma_f32_16x16x32_bf16 v[220:223], a[88:91], a[40:43], v[220:223]
    v_cvt_pk_bf16_f32 v188, v228, v229
    v_cvt_pk_bf16_f32 v189, v230, v231
    v_mfma_f32_16x16x32_bf16 v[220:223], a[84:87], a[36:39], v[220:223]
    v_exp_f32 v232, v232
    v_mfma_f32_16x16x32_bf16 v[220:223], a[80:83], a[32:35], v[220:223]
    ds_read_b128 a[128:131], v1 offset:8960
    v_smfmac_f32_16x16x64_bf16 a[216:219], a[228:231], v[196:203], v10
    ds_read_b64_tr_b16 a[192:193], v2 offset:32
    v_smfmac_f32_16x16x64_bf16 a[220:223], a[228:231], v[204:211], v10
    ds_read_b128 a[132:135], v1 offset:9024
    ds_read_b64_tr_b16 a[194:195], v2 offset:544
    v_mfma_f32_16x16x32_bf16 v[84:87], v[196:199], a[144:147], v[84:87]
    v_exp_f32 v233, v233
    v_mfma_f32_16x16x32_bf16 v[84:87], v[200:203], a[148:151], v[84:87]
    ds_read_b64_tr_b16 a[196:197], v2 offset:4192
    v_mfma_f32_16x16x32_bf16 v[88:91], v[200:203], a[156:159], v[88:91]
    v_exp_f32 v234, v234
    v_mfma_f32_16x16x32_bf16 v[88:91], v[196:199], a[152:155], v[88:91]
    ds_read_b64_tr_b16 a[198:199], v2 offset:4704
    v_mfma_f32_16x16x32_bf16 v[92:95], v[196:199], a[160:163], v[92:95]
    v_exp_f32 v235, v235
    v_mfma_f32_16x16x32_bf16 v[92:95], v[200:203], a[164:167], v[92:95]
    ds_read_b128 a[136:139], v1 offset:9088
    v_mfma_f32_16x16x32_bf16 v[96:99], v[200:203], a[172:175], v[96:99]
    v_cvt_pk_bf16_f32 v190, v232, v233
    v_cvt_pk_bf16_f32 v191, v234, v235
    v_mfma_f32_16x16x32_bf16 v[96:99], v[196:199], a[168:171], v[96:99]
    ds_read_b64_tr_b16 a[200:201], v2 offset:48
    v_mfma_f32_16x16x32_bf16 v[128:131], v[204:207], a[168:171], v[128:131]
    v_exp_f32 v224, v224
    v_mfma_f32_16x16x32_bf16 v[128:131], v[208:211], a[172:175], v[128:131]
    s_add_u32 m0, s25, 24976
    ds_read_b128 a[140:143], v1 offset:9152
    v_mfma_f32_16x16x32_bf16 v[124:127], v[208:211], a[164:167], v[124:127]
    v_exp_f32 v225, v225
    v_mfma_f32_16x16x32_bf16 v[124:127], v[204:207], a[160:163], v[124:127]
    buffer_load_dwordx4 v4, s[8:11], 0 offen offset:1024 nt lds
    v_mfma_f32_16x16x32_bf16 v[120:123], v[204:207], a[152:155], v[120:123]
    s_add_u32 s8, s8, 8320
    v_exp_f32 v226, v226
    v_mfma_f32_16x16x32_bf16 v[120:123], v[208:211], a[156:159], v[120:123]
    s_addc_u32 s9, s9, 0
    ds_read_b64_tr_b16 a[202:203], v2 offset:560
    v_mfma_f32_16x16x32_bf16 v[116:119], v[208:211], a[148:151], v[116:119]
    s_sub_u32 s21, s21, 8320
    v_exp_f32 v227, v227
    v_mfma_f32_16x16x32_bf16 v[116:119], v[204:207], a[144:147], v[116:119]
    s_max_i32 s10, s21, 0
    ds_read_b64_tr_b16 a[204:205], v2 offset:4208
    v_mfma_f32_16x16x32_bf16 v[228:231], a[80:83], a[48:51], v[248:251]
    v_cvt_pk_bf16_f32 v198, v224, v225
    v_cvt_pk_bf16_f32 v199, v226, v227
    v_mfma_f32_16x16x32_bf16 v[228:231], a[84:87], a[52:55], v[228:231]
    v_exp_f32 v220, v220
    v_mfma_f32_16x16x32_bf16 v[228:231], a[88:91], a[56:59], v[228:231]
    v_exp_f32 v221, v221
    v_mfma_f32_16x16x32_bf16 v[228:231], a[92:95], a[60:63], v[228:231]
    ds_read_b64_tr_b16 a[206:207], v2 offset:4720
    v_mfma_f32_16x16x32_bf16 v[232:235], a[108:111], a[60:63], v[248:251]
    v_exp_f32 v222, v222
    v_mfma_f32_16x16x32_bf16 v[232:235], a[104:107], a[56:59], v[232:235]
    v_exp_f32 v223, v223
    v_mfma_f32_16x16x32_bf16 v[232:235], a[100:103], a[52:55], v[232:235]
    v_cvt_pk_bf16_f32 v196, v220, v221
    v_cvt_pk_bf16_f32 v197, v222, v223
    v_mfma_f32_16x16x32_bf16 v[232:235], a[96:99], a[48:51], v[232:235]
    v_exp_f32 v228, v228
    s_min_u32 m0, s23, s48
    v_exp_f32 v229, v229
    v_exp_f32 v230, v230
    buffer_load_dwordx4 v3, s[12:15], s22 offen nt lds
    v_exp_f32 v231, v231
    v_cvt_pk_bf16_f32 v204, v228, v229
    v_cvt_pk_bf16_f32 v205, v230, v231
    v_exp_f32 v232, v232
    ds_read_b128 v[12:15], v0 offset:0
    v_exp_f32 v233, v233
    v_exp_f32 v234, v234
    s_waitcnt vmcnt(10) lgkmcnt(0)
    v_exp_f32 v235, v235
    s_barrier
    v_cvt_pk_bf16_f32 v206, v232, v233
    v_cvt_pk_bf16_f32 v207, v234, v235
    v_mfma_f32_16x16x32_bf16 v[48:51], v[184:187], a[200:203], v[48:51]
    s_add_u32 s22, s22, 1024
    v_mfma_f32_16x16x32_bf16 v[48:51], v[180:183], a[204:207], v[48:51]
    s_add_u32 m0, s24, 8448
    ds_read_b128 a[80:83], v1 offset:16896
    v_lshlrev_b32 v11, 16, v12
    v_mfma_f32_16x16x32_bf16 v[44:47], v[180:183], a[196:199], v[44:47]
    s_add_u32 s23, s23, 1088
    v_mfma_f32_16x16x32_bf16 v[44:47], v[184:187], a[192:195], v[44:47]
    buffer_load_dwordx4 v3, s[4:7], 0 offen nt lds
    v_mfma_f32_16x16x32_bf16 v[40:43], v[184:187], a[184:187], v[40:43]
    s_movk_i32 s26, 3264
    v_mfma_f32_16x16x32_bf16 v[40:43], v[180:183], a[188:191], v[40:43]
    ds_read_b64_tr_b16 a[144:145], v2 offset:8320
    v_and_b32 v12, s29, v12
    v_mfma_f32_16x16x32_bf16 v[36:39], v[180:183], a[180:183], v[36:39]
    v_mfma_f32_16x16x32_bf16 v[36:39], v[184:187], a[176:179], v[36:39]
    ds_read_b128 a[84:87], v1 offset:16960
    v_mul_f32 v11, s30, v11
    v_mfma_f32_16x16x32_bf16 v[228:231], a[112:115], a[0:3], v[236:239]
    v_mfma_f32_16x16x32_bf16 v[228:231], a[116:119], a[4:7], v[228:231]
    v_mfma_f32_16x16x32_bf16 v[228:231], a[120:123], a[8:11], v[228:231]
    v_mfma_f32_16x16x32_bf16 v[228:231], a[124:127], a[12:15], v[228:231]
    ds_read_b64_tr_b16 a[146:147], v2 offset:8832
    v_mul_f32 v12, s30, v12
    v_mfma_f32_16x16x32_bf16 v[232:235], a[140:143], a[12:15], v[236:239]
    v_mfma_f32_16x16x32_bf16 v[232:235], a[136:139], a[8:11], v[232:235]
    v_mfma_f32_16x16x32_bf16 v[232:235], a[132:135], a[4:7], v[232:235]
    v_mfma_f32_16x16x32_bf16 v[232:235], a[128:131], a[0:3], v[232:235]
    ds_read_b64_tr_b16 a[148:149], v2 offset:12480
    ds_read_b64_tr_b16 a[150:151], v2 offset:12992
    v_mfma_f32_16x16x32_bf16 v[224:227], a[128:131], a[16:19], v[240:243]
    v_exp_f32 v228, v228
    v_mfma_f32_16x16x32_bf16 v[224:227], a[132:135], a[20:23], v[224:227]
    s_add_u32 m0, s24, 8480
    v_exp_f32 v229, v229
    v_mfma_f32_16x16x32_bf16 v[224:227], a[136:139], a[24:27], v[224:227]
    v_exp_f32 v230, v230
    v_mfma_f32_16x16x32_bf16 v[224:227], a[140:143], a[28:31], v[224:227]
    buffer_load_dwordx4 v3, s[4:7], 0 offen offset:1024 nt lds
    v_mfma_f32_16x16x32_bf16 v[220:223], a[124:127], a[28:31], v[240:243]
    s_add_u32 s4, s4, 8192
    v_exp_f32 v231, v231
    v_mfma_f32_16x16x32_bf16 v[220:223], a[120:123], a[24:27], v[220:223]
    s_addc_u32 s5, s5, 0
    v_cvt_pk_bf16_f32 v184, v228, v229
    v_cvt_pk_bf16_f32 v185, v230, v231
    v_mfma_f32_16x16x32_bf16 v[220:223], a[116:119], a[20:23], v[220:223]
    s_sub_u32 s20, s20, 8192
    v_exp_f32 v232, v232
    v_mfma_f32_16x16x32_bf16 v[220:223], a[112:115], a[16:19], v[220:223]
    s_max_i32 s6, s20, 0
    ds_read_b128 a[88:91], v1 offset:17024
    v_cvt_pk_bf16_f32 v12, v11, v12
    v_mfma_f32_16x16x32_bf16 v[68:71], v[192:195], a[176:179], v[68:71]
    v_exp_f32 v233, v233
    v_mfma_f32_16x16x32_bf16 v[68:71], v[188:191], a[180:183], v[68:71]
    ds_read_b64_tr_b16 a[152:153], v2 offset:8336
    v_lshlrev_b32 v11, 16, v13
    v_mfma_f32_16x16x32_bf16 v[72:75], v[188:191], a[188:191], v[72:75]
    v_exp_f32 v234, v234
    v_mfma_f32_16x16x32_bf16 v[72:75], v[192:195], a[184:187], v[72:75]
    ds_read_b128 a[92:95], v1 offset:17088
    v_and_b32 v13, s29, v13
    v_mfma_f32_16x16x32_bf16 v[76:79], v[192:195], a[192:195], v[76:79]
    v_exp_f32 v235, v235
    v_mfma_f32_16x16x32_bf16 v[76:79], v[188:191], a[196:199], v[76:79]
    ds_read_b64_tr_b16 a[154:155], v2 offset:8848
    v_mul_f32 v11, s30, v11
    v_mfma_f32_16x16x32_bf16 v[80:83], v[188:191], a[204:207], v[80:83]
    v_cvt_pk_bf16_f32 v186, v232, v233
    v_cvt_pk_bf16_f32 v187, v234, v235
    v_mfma_f32_16x16x32_bf16 v[80:83], v[192:195], a[200:203], v[80:83]
    ds_read_b64_tr_b16 a[156:157], v2 offset:12496
    ds_read_b64_tr_b16 a[158:159], v2 offset:13008
    v_mfma_f32_16x16x32_bf16 v[112:115], v[200:203], a[200:203], v[112:115]
    v_exp_f32 v224, v224
    v_mfma_f32_16x16x32_bf16 v[112:115], v[196:199], a[204:207], v[112:115]
    s_add_u32 m0, s25, 0
    ds_read_b128 a[96:99], v1 offset:17408
    v_mul_f32 v13, s30, v13
    v_mfma_f32_16x16x32_bf16 v[108:111], v[196:199], a[196:199], v[108:111]
    v_exp_f32 v225, v225
    v_mfma_f32_16x16x32_bf16 v[108:111], v[200:203], a[192:195], v[108:111]
    buffer_load_dwordx4 v4, s[8:11], 0 offen nt lds
    v_mfma_f32_16x16x32_bf16 v[104:107], v[200:203], a[184:187], v[104:107]
    v_exp_f32 v226, v226
    v_mfma_f32_16x16x32_bf16 v[104:107], v[196:199], a[188:191], v[104:107]
    ds_read_b64_tr_b16 a[160:161], v2 offset:8352
    v_cvt_pk_bf16_f32 v13, v11, v13
    v_mfma_f32_16x16x32_bf16 v[100:103], v[196:199], a[180:183], v[100:103]
    v_exp_f32 v227, v227
    v_mfma_f32_16x16x32_bf16 v[100:103], v[200:203], a[176:179], v[100:103]
    ds_read_b128 a[100:103], v1 offset:17472
    v_lshlrev_b32 v11, 16, v14
    v_mfma_f32_16x16x32_bf16 v[228:231], a[112:115], a[32:35], v[244:247]
    v_cvt_pk_bf16_f32 v194, v224, v225
    v_cvt_pk_bf16_f32 v195, v226, v227
    v_mfma_f32_16x16x32_bf16 v[228:231], a[116:119], a[36:39], v[228:231]
    v_exp_f32 v220, v220
    v_mfma_f32_16x16x32_bf16 v[228:231], a[120:123], a[40:43], v[228:231]
    v_exp_f32 v221, v221
    v_mfma_f32_16x16x32_bf16 v[228:231], a[124:127], a[44:47], v[228:231]
    ds_read_b64_tr_b16 a[162:163], v2 offset:8864
    v_and_b32 v14, s29, v14
    v_mfma_f32_16x16x32_bf16 v[232:235], a[140:143], a[44:47], v[244:247]
    v_exp_f32 v222, v222
    v_mfma_f32_16x16x32_bf16 v[232:235], a[136:139], a[40:43], v[232:235]
    v_exp_f32 v223, v223
    v_mfma_f32_16x16x32_bf16 v[232:235], a[132:135], a[36:39], v[232:235]
    v_cvt_pk_bf16_f32 v192, v220, v221
    v_cvt_pk_bf16_f32 v193, v222, v223
    v_mfma_f32_16x16x32_bf16 v[232:235], a[128:131], a[32:35], v[232:235]
    ds_read_b64_tr_b16 a[164:165], v2 offset:12512
    ds_read_b64_tr_b16 a[166:167], v2 offset:13024
    v_mfma_f32_16x16x32_bf16 v[224:227], a[128:131], a[48:51], v[248:251]
    v_exp_f32 v228, v228
    v_mfma_f32_16x16x32_bf16 v[224:227], a[132:135], a[52:55], v[224:227]
    s_add_u32 m0, s25, 16
    v_exp_f32 v229, v229
    v_mfma_f32_16x16x32_bf16 v[224:227], a[136:139], a[56:59], v[224:227]
    v_exp_f32 v230, v230
    v_mfma_f32_16x16x32_bf16 v[224:227], a[140:143], a[60:63], v[224:227]
    buffer_load_dwordx4 v4, s[8:11], 0 offen offset:1024 nt lds
    v_mfma_f32_16x16x32_bf16 v[220:223], a[124:127], a[60:63], v[248:251]
    s_add_u32 s8, s8, 8064
    v_exp_f32 v231, v231
    v_mfma_f32_16x16x32_bf16 v[220:223], a[120:123], a[56:59], v[220:223]
    s_addc_u32 s9, s9, 0
    v_cvt_pk_bf16_f32 v200, v228, v229
    v_cvt_pk_bf16_f32 v201, v230, v231
    v_mfma_f32_16x16x32_bf16 v[220:223], a[116:119], a[52:55], v[220:223]
    s_sub_u32 s21, s21, 8064
    v_exp_f32 v232, v232
    v_mfma_f32_16x16x32_bf16 v[220:223], a[112:115], a[48:51], v[220:223]
    s_max_i32 s10, s21, 0
    ds_read_b128 a[104:107], v1 offset:17536
    v_mul_f32 v11, s30, v11
    v_mfma_f32_16x16x32_bf16 v[132:135], v[208:211], a[176:179], v[132:135]
    v_exp_f32 v233, v233
    v_mfma_f32_16x16x32_bf16 v[132:135], v[204:207], a[180:183], v[132:135]
    ds_read_b64_tr_b16 a[168:169], v2 offset:8368
    v_mul_f32 v14, s30, v14
    v_mfma_f32_16x16x32_bf16 v[136:139], v[204:207], a[188:191], v[136:139]
    v_exp_f32 v234, v234
    v_mfma_f32_16x16x32_bf16 v[136:139], v[208:211], a[184:187], v[136:139]
    ds_read_b128 a[108:111], v1 offset:17600
    v_cvt_pk_bf16_f32 v14, v11, v14
    v_mfma_f32_16x16x32_bf16 v[140:143], v[208:211], a[192:195], v[140:143]
    v_exp_f32 v235, v235
    v_mfma_f32_16x16x32_bf16 v[140:143], v[204:207], a[196:199], v[140:143]
    ds_read_b64_tr_b16 a[170:171], v2 offset:8880
    v_lshlrev_b32 v11, 16, v15
    v_mfma_f32_16x16x32_bf16 v[144:147], v[204:207], a[204:207], v[144:147]
    v_cvt_pk_bf16_f32 v202, v232, v233
    v_cvt_pk_bf16_f32 v203, v234, v235
    v_mfma_f32_16x16x32_bf16 v[144:147], v[208:211], a[200:203], v[144:147]
    ds_read_b64_tr_b16 a[172:173], v2 offset:12528
    ds_read_b64_tr_b16 a[174:175], v2 offset:13040
    v_exp_f32 v224, v224
    s_min_u32 m0, s23, s48
    ds_read_b128 v[16:19], v0 offset:1088
    v_and_b32 v15, s29, v15
    v_exp_f32 v225, v225
    buffer_load_dwordx4 v3, s[12:15], s22 offen nt lds
    v_exp_f32 v226, v226
    v_mul_f32 v11, s30, v11
    v_mul_f32 v15, s30, v15
    v_cvt_pk_bf16_f32 v15, v11, v15
    v_exp_f32 v227, v227
    ds_write_b64 v0, v[12:13] offset:0
    v_cvt_pk_bf16_f32 v210, v224, v225
    v_cvt_pk_bf16_f32 v211, v226, v227
    v_exp_f32 v220, v220
    s_waitcnt vmcnt(10) lgkmcnt(1)
    v_exp_f32 v221, v221
    s_barrier
    v_exp_f32 v222, v222
    v_exp_f32 v223, v223
    v_cvt_pk_bf16_f32 v208, v220, v221
    v_cvt_pk_bf16_f32 v209, v222, v223
    ds_write_b64 v0, v[14:15] offset:8
    v_mfma_f32_16x16x32_bf16 v[224:227], a[96:99], a[0:3], v[236:239]
    s_add_u32 s22, s22, 1024
    v_mfma_f32_16x16x32_bf16 v[224:227], a[100:103], a[4:7], v[224:227]
    s_add_u32 m0, s24, 16896
    v_mfma_f32_16x16x32_bf16 v[224:227], a[104:107], a[8:11], v[224:227]
    s_add_u32 s23, s23, 1088
    v_mfma_f32_16x16x32_bf16 v[224:227], a[108:111], a[12:15], v[224:227]
    buffer_load_dwordx4 v3, s[4:7], 0 offen nt lds
    v_mfma_f32_16x16x32_bf16 v[220:223], a[92:95], a[12:15], v[236:239]
    v_mfma_f32_16x16x32_bf16 v[220:223], a[88:91], a[8:11], v[220:223]
    v_mfma_f32_16x16x32_bf16 v[220:223], a[84:87], a[4:7], v[220:223]
    v_mfma_f32_16x16x32_bf16 v[220:223], a[80:83], a[0:3], v[220:223]
    ds_read_b128 a[112:115], v1 offset:25344
    v_lshlrev_b32 v11, 16, v16
    v_smfmac_f32_16x16x64_bf16 a[208:211], a[228:231], v[180:187], v10
    ds_read_b64_tr_b16 a[176:177], v2 offset:16640
    v_and_b32 v16, s29, v16
    v_smfmac_f32_16x16x64_bf16 a[212:215], a[228:231], v[188:195], v10
    ds_read_b128 a[116:119], v1 offset:25408
    v_mul_f32 v11, s30, v11
    v_mfma_f32_16x16x32_bf16 v[20:23], v[180:183], a[144:147], v[20:23]
    v_mfma_f32_16x16x32_bf16 v[20:23], v[184:187], a[148:151], v[20:23]
    ds_read_b64_tr_b16 a[178:179], v2 offset:17152
    v_mul_f32 v16, s30, v16
    v_mfma_f32_16x16x32_bf16 v[24:27], v[184:187], a[156:159], v[24:27]
    v_mfma_f32_16x16x32_bf16 v[24:27], v[180:183], a[152:155], v[24:27]
    ds_read_b64_tr_b16 a[180:181], v2 offset:20800
    v_cvt_pk_bf16_f32 v16, v11, v16
    v_mfma_f32_16x16x32_bf16 v[28:31], v[180:183], a[160:163], v[28:31]
    v_mfma_f32_16x16x32_bf16 v[28:31], v[184:187], a[164:167], v[28:31]
    ds_read_b64_tr_b16 a[182:183], v2 offset:21312
    v_lshlrev_b32 v11, 16, v17
    v_mfma_f32_16x16x32_bf16 v[32:35], v[184:187], a[172:175], v[32:35]
    v_mfma_f32_16x16x32_bf16 v[32:35], v[180:183], a[168:171], v[32:35]
    ds_read_b128 a[120:123], v1 offset:25472
    v_and_b32 v17, s29, v17
    v_mfma_f32_16x16x32_bf16 v[64:67], v[188:191], a[168:171], v[64:67]
    v_exp_f32 v224, v224
    v_mfma_f32_16x16x32_bf16 v[64:67], v[192:195], a[172:175], v[64:67]
    s_add_u32 m0, s24, 16928
    ds_read_b64_tr_b16 a[184:185], v2 offset:16656
    v_mul_f32 v11, s30, v11
    v_mfma_f32_16x16x32_bf16 v[60:63], v[192:195], a[164:167], v[60:63]
    v_exp_f32 v225, v225
    v_mfma_f32_16x16x32_bf16 v[60:63], v[188:191], a[160:163], v[60:63]
    buffer_load_dwordx4 v3, s[4:7], 0 offen offset:1024 nt lds
    v_mfma_f32_16x16x32_bf16 v[56:59], v[188:191], a[152:155], v[56:59]
    s_add_u32 s4, s4, 8192
    v_exp_f32 v226, v226
    v_mfma_f32_16x16x32_bf16 v[56:59], v[192:195], a[156:159], v[56:59]
    s_addc_u32 s5, s5, 0
    ds_read_b128 a[124:127], v1 offset:25536
    v_mul_f32 v17, s30, v17
    v_mfma_f32_16x16x32_bf16 v[52:55], v[192:195], a[148:151], v[52:55]
    s_sub_u32 s20, s20, 8192
    v_exp_f32 v227, v227
    v_mfma_f32_16x16x32_bf16 v[52:55], v[188:191], a[144:147], v[52:55]
    s_max_i32 s6, s20, 0
    ds_read_b64_tr_b16 a[186:187], v2 offset:17168
    v_cvt_pk_bf16_f32 v17, v11, v17
    v_mfma_f32_16x16x32_bf16 v[228:231], a[80:83], a[16:19], v[240:243]
    v_cvt_pk_bf16_f32 v182, v224, v225
    v_cvt_pk_bf16_f32 v183, v226, v227
    v_mfma_f32_16x16x32_bf16 v[228:231], a[84:87], a[20:23], v[228:231]
    v_exp_f32 v220, v220
    v_mfma_f32_16x16x32_bf16 v[228:231], a[88:91], a[24:27], v[228:231]
    v_exp_f32 v221, v221
    v_mfma_f32_16x16x32_bf16 v[228:231], a[92:95], a[28:31], v[228:231]
    ds_read_b64_tr_b16 a[188:189], v2 offset:20816
    v_lshlrev_b32 v11, 16, v18
    v_mfma_f32_16x16x32_bf16 v[232:235], a[108:111], a[28:31], v[240:243]
    v_exp_f32 v222, v222
    v_mfma_f32_16x16x32_bf16 v[232:235], a[104:107], a[24:27], v[232:235]
    v_exp_f32 v223, v223
    v_mfma_f32_16x16x32_bf16 v[232:235], a[100:103], a[20:23], v[232:235]
    v_cvt_pk_bf16_f32 v180, v220, v221
    v_cvt_pk_bf16_f32 v181, v222, v223
    v_mfma_f32_16x16x32_bf16 v[232:235], a[96:99], a[16:19], v[232:235]
    ds_read_b64_tr_b16 a[190:191], v2 offset:21328
    v_and_b32 v18, s29, v18
    v_mfma_f32_16x16x32_bf16 v[224:227], a[96:99], a[32:35], v[244:247]
    v_exp_f32 v228, v228
    v_mfma_f32_16x16x32_bf16 v[224:227], a[100:103], a[36:39], v[224:227]
    s_add_u32 m0, s25, 8320
    v_exp_f32 v229, v229
    v_mfma_f32_16x16x32_bf16 v[224:227], a[104:107], a[40:43], v[224:227]
    v_exp_f32 v230, v230
    v_mfma_f32_16x16x32_bf16 v[224:227], a[108:111], a[44:47], v[224:227]
    buffer_load_dwordx4 v4, s[8:11], 0 offen nt lds
    v_mfma_f32_16x16x32_bf16 v[220:223], a[92:95], a[44:47], v[244:247]
    v_exp_f32 v231, v231
    v_mfma_f32_16x16x32_bf16 v[220:223], a[88:91], a[40:43], v[220:223]
    v_cvt_pk_bf16_f32 v188, v228, v229
    v_cvt_pk_bf16_f32 v189, v230, v231
    v_mfma_f32_16x16x32_bf16 v[220:223], a[84:87], a[36:39], v[220:223]
    v_exp_f32 v232, v232
    v_mfma_f32_16x16x32_bf16 v[220:223], a[80:83], a[32:35], v[220:223]
    ds_read_b128 a[128:131], v1 offset:25856
    v_mul_f32 v11, s30, v11
    v_smfmac_f32_16x16x64_bf16 a[216:219], a[228:231], v[196:203], v10
    ds_read_b64_tr_b16 a[192:193], v2 offset:16672
    v_mul_f32 v18, s30, v18
    v_smfmac_f32_16x16x64_bf16 a[220:223], a[228:231], v[204:211], v10
    ds_read_b128 a[132:135], v1 offset:25920
    v_cvt_pk_bf16_f32 v18, v11, v18
    ds_read_b64_tr_b16 a[194:195], v2 offset:17184
    v_lshlrev_b32 v11, 16, v19
    v_mfma_f32_16x16x32_bf16 v[84:87], v[196:199], a[144:147], v[84:87]
    v_exp_f32 v233, v233
    v_mfma_f32_16x16x32_bf16 v[84:87], v[200:203], a[148:151], v[84:87]
    ds_read_b64_tr_b16 a[196:197], v2 offset:20832
    v_and_b32 v19, s29, v19
    v_mfma_f32_16x16x32_bf16 v[88:91], v[200:203], a[156:159], v[88:91]
    v_exp_f32 v234, v234
    v_mfma_f32_16x16x32_bf16 v[88:91], v[196:199], a[152:155], v[88:91]
    ds_read_b64_tr_b16 a[198:199], v2 offset:21344
    v_mul_f32 v11, s30, v11
    v_mfma_f32_16x16x32_bf16 v[92:95], v[196:199], a[160:163], v[92:95]
    v_exp_f32 v235, v235
    v_mfma_f32_16x16x32_bf16 v[92:95], v[200:203], a[164:167], v[92:95]
    ds_read_b128 a[136:139], v1 offset:25984
    v_mul_f32 v19, s30, v19
    v_mfma_f32_16x16x32_bf16 v[96:99], v[200:203], a[172:175], v[96:99]
    v_cvt_pk_bf16_f32 v190, v232, v233
    v_cvt_pk_bf16_f32 v191, v234, v235
    v_mfma_f32_16x16x32_bf16 v[96:99], v[196:199], a[168:171], v[96:99]
    ds_read_b64_tr_b16 a[200:201], v2 offset:16688
    v_cvt_pk_bf16_f32 v19, v11, v19
    v_mfma_f32_16x16x32_bf16 v[128:131], v[204:207], a[168:171], v[128:131]
    v_exp_f32 v224, v224
    v_mfma_f32_16x16x32_bf16 v[128:131], v[208:211], a[172:175], v[128:131]
    s_add_u32 m0, s25, 8336
    ds_read_b128 a[140:143], v1 offset:26048
    v_mfma_f32_16x16x32_bf16 v[124:127], v[208:211], a[164:167], v[124:127]
    v_exp_f32 v225, v225
    v_mfma_f32_16x16x32_bf16 v[124:127], v[204:207], a[160:163], v[124:127]
    buffer_load_dwordx4 v4, s[8:11], 0 offen offset:1024 nt lds
    v_mfma_f32_16x16x32_bf16 v[120:123], v[204:207], a[152:155], v[120:123]
    s_add_u32 s8, s8, 8320
    v_exp_f32 v226, v226
    v_mfma_f32_16x16x32_bf16 v[120:123], v[208:211], a[156:159], v[120:123]
    s_addc_u32 s9, s9, 0
    ds_read_b64_tr_b16 a[202:203], v2 offset:17200
    v_mfma_f32_16x16x32_bf16 v[116:119], v[208:211], a[148:151], v[116:119]
    s_sub_u32 s21, s21, 8320
    v_exp_f32 v227, v227
    v_mfma_f32_16x16x32_bf16 v[116:119], v[204:207], a[144:147], v[116:119]
    s_max_i32 s10, s21, 0
    ds_read_b64_tr_b16 a[204:205], v2 offset:20848
    v_mfma_f32_16x16x32_bf16 v[228:231], a[80:83], a[48:51], v[248:251]
    v_cvt_pk_bf16_f32 v198, v224, v225
    v_cvt_pk_bf16_f32 v199, v226, v227
    v_mfma_f32_16x16x32_bf16 v[228:231], a[84:87], a[52:55], v[228:231]
    v_exp_f32 v220, v220
    v_mfma_f32_16x16x32_bf16 v[228:231], a[88:91], a[56:59], v[228:231]
    v_exp_f32 v221, v221
    v_mfma_f32_16x16x32_bf16 v[228:231], a[92:95], a[60:63], v[228:231]
    ds_read_b64_tr_b16 a[206:207], v2 offset:21360
    v_mfma_f32_16x16x32_bf16 v[232:235], a[108:111], a[60:63], v[248:251]
    v_exp_f32 v222, v222
    v_mfma_f32_16x16x32_bf16 v[232:235], a[104:107], a[56:59], v[232:235]
    v_exp_f32 v223, v223
    v_mfma_f32_16x16x32_bf16 v[232:235], a[100:103], a[52:55], v[232:235]
    v_cvt_pk_bf16_f32 v196, v220, v221
    v_cvt_pk_bf16_f32 v197, v222, v223
    v_mfma_f32_16x16x32_bf16 v[232:235], a[96:99], a[48:51], v[232:235]
    s_lshr_b64 vcc, vcc, 1
    v_exp_f32 v228, v228
    s_min_u32 m0, s23, s48
    v_exp_f32 v229, v229
    v_exp_f32 v230, v230
    buffer_load_dwordx4 v3, s[12:15], s22 offen nt lds
    v_exp_f32 v231, v231
    v_cvt_pk_bf16_f32 v204, v228, v229
    v_cvt_pk_bf16_f32 v205, v230, v231
    v_exp_f32 v232, v232
    ds_read_b128 v[12:15], v0 offset:2176
    v_exp_f32 v233, v233
    ds_write_b64 v0, v[16:17] offset:1088
    v_exp_f32 v234, v234
    ds_write_b64 v0, v[18:19] offset:1096
    s_waitcnt vmcnt(11) lgkmcnt(2)
    v_exp_f32 v235, v235
    s_barrier
    v_cvt_pk_bf16_f32 v206, v232, v233
    v_cvt_pk_bf16_f32 v207, v234, v235
    s_cbranch_vccnz L_loop0_1
    s_nop 7
    s_branch L_trans
.p2align 6
L_loop1_1:
    v_mfma_f32_16x16x32_bf16 v[48:51], v[184:187], a[200:203], v[48:51]
    s_add_u32 s32, s32, 3072
    v_mfma_f32_16x16x32_bf16 v[48:51], v[180:183], a[204:207], v[48:51]
    s_add_u32 m0, s24, 25344
    ds_read_b128 a[80:83], v1 offset:0
    v_add_u32 v0, 3264, v0
    v_mfma_f32_16x16x32_bf16 v[44:47], v[180:183], a[196:199], v[44:47]
    v_mfma_f32_16x16x32_bf16 v[44:47], v[184:187], a[192:195], v[44:47]
    buffer_load_dwordx4 v3, s[4:7], 0 offen nt lds
    v_mfma_f32_16x16x32_bf16 v[40:43], v[184:187], a[184:187], v[40:43]
    v_mfma_f32_16x16x32_bf16 v[40:43], v[180:183], a[188:191], v[40:43]
    ds_read_b64_tr_b16 a[144:145], v2 offset:24960
    v_mfma_f32_16x16x32_bf16 v[36:39], v[180:183], a[180:183], v[36:39]
    v_mfma_f32_16x16x32_bf16 v[36:39], v[184:187], a[176:179], v[36:39]
    ds_read_b128 a[84:87], v1 offset:64
    v_mfma_f32_16x16x32_bf16 v[228:231], a[112:115], a[0:3], v[236:239]
    v_mfma_f32_16x16x32_bf16 v[228:231], a[116:119], a[4:7], v[228:231]
    v_mfma_f32_16x16x32_bf16 v[228:231], a[120:123], a[8:11], v[228:231]
    v_mfma_f32_16x16x32_bf16 v[228:231], a[124:127], a[12:15], v[228:231]
    ds_read_b64_tr_b16 a[146:147], v2 offset:25472
    v_mfma_f32_16x16x32_bf16 v[232:235], a[140:143], a[12:15], v[236:239]
    v_mfma_f32_16x16x32_bf16 v[232:235], a[136:139], a[8:11], v[232:235]
    v_mfma_f32_16x16x32_bf16 v[232:235], a[132:135], a[4:7], v[232:235]
    v_mfma_f32_16x16x32_bf16 v[232:235], a[128:131], a[0:3], v[232:235]
    ds_read_b64_tr_b16 a[148:149], v2 offset:29120
    ds_read_b64_tr_b16 a[150:151], v2 offset:29632
    v_mfma_f32_16x16x32_bf16 v[224:227], a[128:131], a[16:19], v[240:243]
    v_exp_f32 v228, v228
    v_mfma_f32_16x16x32_bf16 v[224:227], a[132:135], a[20:23], v[224:227]
    s_add_u32 m0, s24, 25376
    v_exp_f32 v229, v229
    v_mfma_f32_16x16x32_bf16 v[224:227], a[136:139], a[24:27], v[224:227]
    v_exp_f32 v230, v230
    v_mfma_f32_16x16x32_bf16 v[224:227], a[140:143], a[28:31], v[224:227]
    buffer_load_dwordx4 v3, s[4:7], 0 offen offset:1024 nt lds
    v_mfma_f32_16x16x32_bf16 v[220:223], a[124:127], a[28:31], v[240:243]
    s_add_u32 s4, s4, 8192
    v_exp_f32 v231, v231
    v_mfma_f32_16x16x32_bf16 v[220:223], a[120:123], a[24:27], v[220:223]
    s_addc_u32 s5, s5, 0
    v_cvt_pk_bf16_f32 v184, v228, v229
    v_cvt_pk_bf16_f32 v185, v230, v231
    v_mfma_f32_16x16x32_bf16 v[220:223], a[116:119], a[20:23], v[220:223]
    s_sub_u32 s20, s20, 8192
    v_exp_f32 v232, v232
    v_mfma_f32_16x16x32_bf16 v[220:223], a[112:115], a[16:19], v[220:223]
    s_max_i32 s6, s20, 0
    ds_read_b128 a[88:91], v1 offset:128
    v_mfma_f32_16x16x32_bf16 v[68:71], v[192:195], a[176:179], v[68:71]
    v_exp_f32 v233, v233
    v_mfma_f32_16x16x32_bf16 v[68:71], v[188:191], a[180:183], v[68:71]
    ds_read_b64_tr_b16 a[152:153], v2 offset:24976
    v_mfma_f32_16x16x32_bf16 v[72:75], v[188:191], a[188:191], v[72:75]
    v_exp_f32 v234, v234
    v_mfma_f32_16x16x32_bf16 v[72:75], v[192:195], a[184:187], v[72:75]
    ds_read_b128 a[92:95], v1 offset:192
    v_mfma_f32_16x16x32_bf16 v[76:79], v[192:195], a[192:195], v[76:79]
    v_exp_f32 v235, v235
    v_mfma_f32_16x16x32_bf16 v[76:79], v[188:191], a[196:199], v[76:79]
    ds_read_b64_tr_b16 a[154:155], v2 offset:25488
    v_mfma_f32_16x16x32_bf16 v[80:83], v[188:191], a[204:207], v[80:83]
    v_cvt_pk_bf16_f32 v186, v232, v233
    v_cvt_pk_bf16_f32 v187, v234, v235
    v_mfma_f32_16x16x32_bf16 v[80:83], v[192:195], a[200:203], v[80:83]
    ds_read_b64_tr_b16 a[156:157], v2 offset:29136
    ds_read_b64_tr_b16 a[158:159], v2 offset:29648
    v_mfma_f32_16x16x32_bf16 v[112:115], v[200:203], a[200:203], v[112:115]
    v_exp_f32 v224, v224
    v_mfma_f32_16x16x32_bf16 v[112:115], v[196:199], a[204:207], v[112:115]
    s_add_u32 m0, s25, 16640
    ds_read_b128 a[96:99], v1 offset:512
    v_mfma_f32_16x16x32_bf16 v[108:111], v[196:199], a[196:199], v[108:111]
    v_exp_f32 v225, v225
    v_mfma_f32_16x16x32_bf16 v[108:111], v[200:203], a[192:195], v[108:111]
    buffer_load_dwordx4 v4, s[8:11], 0 offen nt lds
    v_mfma_f32_16x16x32_bf16 v[104:107], v[200:203], a[184:187], v[104:107]
    v_exp_f32 v226, v226
    v_mfma_f32_16x16x32_bf16 v[104:107], v[196:199], a[188:191], v[104:107]
    ds_read_b64_tr_b16 a[160:161], v2 offset:24992
    v_mfma_f32_16x16x32_bf16 v[100:103], v[196:199], a[180:183], v[100:103]
    v_exp_f32 v227, v227
    v_mfma_f32_16x16x32_bf16 v[100:103], v[200:203], a[176:179], v[100:103]
    ds_read_b128 a[100:103], v1 offset:576
    v_mfma_f32_16x16x32_bf16 v[228:231], a[112:115], a[32:35], v[244:247]
    v_cvt_pk_bf16_f32 v194, v224, v225
    v_cvt_pk_bf16_f32 v195, v226, v227
    v_mfma_f32_16x16x32_bf16 v[228:231], a[116:119], a[36:39], v[228:231]
    v_exp_f32 v220, v220
    v_mfma_f32_16x16x32_bf16 v[228:231], a[120:123], a[40:43], v[228:231]
    v_exp_f32 v221, v221
    v_mfma_f32_16x16x32_bf16 v[228:231], a[124:127], a[44:47], v[228:231]
    ds_read_b64_tr_b16 a[162:163], v2 offset:25504
    v_mfma_f32_16x16x32_bf16 v[232:235], a[140:143], a[44:47], v[244:247]
    v_exp_f32 v222, v222
    v_mfma_f32_16x16x32_bf16 v[232:235], a[136:139], a[40:43], v[232:235]
    v_exp_f32 v223, v223
    v_mfma_f32_16x16x32_bf16 v[232:235], a[132:135], a[36:39], v[232:235]
    v_cvt_pk_bf16_f32 v192, v220, v221
    v_cvt_pk_bf16_f32 v193, v222, v223
    v_mfma_f32_16x16x32_bf16 v[232:235], a[128:131], a[32:35], v[232:235]
    ds_read_b64_tr_b16 a[164:165], v2 offset:29152
    ds_read_b64_tr_b16 a[166:167], v2 offset:29664
    v_mfma_f32_16x16x32_bf16 v[224:227], a[128:131], a[48:51], v[248:251]
    v_exp_f32 v228, v228
    v_mfma_f32_16x16x32_bf16 v[224:227], a[132:135], a[52:55], v[224:227]
    s_add_u32 m0, s25, 16656
    v_exp_f32 v229, v229
    v_mfma_f32_16x16x32_bf16 v[224:227], a[136:139], a[56:59], v[224:227]
    v_exp_f32 v230, v230
    v_mfma_f32_16x16x32_bf16 v[224:227], a[140:143], a[60:63], v[224:227]
    buffer_load_dwordx4 v4, s[8:11], 0 offen offset:1024 nt lds
    v_mfma_f32_16x16x32_bf16 v[220:223], a[124:127], a[60:63], v[248:251]
    s_add_u32 s8, s8, 8064
    v_exp_f32 v231, v231
    v_mfma_f32_16x16x32_bf16 v[220:223], a[120:123], a[56:59], v[220:223]
    s_addc_u32 s9, s9, 0
    v_cvt_pk_bf16_f32 v200, v228, v229
    v_cvt_pk_bf16_f32 v201, v230, v231
    v_mfma_f32_16x16x32_bf16 v[220:223], a[116:119], a[52:55], v[220:223]
    s_sub_u32 s21, s21, 8064
    v_exp_f32 v232, v232
    v_mfma_f32_16x16x32_bf16 v[220:223], a[112:115], a[48:51], v[220:223]
    s_max_i32 s10, s21, 0
    ds_read_b128 a[104:107], v1 offset:640
    v_mfma_f32_16x16x32_bf16 v[132:135], v[208:211], a[176:179], v[132:135]
    v_exp_f32 v233, v233
    v_mfma_f32_16x16x32_bf16 v[132:135], v[204:207], a[180:183], v[132:135]
    ds_read_b64_tr_b16 a[168:169], v2 offset:25008
    v_mfma_f32_16x16x32_bf16 v[136:139], v[204:207], a[188:191], v[136:139]
    v_exp_f32 v234, v234
    v_mfma_f32_16x16x32_bf16 v[136:139], v[208:211], a[184:187], v[136:139]
    ds_read_b128 a[108:111], v1 offset:704
    v_mfma_f32_16x16x32_bf16 v[140:143], v[208:211], a[192:195], v[140:143]
    v_exp_f32 v235, v235
    v_mfma_f32_16x16x32_bf16 v[140:143], v[204:207], a[196:199], v[140:143]
    ds_read_b64_tr_b16 a[170:171], v2 offset:25520
    v_mfma_f32_16x16x32_bf16 v[144:147], v[204:207], a[204:207], v[144:147]
    v_cvt_pk_bf16_f32 v202, v232, v233
    v_cvt_pk_bf16_f32 v203, v234, v235
    v_mfma_f32_16x16x32_bf16 v[144:147], v[208:211], a[200:203], v[144:147]
    ds_read_b64_tr_b16 a[172:173], v2 offset:29168
    ds_read_b64_tr_b16 a[174:175], v2 offset:29680
    v_exp_f32 v224, v224
    v_exp_f32 v225, v225
    buffer_store_dwordx4 a[236:239], v3, s[16:19], s32 offen offset:0 sc1 nt
    v_exp_f32 v226, v226
    v_exp_f32 v227, v227
    buffer_store_dwordx4 a[240:243], v3, s[16:19], s32 offen offset:1024 sc1 nt
    v_cvt_pk_bf16_f32 v210, v224, v225
    v_cvt_pk_bf16_f32 v211, v226, v227
    v_exp_f32 v220, v220
    s_waitcnt vmcnt(10) lgkmcnt(0)
    v_exp_f32 v221, v221
    buffer_store_dwordx4 a[244:247], v3, s[16:19], s32 offen offset:2048 sc1 nt
    s_barrier
    v_exp_f32 v222, v222
    v_exp_f32 v223, v223
    v_cvt_pk_bf16_f32 v208, v220, v221
    v_cvt_pk_bf16_f32 v209, v222, v223
    v_mfma_f32_16x16x32_bf16 v[224:227], a[96:99], a[0:3], v[236:239]
    v_mfma_f32_16x16x32_bf16 v[224:227], a[100:103], a[4:7], v[224:227]
    s_add_u32 m0, s24, 0
    v_mfma_f32_16x16x32_bf16 v[224:227], a[104:107], a[8:11], v[224:227]
    v_mfma_f32_16x16x32_bf16 v[224:227], a[108:111], a[12:15], v[224:227]
    buffer_load_dwordx4 v3, s[4:7], 0 offen nt lds
    v_mfma_f32_16x16x32_bf16 v[220:223], a[92:95], a[12:15], v[236:239]
    v_mfma_f32_16x16x32_bf16 v[220:223], a[88:91], a[8:11], v[220:223]
    v_mfma_f32_16x16x32_bf16 v[220:223], a[84:87], a[4:7], v[220:223]
    v_mfma_f32_16x16x32_bf16 v[220:223], a[80:83], a[0:3], v[220:223]
    ds_read_b128 a[112:115], v1 offset:8448
    v_smfmac_f32_16x16x64_bf16 a[208:211], a[228:231], v[180:187], v10
    ds_read_b64_tr_b16 a[176:177], v2 offset:0
    v_smfmac_f32_16x16x64_bf16 a[212:215], a[228:231], v[188:195], v10
    ds_read_b128 a[116:119], v1 offset:8512
    v_mfma_f32_16x16x32_bf16 v[20:23], v[180:183], a[144:147], v[20:23]
    v_mfma_f32_16x16x32_bf16 v[20:23], v[184:187], a[148:151], v[20:23]
    ds_read_b64_tr_b16 a[178:179], v2 offset:512
    v_mfma_f32_16x16x32_bf16 v[24:27], v[184:187], a[156:159], v[24:27]
    v_mfma_f32_16x16x32_bf16 v[24:27], v[180:183], a[152:155], v[24:27]
    ds_read_b64_tr_b16 a[180:181], v2 offset:4160
    v_mfma_f32_16x16x32_bf16 v[28:31], v[180:183], a[160:163], v[28:31]
    v_mfma_f32_16x16x32_bf16 v[28:31], v[184:187], a[164:167], v[28:31]
    ds_read_b64_tr_b16 a[182:183], v2 offset:4672
    v_mfma_f32_16x16x32_bf16 v[32:35], v[184:187], a[172:175], v[32:35]
    v_mfma_f32_16x16x32_bf16 v[32:35], v[180:183], a[168:171], v[32:35]
    ds_read_b128 a[120:123], v1 offset:8576
    v_mfma_f32_16x16x32_bf16 v[64:67], v[188:191], a[168:171], v[64:67]
    v_exp_f32 v224, v224
    v_mfma_f32_16x16x32_bf16 v[64:67], v[192:195], a[172:175], v[64:67]
    s_add_u32 m0, s24, 32
    ds_read_b64_tr_b16 a[184:185], v2 offset:16
    v_mfma_f32_16x16x32_bf16 v[60:63], v[192:195], a[164:167], v[60:63]
    v_exp_f32 v225, v225
    v_mfma_f32_16x16x32_bf16 v[60:63], v[188:191], a[160:163], v[60:63]
    buffer_load_dwordx4 v3, s[4:7], 0 offen offset:1024 nt lds
    v_mfma_f32_16x16x32_bf16 v[56:59], v[188:191], a[152:155], v[56:59]
    s_add_u32 s4, s4, 8192
    v_exp_f32 v226, v226
    v_mfma_f32_16x16x32_bf16 v[56:59], v[192:195], a[156:159], v[56:59]
    s_addc_u32 s5, s5, 0
    ds_read_b128 a[124:127], v1 offset:8640
    v_mfma_f32_16x16x32_bf16 v[52:55], v[192:195], a[148:151], v[52:55]
    s_sub_u32 s20, s20, 8192
    v_exp_f32 v227, v227
    v_mfma_f32_16x16x32_bf16 v[52:55], v[188:191], a[144:147], v[52:55]
    s_max_i32 s6, s20, 0
    ds_read_b64_tr_b16 a[186:187], v2 offset:528
    v_mfma_f32_16x16x32_bf16 v[228:231], a[80:83], a[16:19], v[240:243]
    v_cvt_pk_bf16_f32 v182, v224, v225
    v_cvt_pk_bf16_f32 v183, v226, v227
    v_mfma_f32_16x16x32_bf16 v[228:231], a[84:87], a[20:23], v[228:231]
    v_exp_f32 v220, v220
    v_mfma_f32_16x16x32_bf16 v[228:231], a[88:91], a[24:27], v[228:231]
    v_exp_f32 v221, v221
    v_mfma_f32_16x16x32_bf16 v[228:231], a[92:95], a[28:31], v[228:231]
    ds_read_b64_tr_b16 a[188:189], v2 offset:4176
    v_mfma_f32_16x16x32_bf16 v[232:235], a[108:111], a[28:31], v[240:243]
    v_exp_f32 v222, v222
    v_mfma_f32_16x16x32_bf16 v[232:235], a[104:107], a[24:27], v[232:235]
    v_exp_f32 v223, v223
    v_mfma_f32_16x16x32_bf16 v[232:235], a[100:103], a[20:23], v[232:235]
    v_cvt_pk_bf16_f32 v180, v220, v221
    v_cvt_pk_bf16_f32 v181, v222, v223
    v_mfma_f32_16x16x32_bf16 v[232:235], a[96:99], a[16:19], v[232:235]
    ds_read_b64_tr_b16 a[190:191], v2 offset:4688
    v_mfma_f32_16x16x32_bf16 v[224:227], a[96:99], a[32:35], v[244:247]
    v_exp_f32 v228, v228
    v_mfma_f32_16x16x32_bf16 v[224:227], a[100:103], a[36:39], v[224:227]
    s_add_u32 m0, s25, 24960
    v_exp_f32 v229, v229
    v_mfma_f32_16x16x32_bf16 v[224:227], a[104:107], a[40:43], v[224:227]
    v_exp_f32 v230, v230
    v_mfma_f32_16x16x32_bf16 v[224:227], a[108:111], a[44:47], v[224:227]
    buffer_load_dwordx4 v4, s[8:11], 0 offen nt lds
    v_mfma_f32_16x16x32_bf16 v[220:223], a[92:95], a[44:47], v[244:247]
    v_exp_f32 v231, v231
    v_mfma_f32_16x16x32_bf16 v[220:223], a[88:91], a[40:43], v[220:223]
    v_cvt_pk_bf16_f32 v188, v228, v229
    v_cvt_pk_bf16_f32 v189, v230, v231
    v_mfma_f32_16x16x32_bf16 v[220:223], a[84:87], a[36:39], v[220:223]
    v_exp_f32 v232, v232
    v_mfma_f32_16x16x32_bf16 v[220:223], a[80:83], a[32:35], v[220:223]
    ds_read_b128 a[128:131], v1 offset:8960
    v_smfmac_f32_16x16x64_bf16 a[216:219], a[228:231], v[196:203], v10
    ds_read_b64_tr_b16 a[192:193], v2 offset:32
    v_smfmac_f32_16x16x64_bf16 a[220:223], a[228:231], v[204:211], v10
    ds_read_b128 a[132:135], v1 offset:9024
    ds_read_b64_tr_b16 a[194:195], v2 offset:544
    v_mfma_f32_16x16x32_bf16 v[84:87], v[196:199], a[144:147], v[84:87]
    v_exp_f32 v233, v233
    v_mfma_f32_16x16x32_bf16 v[84:87], v[200:203], a[148:151], v[84:87]
    ds_read_b64_tr_b16 a[196:197], v2 offset:4192
    v_mfma_f32_16x16x32_bf16 v[88:91], v[200:203], a[156:159], v[88:91]
    v_exp_f32 v234, v234
    v_mfma_f32_16x16x32_bf16 v[88:91], v[196:199], a[152:155], v[88:91]
    ds_read_b64_tr_b16 a[198:199], v2 offset:4704
    v_mfma_f32_16x16x32_bf16 v[92:95], v[196:199], a[160:163], v[92:95]
    v_exp_f32 v235, v235
    v_mfma_f32_16x16x32_bf16 v[92:95], v[200:203], a[164:167], v[92:95]
    ds_read_b128 a[136:139], v1 offset:9088
    v_mfma_f32_16x16x32_bf16 v[96:99], v[200:203], a[172:175], v[96:99]
    v_cvt_pk_bf16_f32 v190, v232, v233
    v_cvt_pk_bf16_f32 v191, v234, v235
    v_mfma_f32_16x16x32_bf16 v[96:99], v[196:199], a[168:171], v[96:99]
    ds_read_b64_tr_b16 a[200:201], v2 offset:48
    v_mfma_f32_16x16x32_bf16 v[128:131], v[204:207], a[168:171], v[128:131]
    v_exp_f32 v224, v224
    v_mfma_f32_16x16x32_bf16 v[128:131], v[208:211], a[172:175], v[128:131]
    s_add_u32 m0, s25, 24976
    ds_read_b128 a[140:143], v1 offset:9152
    v_mfma_f32_16x16x32_bf16 v[124:127], v[208:211], a[164:167], v[124:127]
    v_exp_f32 v225, v225
    v_mfma_f32_16x16x32_bf16 v[124:127], v[204:207], a[160:163], v[124:127]
    buffer_load_dwordx4 v4, s[8:11], 0 offen offset:1024 nt lds
    v_mfma_f32_16x16x32_bf16 v[120:123], v[204:207], a[152:155], v[120:123]
    s_add_u32 s8, s8, 8320
    v_exp_f32 v226, v226
    v_mfma_f32_16x16x32_bf16 v[120:123], v[208:211], a[156:159], v[120:123]
    s_addc_u32 s9, s9, 0
    ds_read_b64_tr_b16 a[202:203], v2 offset:560
    v_mfma_f32_16x16x32_bf16 v[116:119], v[208:211], a[148:151], v[116:119]
    s_sub_u32 s21, s21, 8320
    v_exp_f32 v227, v227
    v_mfma_f32_16x16x32_bf16 v[116:119], v[204:207], a[144:147], v[116:119]
    s_max_i32 s10, s21, 0
    ds_read_b64_tr_b16 a[204:205], v2 offset:4208
    v_mfma_f32_16x16x32_bf16 v[228:231], a[80:83], a[48:51], v[248:251]
    v_cvt_pk_bf16_f32 v198, v224, v225
    v_cvt_pk_bf16_f32 v199, v226, v227
    v_mfma_f32_16x16x32_bf16 v[228:231], a[84:87], a[52:55], v[228:231]
    v_exp_f32 v220, v220
    v_mfma_f32_16x16x32_bf16 v[228:231], a[88:91], a[56:59], v[228:231]
    v_exp_f32 v221, v221
    v_mfma_f32_16x16x32_bf16 v[228:231], a[92:95], a[60:63], v[228:231]
    ds_read_b64_tr_b16 a[206:207], v2 offset:4720
    v_mfma_f32_16x16x32_bf16 v[232:235], a[108:111], a[60:63], v[248:251]
    v_exp_f32 v222, v222
    v_mfma_f32_16x16x32_bf16 v[232:235], a[104:107], a[56:59], v[232:235]
    v_exp_f32 v223, v223
    v_mfma_f32_16x16x32_bf16 v[232:235], a[100:103], a[52:55], v[232:235]
    v_cvt_pk_bf16_f32 v196, v220, v221
    v_cvt_pk_bf16_f32 v197, v222, v223
    v_mfma_f32_16x16x32_bf16 v[232:235], a[96:99], a[48:51], v[232:235]
    v_exp_f32 v228, v228
    v_exp_f32 v229, v229
    v_exp_f32 v230, v230
    v_exp_f32 v231, v231
    v_cvt_pk_bf16_f32 v204, v228, v229
    v_cvt_pk_bf16_f32 v205, v230, v231
    s_nop 1
    v_exp_f32 v232, v232
    ds_read_b64_tr_b16 a[236:237], v0 offset:0
    ds_read_b64_tr_b16 a[238:239], v0 offset:32
    v_exp_f32 v233, v233
    v_exp_f32 v234, v234
    s_waitcnt vmcnt(11) lgkmcnt(0)
    v_exp_f32 v235, v235
    s_barrier
    v_cvt_pk_bf16_f32 v206, v232, v233
    v_cvt_pk_bf16_f32 v207, v234, v235
    v_mfma_f32_16x16x32_bf16 v[48:51], v[184:187], a[200:203], v[48:51]
    v_mfma_f32_16x16x32_bf16 v[48:51], v[180:183], a[204:207], v[48:51]
    s_add_u32 m0, s24, 8448
    ds_read_b128 a[80:83], v1 offset:16896
    v_mfma_f32_16x16x32_bf16 v[44:47], v[180:183], a[196:199], v[44:47]
    v_mfma_f32_16x16x32_bf16 v[44:47], v[184:187], a[192:195], v[44:47]
    buffer_load_dwordx4 v3, s[4:7], 0 offen nt lds
    v_mfma_f32_16x16x32_bf16 v[40:43], v[184:187], a[184:187], v[40:43]
    v_mfma_f32_16x16x32_bf16 v[40:43], v[180:183], a[188:191], v[40:43]
    ds_read_b64_tr_b16 a[144:145], v2 offset:8320
    v_mfma_f32_16x16x32_bf16 v[36:39], v[180:183], a[180:183], v[36:39]
    v_mfma_f32_16x16x32_bf16 v[36:39], v[184:187], a[176:179], v[36:39]
    ds_read_b128 a[84:87], v1 offset:16960
    v_mfma_f32_16x16x32_bf16 v[228:231], a[112:115], a[0:3], v[236:239]
    v_mfma_f32_16x16x32_bf16 v[228:231], a[116:119], a[4:7], v[228:231]
    v_mfma_f32_16x16x32_bf16 v[228:231], a[120:123], a[8:11], v[228:231]
    v_mfma_f32_16x16x32_bf16 v[228:231], a[124:127], a[12:15], v[228:231]
    ds_read_b64_tr_b16 a[146:147], v2 offset:8832
    v_mfma_f32_16x16x32_bf16 v[232:235], a[140:143], a[12:15], v[236:239]
    v_mfma_f32_16x16x32_bf16 v[232:235], a[136:139], a[8:11], v[232:235]
    v_mfma_f32_16x16x32_bf16 v[232:235], a[132:135], a[4:7], v[232:235]
    v_mfma_f32_16x16x32_bf16 v[232:235], a[128:131], a[0:3], v[232:235]
    ds_read_b64_tr_b16 a[148:149], v2 offset:12480
    ds_read_b64_tr_b16 a[150:151], v2 offset:12992
    v_mfma_f32_16x16x32_bf16 v[224:227], a[128:131], a[16:19], v[240:243]
    v_exp_f32 v228, v228
    v_mfma_f32_16x16x32_bf16 v[224:227], a[132:135], a[20:23], v[224:227]
    s_add_u32 m0, s24, 8480
    v_exp_f32 v229, v229
    v_mfma_f32_16x16x32_bf16 v[224:227], a[136:139], a[24:27], v[224:227]
    v_exp_f32 v230, v230
    v_mfma_f32_16x16x32_bf16 v[224:227], a[140:143], a[28:31], v[224:227]
    buffer_load_dwordx4 v3, s[4:7], 0 offen offset:1024 nt lds
    v_mfma_f32_16x16x32_bf16 v[220:223], a[124:127], a[28:31], v[240:243]
    s_add_u32 s4, s4, 8192
    v_exp_f32 v231, v231
    v_mfma_f32_16x16x32_bf16 v[220:223], a[120:123], a[24:27], v[220:223]
    s_addc_u32 s5, s5, 0
    v_cvt_pk_bf16_f32 v184, v228, v229
    v_cvt_pk_bf16_f32 v185, v230, v231
    v_mfma_f32_16x16x32_bf16 v[220:223], a[116:119], a[20:23], v[220:223]
    s_sub_u32 s20, s20, 8192
    v_exp_f32 v232, v232
    v_mfma_f32_16x16x32_bf16 v[220:223], a[112:115], a[16:19], v[220:223]
    s_max_i32 s6, s20, 0
    ds_read_b128 a[88:91], v1 offset:17024
    v_mfma_f32_16x16x32_bf16 v[68:71], v[192:195], a[176:179], v[68:71]
    v_exp_f32 v233, v233
    v_mfma_f32_16x16x32_bf16 v[68:71], v[188:191], a[180:183], v[68:71]
    ds_read_b64_tr_b16 a[152:153], v2 offset:8336
    v_mfma_f32_16x16x32_bf16 v[72:75], v[188:191], a[188:191], v[72:75]
    v_exp_f32 v234, v234
    v_mfma_f32_16x16x32_bf16 v[72:75], v[192:195], a[184:187], v[72:75]
    ds_read_b128 a[92:95], v1 offset:17088
    v_mfma_f32_16x16x32_bf16 v[76:79], v[192:195], a[192:195], v[76:79]
    v_exp_f32 v235, v235
    v_mfma_f32_16x16x32_bf16 v[76:79], v[188:191], a[196:199], v[76:79]
    ds_read_b64_tr_b16 a[154:155], v2 offset:8848
    v_mfma_f32_16x16x32_bf16 v[80:83], v[188:191], a[204:207], v[80:83]
    v_cvt_pk_bf16_f32 v186, v232, v233
    v_cvt_pk_bf16_f32 v187, v234, v235
    v_mfma_f32_16x16x32_bf16 v[80:83], v[192:195], a[200:203], v[80:83]
    ds_read_b64_tr_b16 a[156:157], v2 offset:12496
    ds_read_b64_tr_b16 a[158:159], v2 offset:13008
    v_mfma_f32_16x16x32_bf16 v[112:115], v[200:203], a[200:203], v[112:115]
    v_exp_f32 v224, v224
    v_mfma_f32_16x16x32_bf16 v[112:115], v[196:199], a[204:207], v[112:115]
    s_add_u32 m0, s25, 0
    ds_read_b128 a[96:99], v1 offset:17408
    v_mfma_f32_16x16x32_bf16 v[108:111], v[196:199], a[196:199], v[108:111]
    v_exp_f32 v225, v225
    v_mfma_f32_16x16x32_bf16 v[108:111], v[200:203], a[192:195], v[108:111]
    buffer_load_dwordx4 v4, s[8:11], 0 offen nt lds
    v_mfma_f32_16x16x32_bf16 v[104:107], v[200:203], a[184:187], v[104:107]
    v_exp_f32 v226, v226
    v_mfma_f32_16x16x32_bf16 v[104:107], v[196:199], a[188:191], v[104:107]
    ds_read_b64_tr_b16 a[160:161], v2 offset:8352
    v_mfma_f32_16x16x32_bf16 v[100:103], v[196:199], a[180:183], v[100:103]
    v_exp_f32 v227, v227
    v_mfma_f32_16x16x32_bf16 v[100:103], v[200:203], a[176:179], v[100:103]
    ds_read_b128 a[100:103], v1 offset:17472
    v_mfma_f32_16x16x32_bf16 v[228:231], a[112:115], a[32:35], v[244:247]
    v_cvt_pk_bf16_f32 v194, v224, v225
    v_cvt_pk_bf16_f32 v195, v226, v227
    v_mfma_f32_16x16x32_bf16 v[228:231], a[116:119], a[36:39], v[228:231]
    v_exp_f32 v220, v220
    v_mfma_f32_16x16x32_bf16 v[228:231], a[120:123], a[40:43], v[228:231]
    v_exp_f32 v221, v221
    v_mfma_f32_16x16x32_bf16 v[228:231], a[124:127], a[44:47], v[228:231]
    ds_read_b64_tr_b16 a[162:163], v2 offset:8864
    v_mfma_f32_16x16x32_bf16 v[232:235], a[140:143], a[44:47], v[244:247]
    v_exp_f32 v222, v222
    v_mfma_f32_16x16x32_bf16 v[232:235], a[136:139], a[40:43], v[232:235]
    v_exp_f32 v223, v223
    v_mfma_f32_16x16x32_bf16 v[232:235], a[132:135], a[36:39], v[232:235]
    v_cvt_pk_bf16_f32 v192, v220, v221
    v_cvt_pk_bf16_f32 v193, v222, v223
    v_mfma_f32_16x16x32_bf16 v[232:235], a[128:131], a[32:35], v[232:235]
    ds_read_b64_tr_b16 a[164:165], v2 offset:12512
    ds_read_b64_tr_b16 a[166:167], v2 offset:13024
    v_mfma_f32_16x16x32_bf16 v[224:227], a[128:131], a[48:51], v[248:251]
    v_exp_f32 v228, v228
    v_mfma_f32_16x16x32_bf16 v[224:227], a[132:135], a[52:55], v[224:227]
    s_add_u32 m0, s25, 16
    v_exp_f32 v229, v229
    v_mfma_f32_16x16x32_bf16 v[224:227], a[136:139], a[56:59], v[224:227]
    v_exp_f32 v230, v230
    v_mfma_f32_16x16x32_bf16 v[224:227], a[140:143], a[60:63], v[224:227]
    buffer_load_dwordx4 v4, s[8:11], 0 offen offset:1024 nt lds
    v_mfma_f32_16x16x32_bf16 v[220:223], a[124:127], a[60:63], v[248:251]
    s_add_u32 s8, s8, 8064
    v_exp_f32 v231, v231
    v_mfma_f32_16x16x32_bf16 v[220:223], a[120:123], a[56:59], v[220:223]
    s_addc_u32 s9, s9, 0
    v_cvt_pk_bf16_f32 v200, v228, v229
    v_cvt_pk_bf16_f32 v201, v230, v231
    v_mfma_f32_16x16x32_bf16 v[220:223], a[116:119], a[52:55], v[220:223]
    s_sub_u32 s21, s21, 8064
    v_exp_f32 v232, v232
    v_mfma_f32_16x16x32_bf16 v[220:223], a[112:115], a[48:51], v[220:223]
    s_max_i32 s10, s21, 0
    ds_read_b128 a[104:107], v1 offset:17536
    v_mfma_f32_16x16x32_bf16 v[132:135], v[208:211], a[176:179], v[132:135]
    v_exp_f32 v233, v233
    v_mfma_f32_16x16x32_bf16 v[132:135], v[204:207], a[180:183], v[132:135]
    ds_read_b64_tr_b16 a[168:169], v2 offset:8368
    v_mfma_f32_16x16x32_bf16 v[136:139], v[204:207], a[188:191], v[136:139]
    v_exp_f32 v234, v234
    v_mfma_f32_16x16x32_bf16 v[136:139], v[208:211], a[184:187], v[136:139]
    ds_read_b128 a[108:111], v1 offset:17600
    v_mfma_f32_16x16x32_bf16 v[140:143], v[208:211], a[192:195], v[140:143]
    v_exp_f32 v235, v235
    v_mfma_f32_16x16x32_bf16 v[140:143], v[204:207], a[196:199], v[140:143]
    ds_read_b64_tr_b16 a[170:171], v2 offset:8880
    v_mfma_f32_16x16x32_bf16 v[144:147], v[204:207], a[204:207], v[144:147]
    v_cvt_pk_bf16_f32 v202, v232, v233
    v_cvt_pk_bf16_f32 v203, v234, v235
    v_mfma_f32_16x16x32_bf16 v[144:147], v[208:211], a[200:203], v[144:147]
    ds_read_b64_tr_b16 a[172:173], v2 offset:12528
    ds_read_b64_tr_b16 a[174:175], v2 offset:13040
    v_exp_f32 v224, v224
    ds_read_b64_tr_b16 a[240:241], v0 offset:1088
    ds_read_b64_tr_b16 a[242:243], v0 offset:1120
    v_exp_f32 v225, v225
    v_exp_f32 v226, v226
    v_exp_f32 v227, v227
    v_cvt_pk_bf16_f32 v210, v224, v225
    v_cvt_pk_bf16_f32 v211, v226, v227
    v_exp_f32 v220, v220
    s_waitcnt vmcnt(11) lgkmcnt(0)
    v_exp_f32 v221, v221
    s_barrier
    v_exp_f32 v222, v222
    v_exp_f32 v223, v223
    v_cvt_pk_bf16_f32 v208, v220, v221
    v_cvt_pk_bf16_f32 v209, v222, v223
    v_mfma_f32_16x16x32_bf16 v[224:227], a[96:99], a[0:3], v[236:239]
    v_mfma_f32_16x16x32_bf16 v[224:227], a[100:103], a[4:7], v[224:227]
    s_add_u32 m0, s24, 16896
    v_mfma_f32_16x16x32_bf16 v[224:227], a[104:107], a[8:11], v[224:227]
    v_mfma_f32_16x16x32_bf16 v[224:227], a[108:111], a[12:15], v[224:227]
    buffer_load_dwordx4 v3, s[4:7], 0 offen nt lds
    v_mfma_f32_16x16x32_bf16 v[220:223], a[92:95], a[12:15], v[236:239]
    v_mfma_f32_16x16x32_bf16 v[220:223], a[88:91], a[8:11], v[220:223]
    v_mfma_f32_16x16x32_bf16 v[220:223], a[84:87], a[4:7], v[220:223]
    v_mfma_f32_16x16x32_bf16 v[220:223], a[80:83], a[0:3], v[220:223]
    ds_read_b128 a[112:115], v1 offset:25344
    v_smfmac_f32_16x16x64_bf16 a[208:211], a[228:231], v[180:187], v10
    ds_read_b64_tr_b16 a[176:177], v2 offset:16640
    v_smfmac_f32_16x16x64_bf16 a[212:215], a[228:231], v[188:195], v10
    ds_read_b128 a[116:119], v1 offset:25408
    v_mfma_f32_16x16x32_bf16 v[20:23], v[180:183], a[144:147], v[20:23]
    v_mfma_f32_16x16x32_bf16 v[20:23], v[184:187], a[148:151], v[20:23]
    ds_read_b64_tr_b16 a[178:179], v2 offset:17152
    v_mfma_f32_16x16x32_bf16 v[24:27], v[184:187], a[156:159], v[24:27]
    v_mfma_f32_16x16x32_bf16 v[24:27], v[180:183], a[152:155], v[24:27]
    ds_read_b64_tr_b16 a[180:181], v2 offset:20800
    v_mfma_f32_16x16x32_bf16 v[28:31], v[180:183], a[160:163], v[28:31]
    v_mfma_f32_16x16x32_bf16 v[28:31], v[184:187], a[164:167], v[28:31]
    ds_read_b64_tr_b16 a[182:183], v2 offset:21312
    v_mfma_f32_16x16x32_bf16 v[32:35], v[184:187], a[172:175], v[32:35]
    v_mfma_f32_16x16x32_bf16 v[32:35], v[180:183], a[168:171], v[32:35]
    ds_read_b128 a[120:123], v1 offset:25472
    v_mfma_f32_16x16x32_bf16 v[64:67], v[188:191], a[168:171], v[64:67]
    v_exp_f32 v224, v224
    v_mfma_f32_16x16x32_bf16 v[64:67], v[192:195], a[172:175], v[64:67]
    s_add_u32 m0, s24, 16928
    ds_read_b64_tr_b16 a[184:185], v2 offset:16656
    v_mfma_f32_16x16x32_bf16 v[60:63], v[192:195], a[164:167], v[60:63]
    v_exp_f32 v225, v225
    v_mfma_f32_16x16x32_bf16 v[60:63], v[188:191], a[160:163], v[60:63]
    buffer_load_dwordx4 v3, s[4:7], 0 offen offset:1024 nt lds
    v_mfma_f32_16x16x32_bf16 v[56:59], v[188:191], a[152:155], v[56:59]
    s_add_u32 s4, s4, 8192
    v_exp_f32 v226, v226
    v_mfma_f32_16x16x32_bf16 v[56:59], v[192:195], a[156:159], v[56:59]
    s_addc_u32 s5, s5, 0
    ds_read_b128 a[124:127], v1 offset:25536
    v_mfma_f32_16x16x32_bf16 v[52:55], v[192:195], a[148:151], v[52:55]
    s_sub_u32 s20, s20, 8192
    v_exp_f32 v227, v227
    v_mfma_f32_16x16x32_bf16 v[52:55], v[188:191], a[144:147], v[52:55]
    s_max_i32 s6, s20, 0
    ds_read_b64_tr_b16 a[186:187], v2 offset:17168
    v_mfma_f32_16x16x32_bf16 v[228:231], a[80:83], a[16:19], v[240:243]
    v_cvt_pk_bf16_f32 v182, v224, v225
    v_cvt_pk_bf16_f32 v183, v226, v227
    v_mfma_f32_16x16x32_bf16 v[228:231], a[84:87], a[20:23], v[228:231]
    v_exp_f32 v220, v220
    v_mfma_f32_16x16x32_bf16 v[228:231], a[88:91], a[24:27], v[228:231]
    v_exp_f32 v221, v221
    v_mfma_f32_16x16x32_bf16 v[228:231], a[92:95], a[28:31], v[228:231]
    ds_read_b64_tr_b16 a[188:189], v2 offset:20816
    v_mfma_f32_16x16x32_bf16 v[232:235], a[108:111], a[28:31], v[240:243]
    v_exp_f32 v222, v222
    v_mfma_f32_16x16x32_bf16 v[232:235], a[104:107], a[24:27], v[232:235]
    v_exp_f32 v223, v223
    v_mfma_f32_16x16x32_bf16 v[232:235], a[100:103], a[20:23], v[232:235]
    v_cvt_pk_bf16_f32 v180, v220, v221
    v_cvt_pk_bf16_f32 v181, v222, v223
    v_mfma_f32_16x16x32_bf16 v[232:235], a[96:99], a[16:19], v[232:235]
    ds_read_b64_tr_b16 a[190:191], v2 offset:21328
    v_mfma_f32_16x16x32_bf16 v[224:227], a[96:99], a[32:35], v[244:247]
    v_exp_f32 v228, v228
    v_mfma_f32_16x16x32_bf16 v[224:227], a[100:103], a[36:39], v[224:227]
    s_add_u32 m0, s25, 8320
    v_exp_f32 v229, v229
    v_mfma_f32_16x16x32_bf16 v[224:227], a[104:107], a[40:43], v[224:227]
    v_exp_f32 v230, v230
    v_mfma_f32_16x16x32_bf16 v[224:227], a[108:111], a[44:47], v[224:227]
    buffer_load_dwordx4 v4, s[8:11], 0 offen nt lds
    v_mfma_f32_16x16x32_bf16 v[220:223], a[92:95], a[44:47], v[244:247]
    v_exp_f32 v231, v231
    v_mfma_f32_16x16x32_bf16 v[220:223], a[88:91], a[40:43], v[220:223]
    v_cvt_pk_bf16_f32 v188, v228, v229
    v_cvt_pk_bf16_f32 v189, v230, v231
    v_mfma_f32_16x16x32_bf16 v[220:223], a[84:87], a[36:39], v[220:223]
    v_exp_f32 v232, v232
    v_mfma_f32_16x16x32_bf16 v[220:223], a[80:83], a[32:35], v[220:223]
    ds_read_b128 a[128:131], v1 offset:25856
    v_smfmac_f32_16x16x64_bf16 a[216:219], a[228:231], v[196:203], v10
    ds_read_b64_tr_b16 a[192:193], v2 offset:16672
    v_smfmac_f32_16x16x64_bf16 a[220:223], a[228:231], v[204:211], v10
    ds_read_b128 a[132:135], v1 offset:25920
    ds_read_b64_tr_b16 a[194:195], v2 offset:17184
    v_mfma_f32_16x16x32_bf16 v[84:87], v[196:199], a[144:147], v[84:87]
    v_exp_f32 v233, v233
    v_mfma_f32_16x16x32_bf16 v[84:87], v[200:203], a[148:151], v[84:87]
    ds_read_b64_tr_b16 a[196:197], v2 offset:20832
    v_mfma_f32_16x16x32_bf16 v[88:91], v[200:203], a[156:159], v[88:91]
    v_exp_f32 v234, v234
    v_mfma_f32_16x16x32_bf16 v[88:91], v[196:199], a[152:155], v[88:91]
    ds_read_b64_tr_b16 a[198:199], v2 offset:21344
    v_mfma_f32_16x16x32_bf16 v[92:95], v[196:199], a[160:163], v[92:95]
    v_exp_f32 v235, v235
    v_mfma_f32_16x16x32_bf16 v[92:95], v[200:203], a[164:167], v[92:95]
    ds_read_b128 a[136:139], v1 offset:25984
    v_mfma_f32_16x16x32_bf16 v[96:99], v[200:203], a[172:175], v[96:99]
    v_cvt_pk_bf16_f32 v190, v232, v233
    v_cvt_pk_bf16_f32 v191, v234, v235
    v_mfma_f32_16x16x32_bf16 v[96:99], v[196:199], a[168:171], v[96:99]
    ds_read_b64_tr_b16 a[200:201], v2 offset:16688
    v_mfma_f32_16x16x32_bf16 v[128:131], v[204:207], a[168:171], v[128:131]
    v_exp_f32 v224, v224
    v_mfma_f32_16x16x32_bf16 v[128:131], v[208:211], a[172:175], v[128:131]
    s_add_u32 m0, s25, 8336
    ds_read_b128 a[140:143], v1 offset:26048
    v_mfma_f32_16x16x32_bf16 v[124:127], v[208:211], a[164:167], v[124:127]
    v_exp_f32 v225, v225
    v_mfma_f32_16x16x32_bf16 v[124:127], v[204:207], a[160:163], v[124:127]
    buffer_load_dwordx4 v4, s[8:11], 0 offen offset:1024 nt lds
    v_mfma_f32_16x16x32_bf16 v[120:123], v[204:207], a[152:155], v[120:123]
    s_add_u32 s8, s8, 8320
    v_exp_f32 v226, v226
    v_mfma_f32_16x16x32_bf16 v[120:123], v[208:211], a[156:159], v[120:123]
    s_addc_u32 s9, s9, 0
    ds_read_b64_tr_b16 a[202:203], v2 offset:17200
    v_mfma_f32_16x16x32_bf16 v[116:119], v[208:211], a[148:151], v[116:119]
    s_sub_u32 s21, s21, 8320
    v_exp_f32 v227, v227
    v_mfma_f32_16x16x32_bf16 v[116:119], v[204:207], a[144:147], v[116:119]
    s_max_i32 s10, s21, 0
    ds_read_b64_tr_b16 a[204:205], v2 offset:20848
    v_mfma_f32_16x16x32_bf16 v[228:231], a[80:83], a[48:51], v[248:251]
    v_cvt_pk_bf16_f32 v198, v224, v225
    v_cvt_pk_bf16_f32 v199, v226, v227
    v_mfma_f32_16x16x32_bf16 v[228:231], a[84:87], a[52:55], v[228:231]
    v_exp_f32 v220, v220
    v_mfma_f32_16x16x32_bf16 v[228:231], a[88:91], a[56:59], v[228:231]
    v_exp_f32 v221, v221
    v_mfma_f32_16x16x32_bf16 v[228:231], a[92:95], a[60:63], v[228:231]
    ds_read_b64_tr_b16 a[206:207], v2 offset:21360
    v_mfma_f32_16x16x32_bf16 v[232:235], a[108:111], a[60:63], v[248:251]
    v_exp_f32 v222, v222
    v_mfma_f32_16x16x32_bf16 v[232:235], a[104:107], a[56:59], v[232:235]
    v_exp_f32 v223, v223
    v_mfma_f32_16x16x32_bf16 v[232:235], a[100:103], a[52:55], v[232:235]
    v_cvt_pk_bf16_f32 v196, v220, v221
    v_cvt_pk_bf16_f32 v197, v222, v223
    v_mfma_f32_16x16x32_bf16 v[232:235], a[96:99], a[48:51], v[232:235]
    s_lshr_b64 vcc, vcc, 1
    v_exp_f32 v228, v228
    v_exp_f32 v229, v229
    v_exp_f32 v230, v230
    v_exp_f32 v231, v231
    v_cvt_pk_bf16_f32 v204, v228, v229
    v_cvt_pk_bf16_f32 v205, v230, v231
    s_nop 0
    v_exp_f32 v232, v232
    ds_read_b64_tr_b16 a[244:245], v0 offset:2176
    ds_read_b64_tr_b16 a[246:247], v0 offset:2208
    v_exp_f32 v233, v233
    v_exp_f32 v234, v234
    s_waitcnt vmcnt(8) lgkmcnt(0)
    v_exp_f32 v235, v235
    s_barrier
    v_cvt_pk_bf16_f32 v206, v232, v233
    v_cvt_pk_bf16_f32 v207, v234, v235
    s_cbranch_vccnz L_loop1_1
    s_nop 7
    s_branch L_final
L_end:
L_slow:
    s_waitcnt vmcnt(0) lgkmcnt(0)
    s_mov_b32 s27, 0
    v_lshrrev_b32 v0, 4, v3
    s_mov_b32 s4, s50
    s_mov_b32 s5, s51
    s_mov_b32 s6, 524288
    s_mov_b32 s8, s52
    s_mov_b32 s9, s53
    s_mov_b32 s10, 524288
    v_and_b32 v11, 15, v0
    v_lshrrev_b32 v12, 4, v0
    v_lshlrev_b32 v13, 8, v11
    v_lshl_add_u32 v147, v12, 4, v13
    v_lshl_add_u32 v149, v12, 3, v13
    v_lshrrev_b32 v13, 2, v0
    v_lshlrev_b32 v13, 8, v13
    v_and_b32 v14, 3, v0
    v_lshl_add_u32 v13, v14, 3, v13
    v_add_u32 v148, s36, v13
    s_mov_b32 s14, 159744
    s_mov_b32 s18, 159744
L_slow_task:
    s_bitcmp1_b32 s28, s27
    s_cbranch_scc0 L_slow_next
    s_mul_i32 s34, s27, 159744
    s_add_u32 s12, s40, s34
    s_addc_u32 s13, s41, 0
    s_add_u32 s16, s42, s34
    s_addc_u32 s17, s43, 0
    s_cmp_eq_u32 s27, 0
    s_cselect_b32 s59, s37, s38
    s_mov_b32 s46, 0
L_slow_tile:
    buffer_load_dwordx4 v[20:23], v147, s[12:15], s59 offen offset:0
    buffer_load_dwordx4 v[24:27], v147, s[12:15], s59 offen offset:64
    buffer_load_dwordx4 v[28:31], v147, s[12:15], s59 offen offset:128
    buffer_load_dwordx4 v[32:35], v147, s[12:15], s59 offen offset:192
    s_waitcnt vmcnt(0)
    v_lshlrev_b32 v152, 16, v20
    v_lshlrev_b32 v154, 16, v21
    v_lshlrev_b32 v156, 16, v22
    v_lshlrev_b32 v158, 16, v23
    v_and_b32 v153, s29, v20
    v_and_b32 v155, s29, v21
    v_and_b32 v157, s29, v22
    v_and_b32 v159, s29, v23
    v_pk_mul_f32 v[152:153], v[152:153], s[30:31]
    v_pk_mul_f32 v[154:155], v[154:155], s[30:31]
    v_pk_mul_f32 v[156:157], v[156:157], s[30:31]
    v_pk_mul_f32 v[158:159], v[158:159], s[30:31]
    v_cvt_pk_bf16_f32 v20, v152, v153
    v_cvt_pk_bf16_f32 v21, v154, v155
    v_cvt_pk_bf16_f32 v22, v156, v157
    v_cvt_pk_bf16_f32 v23, v158, v159
    v_lshlrev_b32 v152, 16, v24
    v_lshlrev_b32 v154, 16, v25
    v_lshlrev_b32 v156, 16, v26
    v_lshlrev_b32 v158, 16, v27
    v_and_b32 v153, s29, v24
    v_and_b32 v155, s29, v25
    v_and_b32 v157, s29, v26
    v_and_b32 v159, s29, v27
    v_pk_mul_f32 v[152:153], v[152:153], s[30:31]
    v_pk_mul_f32 v[154:155], v[154:155], s[30:31]
    v_pk_mul_f32 v[156:157], v[156:157], s[30:31]
    v_pk_mul_f32 v[158:159], v[158:159], s[30:31]
    v_cvt_pk_bf16_f32 v24, v152, v153
    v_cvt_pk_bf16_f32 v25, v154, v155
    v_cvt_pk_bf16_f32 v26, v156, v157
    v_cvt_pk_bf16_f32 v27, v158, v159
    v_lshlrev_b32 v152, 16, v28
    v_lshlrev_b32 v154, 16, v29
    v_lshlrev_b32 v156, 16, v30
    v_lshlrev_b32 v158, 16, v31
    v_and_b32 v153, s29, v28
    v_and_b32 v155, s29, v29
    v_and_b32 v157, s29, v30
    v_and_b32 v159, s29, v31
    v_pk_mul_f32 v[152:153], v[152:153], s[30:31]
    v_pk_mul_f32 v[154:155], v[154:155], s[30:31]
    v_pk_mul_f32 v[156:157], v[156:157], s[30:31]
    v_pk_mul_f32 v[158:159], v[158:159], s[30:31]
    v_cvt_pk_bf16_f32 v28, v152, v153
    v_cvt_pk_bf16_f32 v29, v154, v155
    v_cvt_pk_bf16_f32 v30, v156, v157
    v_cvt_pk_bf16_f32 v31, v158, v159
    v_lshlrev_b32 v152, 16, v32
    v_lshlrev_b32 v154, 16, v33
    v_lshlrev_b32 v156, 16, v34
    v_lshlrev_b32 v158, 16, v35
    v_and_b32 v153, s29, v32
    v_and_b32 v155, s29, v33
    v_and_b32 v157, s29, v34
    v_and_b32 v159, s29, v35
    v_pk_mul_f32 v[152:153], v[152:153], s[30:31]
    v_pk_mul_f32 v[154:155], v[154:155], s[30:31]
    v_pk_mul_f32 v[156:157], v[156:157], s[30:31]
    v_pk_mul_f32 v[158:159], v[158:159], s[30:31]
    v_cvt_pk_bf16_f32 v32, v152, v153
    v_cvt_pk_bf16_f32 v33, v154, v155
    v_cvt_pk_bf16_f32 v34, v156, v157
    v_cvt_pk_bf16_f32 v35, v158, v159
    v_mov_b32 v100, 0
    v_mov_b32 v101, 0
    v_mov_b32 v102, 0
    v_mov_b32 v103, 0
    v_mov_b32 v104, 0
    v_mov_b32 v105, 0
    v_mov_b32 v106, 0
    v_mov_b32 v107, 0
    v_mov_b32 v108, 0
    v_mov_b32 v109, 0
    v_mov_b32 v110, 0
    v_mov_b32 v111, 0
    v_mov_b32 v112, 0
    v_mov_b32 v113, 0
    v_mov_b32 v114, 0
    v_mov_b32 v115, 0
    v_mov_b32 v116, 0
    v_mov_b32 v117, 0
    v_mov_b32 v118, 0
    v_mov_b32 v119, 0
    v_mov_b32 v120, 0
    v_mov_b32 v121, 0
    v_mov_b32 v122, 0
    v_mov_b32 v123, 0
    v_mov_b32 v124, 0
    v_mov_b32 v125, 0
    v_mov_b32 v126, 0
    v_mov_b32 v127, 0
    v_mov_b32 v128, 0
    v_mov_b32 v129, 0
    v_mov_b32 v130, 0
    v_mov_b32 v131, 0
    v_mov_b32 v144, 0xff7fffff
    v_mov_b32 v145, 0
    s_lshl_b32 s58, s27, 18
    s_mov_b32 s47, 0
L_slow_kb:
    s_add_u32 s34, s58, 4096
    buffer_load_dwordx4 v[36:39], v147, s[4:7], s58 offen offset:0
    buffer_load_dwordx4 v[40:43], v147, s[4:7], s58 offen offset:64
    buffer_load_dwordx4 v[44:47], v147, s[4:7], s58 offen offset:128
    buffer_load_dwordx4 v[48:51], v147, s[4:7], s58 offen offset:192
    buffer_load_dwordx4 v[52:55], v147, s[4:7], s34 offen offset:0
    buffer_load_dwordx4 v[56:59], v147, s[4:7], s34 offen offset:64
    buffer_load_dwordx4 v[60:63], v147, s[4:7], s34 offen offset:128
    buffer_load_dwordx4 v[64:67], v147, s[4:7], s34 offen offset:192
    s_add_u32 m0, s36, 0
    s_nop 0
    buffer_load_dwordx4 v3, s[8:11], s58 offen offset:0 lds
    buffer_load_dwordx4 v3, s[8:11], s58 offen offset:1024 lds
    buffer_load_dwordx4 v3, s[8:11], s58 offen offset:2048 lds
    buffer_load_dwordx4 v3, s[8:11], s58 offen offset:3072 lds
    s_add_u32 m0, s36, 4096
    s_nop 0
    buffer_load_dwordx4 v3, s[8:11], s34 offen offset:0 lds
    buffer_load_dwordx4 v3, s[8:11], s34 offen offset:1024 lds
    buffer_load_dwordx4 v3, s[8:11], s34 offen offset:2048 lds
    buffer_load_dwordx4 v3, s[8:11], s34 offen offset:3072 lds
    s_waitcnt vmcnt(0)
    ds_read_b64_tr_b16 v[68:69], v148 offset:0
    ds_read_b64_tr_b16 v[70:71], v148 offset:4096
    ds_read_b64_tr_b16 v[72:73], v148 offset:32
    ds_read_b64_tr_b16 v[74:75], v148 offset:4128
    ds_read_b64_tr_b16 v[76:77], v148 offset:64
    ds_read_b64_tr_b16 v[78:79], v148 offset:4160
    ds_read_b64_tr_b16 v[80:81], v148 offset:96
    ds_read_b64_tr_b16 v[82:83], v148 offset:4192
    ds_read_b64_tr_b16 v[84:85], v148 offset:128
    ds_read_b64_tr_b16 v[86:87], v148 offset:4224
    ds_read_b64_tr_b16 v[88:89], v148 offset:160
    ds_read_b64_tr_b16 v[90:91], v148 offset:4256
    ds_read_b64_tr_b16 v[92:93], v148 offset:192
    ds_read_b64_tr_b16 v[94:95], v148 offset:4288
    ds_read_b64_tr_b16 v[96:97], v148 offset:224
    ds_read_b64_tr_b16 v[98:99], v148 offset:4320
    v_mfma_f32_16x16x32_bf16 v[132:135], v[36:39], v[20:23], 0
    v_mfma_f32_16x16x32_bf16 v[132:135], v[40:43], v[24:27], v[132:135]
    v_mfma_f32_16x16x32_bf16 v[132:135], v[44:47], v[28:31], v[132:135]
    v_mfma_f32_16x16x32_bf16 v[132:135], v[48:51], v[32:35], v[132:135]
    v_mfma_f32_16x16x32_bf16 v[136:139], v[52:55], v[20:23], 0
    v_mfma_f32_16x16x32_bf16 v[136:139], v[56:59], v[24:27], v[136:139]
    v_mfma_f32_16x16x32_bf16 v[136:139], v[60:63], v[28:31], v[136:139]
    v_mfma_f32_16x16x32_bf16 v[136:139], v[64:67], v[32:35], v[136:139]
    s_nop 7
    v_max3_f32 v11, v132, v133, v134
    v_max3_f32 v12, v135, v136, v137
    v_max3_f32 v11, v11, v138, v139
    v_max_f32 v11, v11, v12
    v_mov_b32 v12, v11
    s_nop 1
    v_permlane32_swap_b32 v11, v12
    v_max_f32 v11, v11, v12
    v_mov_b32 v12, v11
    s_nop 1
    v_permlane16_swap_b32 v11, v12
    v_max_f32 v11, v11, v12
    v_max_f32 v11, v11, v144
    v_sub_f32 v146, v144, v11
    v_mov_b32 v144, v11
    v_exp_f32 v146, v146
    v_sub_f32 v132, v132, v144
    v_sub_f32 v133, v133, v144
    v_sub_f32 v134, v134, v144
    v_sub_f32 v135, v135, v144
    v_sub_f32 v136, v136, v144
    v_sub_f32 v137, v137, v144
    v_sub_f32 v138, v138, v144
    v_sub_f32 v139, v139, v144
    v_exp_f32 v132, v132
    v_exp_f32 v133, v133
    v_exp_f32 v134, v134
    v_exp_f32 v135, v135
    v_exp_f32 v136, v136
    v_exp_f32 v137, v137
    v_exp_f32 v138, v138
    v_exp_f32 v139, v139
    v_mul_f32 v145, v145, v146
    v_cvt_pk_bf16_f32 v140, v132, v133
    v_cvt_pk_bf16_f32 v141, v134, v135
    v_cvt_pk_bf16_f32 v142, v136, v137
    v_cvt_pk_bf16_f32 v143, v138, v139
    v_lshlrev_b32 v13, 16, v140
    v_and_b32 v14, s29, v140
    v_add_f32 v145, v145, v13
    v_add_f32 v145, v145, v14
    v_lshlrev_b32 v13, 16, v141
    v_and_b32 v14, s29, v141
    v_add_f32 v145, v145, v13
    v_add_f32 v145, v145, v14
    v_lshlrev_b32 v13, 16, v142
    v_and_b32 v14, s29, v142
    v_add_f32 v145, v145, v13
    v_add_f32 v145, v145, v14
    v_lshlrev_b32 v13, 16, v143
    v_and_b32 v14, s29, v143
    v_add_f32 v145, v145, v13
    v_add_f32 v145, v145, v14
    v_mul_f32 v100, v100, v146
    v_mul_f32 v101, v101, v146
    v_mul_f32 v102, v102, v146
    v_mul_f32 v103, v103, v146
    v_mul_f32 v104, v104, v146
    v_mul_f32 v105, v105, v146
    v_mul_f32 v106, v106, v146
    v_mul_f32 v107, v107, v146
    v_mul_f32 v108, v108, v146
    v_mul_f32 v109, v109, v146
    v_mul_f32 v110, v110, v146
    v_mul_f32 v111, v111, v146
    v_mul_f32 v112, v112, v146
    v_mul_f32 v113, v113, v146
    v_mul_f32 v114, v114, v146
    v_mul_f32 v115, v115, v146
    v_mul_f32 v116, v116, v146
    v_mul_f32 v117, v117, v146
    v_mul_f32 v118, v118, v146
    v_mul_f32 v119, v119, v146
    v_mul_f32 v120, v120, v146
    v_mul_f32 v121, v121, v146
    v_mul_f32 v122, v122, v146
    v_mul_f32 v123, v123, v146
    v_mul_f32 v124, v124, v146
    v_mul_f32 v125, v125, v146
    v_mul_f32 v126, v126, v146
    v_mul_f32 v127, v127, v146
    v_mul_f32 v128, v128, v146
    v_mul_f32 v129, v129, v146
    v_mul_f32 v130, v130, v146
    v_mul_f32 v131, v131, v146
    s_waitcnt lgkmcnt(0)
    s_nop 0
    v_mfma_f32_16x16x32_bf16 v[100:103], v[68:71], v[140:143], v[100:103]
    v_mfma_f32_16x16x32_bf16 v[104:107], v[72:75], v[140:143], v[104:107]
    v_mfma_f32_16x16x32_bf16 v[108:111], v[76:79], v[140:143], v[108:111]
    v_mfma_f32_16x16x32_bf16 v[112:115], v[80:83], v[140:143], v[112:115]
    v_mfma_f32_16x16x32_bf16 v[116:119], v[84:87], v[140:143], v[116:119]
    v_mfma_f32_16x16x32_bf16 v[120:123], v[88:91], v[140:143], v[120:123]
    v_mfma_f32_16x16x32_bf16 v[124:127], v[92:95], v[140:143], v[124:127]
    v_mfma_f32_16x16x32_bf16 v[128:131], v[96:99], v[140:143], v[128:131]
    s_add_u32 s58, s58, 8192
    s_add_u32 s47, s47, 1
    s_cmp_lt_u32 s47, 32
    s_cbranch_scc1 L_slow_kb
    v_mov_b32 v12, v145
    s_nop 1
    v_permlane32_swap_b32 v145, v12
    v_add_f32 v145, v145, v12
    v_mov_b32 v12, v145
    s_nop 1
    v_permlane16_swap_b32 v145, v12
    v_add_f32 v145, v145, v12
    v_rcp_f32 v145, v145
    s_nop 7
    v_mul_f32 v100, v100, v145
    v_mul_f32 v101, v101, v145
    v_mul_f32 v102, v102, v145
    v_mul_f32 v103, v103, v145
    v_mul_f32 v104, v104, v145
    v_mul_f32 v105, v105, v145
    v_mul_f32 v106, v106, v145
    v_mul_f32 v107, v107, v145
    v_mul_f32 v108, v108, v145
    v_mul_f32 v109, v109, v145
    v_mul_f32 v110, v110, v145
    v_mul_f32 v111, v111, v145
    v_mul_f32 v112, v112, v145
    v_mul_f32 v113, v113, v145
    v_mul_f32 v114, v114, v145
    v_mul_f32 v115, v115, v145
    v_mul_f32 v116, v116, v145
    v_mul_f32 v117, v117, v145
    v_mul_f32 v118, v118, v145
    v_mul_f32 v119, v119, v145
    v_mul_f32 v120, v120, v145
    v_mul_f32 v121, v121, v145
    v_mul_f32 v122, v122, v145
    v_mul_f32 v123, v123, v145
    v_mul_f32 v124, v124, v145
    v_mul_f32 v125, v125, v145
    v_mul_f32 v126, v126, v145
    v_mul_f32 v127, v127, v145
    v_mul_f32 v128, v128, v145
    v_mul_f32 v129, v129, v145
    v_mul_f32 v130, v130, v145
    v_mul_f32 v131, v131, v145
    v_cvt_pk_bf16_f32 v36, v100, v101
    v_cvt_pk_bf16_f32 v37, v102, v103
    v_cvt_pk_bf16_f32 v38, v104, v105
    v_cvt_pk_bf16_f32 v39, v106, v107
    v_cvt_pk_bf16_f32 v40, v108, v109
    v_cvt_pk_bf16_f32 v41, v110, v111
    v_cvt_pk_bf16_f32 v42, v112, v113
    v_cvt_pk_bf16_f32 v43, v114, v115
    v_cvt_pk_bf16_f32 v44, v116, v117
    v_cvt_pk_bf16_f32 v45, v118, v119
    v_cvt_pk_bf16_f32 v46, v120, v121
    v_cvt_pk_bf16_f32 v47, v122, v123
    v_cvt_pk_bf16_f32 v48, v124, v125
    v_cvt_pk_bf16_f32 v49, v126, v127
    v_cvt_pk_bf16_f32 v50, v128, v129
    v_cvt_pk_bf16_f32 v51, v130, v131
    buffer_store_dwordx2 v[36:37], v149, s[16:19], s59 offen offset:0
    buffer_store_dwordx2 v[38:39], v149, s[16:19], s59 offen offset:32
    buffer_store_dwordx2 v[40:41], v149, s[16:19], s59 offen offset:64
    buffer_store_dwordx2 v[42:43], v149, s[16:19], s59 offen offset:96
    buffer_store_dwordx2 v[44:45], v149, s[16:19], s59 offen offset:128
    buffer_store_dwordx2 v[46:47], v149, s[16:19], s59 offen offset:160
    buffer_store_dwordx2 v[48:49], v149, s[16:19], s59 offen offset:192
    buffer_store_dwordx2 v[50:51], v149, s[16:19], s59 offen offset:224
    s_waitcnt vmcnt(0)
    s_add_u32 s59, s59, 4096
    s_add_u32 s46, s46, 1
    s_cmp_lt_u32 s46, 5
    s_cbranch_scc1 L_slow_tile
L_slow_next:
    s_add_u32 s27, s27, 1
    s_cmp_lt_u32 s27, 2
    s_cbranch_scc1 L_slow_task
    s_endpgm
.section .rodata,"a"
.p2align 6
.amdhsa_kernel standalone__mha_softmax__near_ridge_kernel
  .amdhsa_next_free_vgpr 512
  .amdhsa_next_free_sgpr 102
  .amdhsa_accum_offset 256
  .amdhsa_group_segment_fixed_size 0
  .amdhsa_kernarg_size 48
  .amdhsa_user_sgpr_count 2
  .amdhsa_user_sgpr_kernarg_segment_ptr 1
  .amdhsa_system_sgpr_workgroup_id_x 1
  .amdhsa_float_denorm_mode_32 3
.end_amdhsa_kernel
```
